```python
import torch

def _softmax(x, axis=-1):
    return torch.softmax(x, dim=axis)

def _gelu(x):
    return torch.nn.functional.gelu(x, approximate='tanh')

def _silu(x):
    return torch.nn.functional.silu(x)

def _sigmoid(x):
    return torch.sigmoid(x)

def _layernorm(x, axis=-1, eps=1e-05):
    m = x.mean(dim=axis, keepdim=True)
    v = x.var(dim=axis, keepdim=True, unbiased=False)
    return (x - m) / torch.sqrt(v + eps)

def _scatter_add(tgt, idx, src, axis=0):
    return tgt.clone().index_add_(axis, idx, src)

def _segment_sum(src, seg, n):
    out = torch.zeros((n,) + src.shape[1:], dtype=src.dtype)
    return out.index_add_(0, seg, src)

def _pad(x, pw):
    flat = tuple((v for pair in reversed(pw) for v in pair))
    return torch.nn.functional.pad(x, flat)
kernel_name = 'adaLN_cond__memory_aug_recurrent_mem_tr__dense_activation_relu__prompt'

def setup_inputs():

    _w = lambda a: (lambda t: t.to(torch.bfloat16) if t.is_floating_point() else t)(torch.as_tensor(a))

    def _A_setup():
        B, S, Dm = (1, 2048, 512)
        H, Dh = (32, 128)
        M, seg = (8, 32)
        seg = min(seg, S)
        S = S // seg * seg
        return {'x': _w((lambda *s: torch.randn(*s, dtype=torch.bfloat16) * 0.05)(B, S, Dm)), 'mem0': _w((lambda *s: torch.randn(*s, dtype=torch.bfloat16) * 0.4)(B, M, Dm)), 'Wq': _w((lambda *s: torch.randn(*s, dtype=torch.bfloat16) * 3.2)(Dm, H, Dh) * Dm ** (-0.5)), 'Wk': _w((lambda *s: torch.randn(*s, dtype=torch.bfloat16) * 3.2)(Dm, H, Dh) * Dm ** (-0.5)), 'Wv': _w((lambda *s: torch.randn(*s, dtype=torch.bfloat16) * 0.4)(Dm, H, Dh) * Dm ** (-0.5)), 'Wo': _w((lambda *s: torch.randn(*s, dtype=torch.bfloat16) * 0.4)(H, Dh, Dm) * (H * Dh) ** (-0.5)), 'seg_len': seg}
    _A_in = _A_setup()

    def _B_setup():
        B, S, D, Dff = (1, 2048, 512, 1376)
        return {'x': _w((lambda *s: torch.randn(*s, dtype=torch.bfloat16) * 0.05)(B, S, D)), 'w1': _w((lambda *s: torch.randn(*s, dtype=torch.bfloat16) * 0.05)(D, Dff)), 'w2': _w((lambda *s: torch.randn(*s, dtype=torch.bfloat16) * 0.05)(Dff, D))}
    _B_in = _B_setup()
    return {'A_x': _A_in['x'], 'A_mem0': _A_in['mem0'], 'A_Wq': _A_in['Wq'], 'A_Wk': _A_in['Wk'], 'A_Wv': _A_in['Wv'], 'A_Wo': _A_in['Wo'], 'A_seg_len': _A_in['seg_len'], 'B_x': _B_in['x'], 'B_w1': _B_in['w1'], 'B_w2': _B_in['w2'], 'c': _w((lambda *s: torch.randn(*s, dtype=torch.bfloat16) * 0.1)(1, 512) * 8.0), 'w_mod': _w((lambda *s: torch.randn(*s, dtype=torch.bfloat16) * 0.1)(512, 6 * 512) * 512 ** (-0.5) * 8.0)}

def reference(A_x, A_mem0, A_Wq, A_Wk, A_Wv, A_Wo, A_seg_len, B_x, B_w1, B_w2, c, w_mod):

    def _A_ref(x, mem0, Wq, Wk, Wv, Wo, seg_len):
        B, S, Dm = x.shape
        H, Dh = (Wq.shape[1], Wq.shape[2])
        M = mem0.shape[1]
        scale = Dh ** (-0.5)
        n_seg = S // seg_len
        L = M + seg_len
        idx = torch.arange(L)
        mask = (idx[:, None] < M) | (idx[:, None] >= idx[None, :])
        mem = mem0
        outs = []
        for s in range(n_seg):
            xs = x[:, s * seg_len:(s + 1) * seg_len, :].clone()
            h = torch.concatenate([mem, xs], axis=1)
            q = torch.einsum('btd,dhe->bhte', h, Wq)
            k = torch.einsum('btd,dhe->bhte', h, Wk)
            v = torch.einsum('btd,dhe->bhte', h, Wv)
            scores = torch.einsum('bhqe,bhke->bhqk', q, k) * scale
            scores = torch.where(mask[None, None], scores, -1000000000.0)
            p = _softmax(scores, axis=-1)
            o = torch.einsum('bhqk,bhke->bhqe', p, v)
            o = torch.einsum('bhte,hed->btd', o, Wo)
            mem = o[:, :M, :].clone()
            outs.append(o[:, M:, :])
        return torch.concatenate(outs, axis=1)

    def _B_ref(x, w1, w2):
        h = torch.einsum('bsd,df->bsf', x, w1)
        zero = torch.zeros_like(h)
        h = torch.maximum(h, zero)
        return torch.einsum('bsf,fd->bsd', h, w2)
    x = A_x
    mod = (_silu(c) @ w_mod).reshape(c.shape[0], 6, 1, -1)
    sa, ca, ga, sb, cb, gb = (mod[:, 0].clone(), mod[:, 1].clone(), mod[:, 2].clone(), mod[:, 3].clone(), mod[:, 4].clone(), mod[:, 5].clone())
    h = _layernorm(x, axis=-1) * (1 + ca) + sa
    x = x + ga * _A_ref(h, A_mem0, A_Wq, A_Wk, A_Wv, A_Wo, A_seg_len)
    h = _layernorm(x, axis=-1) * (1 + cb) + sb
    x = x + gb * _B_ref(h, B_w1, B_w2)
    return x
```

```asm
; @launch grid=(256,1,1) block=(256,1,1) lds=160768
.amdgcn_target "amdgcn-amd-amdhsa--gfx950"
.text
.globl adaLN_cond__memory_aug_recurrent_mem_tr__dense_activation_relu__prompt_kernel
.p2align 8
.type adaLN_cond__memory_aug_recurrent_mem_tr__dense_activation_relu__prompt_kernel,@function
adaLN_cond__memory_aug_recurrent_mem_tr__dense_activation_relu__prompt_kernel:
  s_cmp_ge_u32 s2, 256
  s_cbranch_scc1 L_exit
  v_and_b32 v1, 63, v0
  v_lshrrev_b32 v2, 6, v0
  s_load_dwordx2 s[4:5], s[0:1], 112
  s_load_dwordx2 s[52:53], s[0:1], 104
  v_readfirstlane_b32 s9, v2
  s_waitcnt lgkmcnt(0)
  s_mov_b32 s6, 268435456
  s_mov_b32 s7, 0x20000
  s_mov_b32 s54, 256
  s_mov_b32 s55, 0x20000
  s_getreg_b32 s56, hwreg(HW_REG_XCC_ID, 0, 4)
  s_and_b32 s56, s56, 7
  s_cmp_lg_u32 s9, 0
  s_cbranch_scc1 L_tk_wait
  s_mov_b64 exec, 1
  s_lshl_b32 s57, s56, 2
  s_add_u32 s57, s57, 32
  v_mov_b32 v3, 1
  v_mov_b32 v4, s57
  buffer_atomic_add v3, v4, s[52:55], 0 offen sc0 sc1
  s_waitcnt vmcnt(0)
  v_readfirstlane_b32 s58, v3
  s_nop 0
  s_cmp_lt_u32 s58, 32
  s_nop 1
  s_cbranch_scc1 L_tk_done
  v_mov_b32 v3, 1
  v_mov_b32 v4, 64
  buffer_atomic_add v3, v4, s[52:55], 0 offen sc0 sc1
  s_waitcnt vmcnt(0)
  v_readfirstlane_b32 s59, v3
  s_mov_b64 exec, 255
  v_lshlrev_b32 v4, 2, v1
  s_mov_b32 s43, 0
  s_mov_b32 s60, 32
L_tk_poll:
  buffer_load_dword v3, v4, s[52:55], s60 offen sc1
  s_waitcnt vmcnt(0)
  s_mov_b32 s61, 0
  v_readlane_b32 s62, v3, 0
  s_nop 0
  s_add_u32 s61, s61, s62
  v_readlane_b32 s62, v3, 1
  s_nop 0
  s_add_u32 s61, s61, s62
  v_readlane_b32 s62, v3, 2
  s_nop 0
  s_add_u32 s61, s61, s62
  v_readlane_b32 s62, v3, 3
  s_nop 0
  s_add_u32 s61, s61, s62
  v_readlane_b32 s62, v3, 4
  s_nop 0
  s_add_u32 s61, s61, s62
  v_readlane_b32 s62, v3, 5
  s_nop 0
  s_add_u32 s61, s61, s62
  v_readlane_b32 s62, v3, 6
  s_nop 0
  s_add_u32 s61, s61, s62
  v_readlane_b32 s62, v3, 7
  s_nop 0
  s_add_u32 s61, s61, s62
  s_cmp_ge_u32 s61, 256
  s_nop 0
  s_cbranch_scc1 L_tk_all
  s_sleep 4
  s_add_u32 s43, s43, 1
  s_cmp_lt_u32 s43, 400000
  s_cbranch_scc1 L_tk_poll
  s_branch L_bail
L_tk_all:
  s_mov_b32 s56, 0
  s_mov_b32 s58, 0
  v_readlane_b32 s62, v3, 0
  s_nop 0
  s_min_u32 s62, s62, 32
  s_sub_u32 s61, 32, s62
  s_cmp_lt_u32 s59, s61
  s_cbranch_scc0 L_tk_n0
  s_mov_b32 s56, 0
  s_add_u32 s58, s62, s59
  s_branch L_tk_found
L_tk_n0:
  s_sub_u32 s59, s59, s61
  v_readlane_b32 s62, v3, 1
  s_nop 0
  s_min_u32 s62, s62, 32
  s_sub_u32 s61, 32, s62
  s_cmp_lt_u32 s59, s61
  s_cbranch_scc0 L_tk_n1
  s_mov_b32 s56, 1
  s_add_u32 s58, s62, s59
  s_branch L_tk_found
L_tk_n1:
  s_sub_u32 s59, s59, s61
  v_readlane_b32 s62, v3, 2
  s_nop 0
  s_min_u32 s62, s62, 32
  s_sub_u32 s61, 32, s62
  s_cmp_lt_u32 s59, s61
  s_cbranch_scc0 L_tk_n2
  s_mov_b32 s56, 2
  s_add_u32 s58, s62, s59
  s_branch L_tk_found
L_tk_n2:
  s_sub_u32 s59, s59, s61
  v_readlane_b32 s62, v3, 3
  s_nop 0
  s_min_u32 s62, s62, 32
  s_sub_u32 s61, 32, s62
  s_cmp_lt_u32 s59, s61
  s_cbranch_scc0 L_tk_n3
  s_mov_b32 s56, 3
  s_add_u32 s58, s62, s59
  s_branch L_tk_found
L_tk_n3:
  s_sub_u32 s59, s59, s61
  v_readlane_b32 s62, v3, 4
  s_nop 0
  s_min_u32 s62, s62, 32
  s_sub_u32 s61, 32, s62
  s_cmp_lt_u32 s59, s61
  s_cbranch_scc0 L_tk_n4
  s_mov_b32 s56, 4
  s_add_u32 s58, s62, s59
  s_branch L_tk_found
L_tk_n4:
  s_sub_u32 s59, s59, s61
  v_readlane_b32 s62, v3, 5
  s_nop 0
  s_min_u32 s62, s62, 32
  s_sub_u32 s61, 32, s62
  s_cmp_lt_u32 s59, s61
  s_cbranch_scc0 L_tk_n5
  s_mov_b32 s56, 5
  s_add_u32 s58, s62, s59
  s_branch L_tk_found
L_tk_n5:
  s_sub_u32 s59, s59, s61
  v_readlane_b32 s62, v3, 6
  s_nop 0
  s_min_u32 s62, s62, 32
  s_sub_u32 s61, 32, s62
  s_cmp_lt_u32 s59, s61
  s_cbranch_scc0 L_tk_n6
  s_mov_b32 s56, 6
  s_add_u32 s58, s62, s59
  s_branch L_tk_found
L_tk_n6:
  s_sub_u32 s59, s59, s61
  v_readlane_b32 s62, v3, 7
  s_nop 0
  s_min_u32 s62, s62, 32
  s_sub_u32 s61, 32, s62
  s_cmp_lt_u32 s59, s61
  s_cbranch_scc0 L_tk_n7
  s_mov_b32 s56, 7
  s_add_u32 s58, s62, s59
  s_branch L_tk_found
L_tk_n7:
  s_sub_u32 s59, s59, s61
L_tk_found:
  s_mov_b64 exec, 1
  s_lshl_b32 s57, s56, 2
  s_add_u32 s57, s57, 96
  v_mov_b32 v3, 1
  v_mov_b32 v4, s57
  buffer_store_dword v3, v4, s[52:55], 0 offen sc1
  s_waitcnt vmcnt(0)
L_tk_done:
  s_lshl_b32 s57, s56, 5
  s_add_u32 s57, s57, s58
  v_mov_b32 v3, s57
  v_mov_b32 v4, 0
  ds_write_b32 v4, v3
  s_waitcnt lgkmcnt(0)
  s_mov_b64 exec, -1
L_tk_wait:
  s_barrier
  v_mov_b32 v4, 0
  ds_read_b32 v3, v4
  s_waitcnt lgkmcnt(0)
  v_readfirstlane_b32 s57, v3
  s_nop 0
  s_lshr_b32 s11, s57, 5
  s_and_b32 s14, s57, 31
  s_barrier
  s_cmp_eq_u32 s11, 0
  s_cbranch_scc1 L_role_c
  s_cmp_le_u32 s11, 3
  s_cbranch_scc1 L_role_a
  s_cmp_le_u32 s11, 5
  s_cbranch_scc1 L_role_f
  s_sub_u32 s16, s11, 6
  s_cmp_ge_u32 s14, 24
  s_cbranch_scc1 L_p_spare
  s_cmp_ge_u32 s14, 16
  s_cbranch_scc1 L_p_q
  s_lshl_b32 s20, s16, 4
  s_add_u32 s20, s20, s14
  s_load_dwordx2 s[48:49], s[0:1], 24
  s_waitcnt lgkmcnt(0)
  s_mov_b32 s50, 4194304
  s_mov_b32 s51, 0x20000
  v_and_b32 v16, 15, v1
  v_lshrrev_b32 v17, 4, v1
  v_lshlrev_b32 v18, 16, v17
  v_lshlrev_b32 v19, 2, v16
  v_add_u32 v18, v18, v19
  s_lshl_b32 s56, s20, 8
  s_lshl_b32 s57, s9, 6
  s_add_u32 s56, s56, s57
  v_add_u32 v18, s56, v18
  s_mov_b32 s70, 0x05040100
  s_mov_b32 s71, 0x07060302
  s_mov_b32 s58, 0
  buffer_load_dword v24, v18, s[48:51], s58 offen
  s_mov_b32 s59, 8192
  buffer_load_dword v25, v18, s[48:51], s59 offen
  s_mov_b32 s60, 16384
  buffer_load_dword v26, v18, s[48:51], s60 offen
  s_mov_b32 s61, 24576
  buffer_load_dword v27, v18, s[48:51], s61 offen
  s_mov_b32 s58, 32768
  buffer_load_dword v28, v18, s[48:51], s58 offen
  s_mov_b32 s59, 40960
  buffer_load_dword v29, v18, s[48:51], s59 offen
  s_mov_b32 s60, 49152
  buffer_load_dword v30, v18, s[48:51], s60 offen
  s_mov_b32 s61, 57344
  buffer_load_dword v31, v18, s[48:51], s61 offen
  s_mov_b32 s58, 262144
  buffer_load_dword v32, v18, s[48:51], s58 offen
  s_mov_b32 s59, 270336
  buffer_load_dword v33, v18, s[48:51], s59 offen
  s_mov_b32 s60, 278528
  buffer_load_dword v34, v18, s[48:51], s60 offen
  s_mov_b32 s61, 286720
  buffer_load_dword v35, v18, s[48:51], s61 offen
  s_mov_b32 s58, 294912
  buffer_load_dword v36, v18, s[48:51], s58 offen
  s_mov_b32 s59, 303104
  buffer_load_dword v37, v18, s[48:51], s59 offen
  s_mov_b32 s60, 311296
  buffer_load_dword v38, v18, s[48:51], s60 offen
  s_mov_b32 s61, 319488
  buffer_load_dword v39, v18, s[48:51], s61 offen
  s_mov_b32 s58, 524288
  buffer_load_dword v40, v18, s[48:51], s58 offen
  s_mov_b32 s59, 532480
  buffer_load_dword v41, v18, s[48:51], s59 offen
  s_mov_b32 s60, 540672
  buffer_load_dword v42, v18, s[48:51], s60 offen
  s_mov_b32 s61, 548864
  buffer_load_dword v43, v18, s[48:51], s61 offen
  s_mov_b32 s58, 557056
  buffer_load_dword v44, v18, s[48:51], s58 offen
  s_mov_b32 s59, 565248
  buffer_load_dword v45, v18, s[48:51], s59 offen
  s_mov_b32 s60, 573440
  buffer_load_dword v46, v18, s[48:51], s60 offen
  s_mov_b32 s61, 581632
  buffer_load_dword v47, v18, s[48:51], s61 offen
  s_mov_b32 s58, 786432
  buffer_load_dword v48, v18, s[48:51], s58 offen
  s_mov_b32 s59, 794624
  buffer_load_dword v49, v18, s[48:51], s59 offen
  s_mov_b32 s60, 802816
  buffer_load_dword v50, v18, s[48:51], s60 offen
  s_mov_b32 s61, 811008
  buffer_load_dword v51, v18, s[48:51], s61 offen
  s_mov_b32 s58, 819200
  buffer_load_dword v52, v18, s[48:51], s58 offen
  s_mov_b32 s59, 827392
  buffer_load_dword v53, v18, s[48:51], s59 offen
  s_mov_b32 s60, 835584
  buffer_load_dword v54, v18, s[48:51], s60 offen
  s_mov_b32 s61, 843776
  buffer_load_dword v55, v18, s[48:51], s61 offen
  s_mov_b32 s58, 1048576
  buffer_load_dword v56, v18, s[48:51], s58 offen
  s_mov_b32 s59, 1056768
  buffer_load_dword v57, v18, s[48:51], s59 offen
  s_mov_b32 s60, 1064960
  buffer_load_dword v58, v18, s[48:51], s60 offen
  s_mov_b32 s61, 1073152
  buffer_load_dword v59, v18, s[48:51], s61 offen
  s_mov_b32 s58, 1081344
  buffer_load_dword v60, v18, s[48:51], s58 offen
  s_mov_b32 s59, 1089536
  buffer_load_dword v61, v18, s[48:51], s59 offen
  s_mov_b32 s60, 1097728
  buffer_load_dword v62, v18, s[48:51], s60 offen
  s_mov_b32 s61, 1105920
  buffer_load_dword v63, v18, s[48:51], s61 offen
  s_mov_b32 s58, 1310720
  buffer_load_dword v64, v18, s[48:51], s58 offen
  s_mov_b32 s59, 1318912
  buffer_load_dword v65, v18, s[48:51], s59 offen
  s_mov_b32 s60, 1327104
  buffer_load_dword v66, v18, s[48:51], s60 offen
  s_mov_b32 s61, 1335296
  buffer_load_dword v67, v18, s[48:51], s61 offen
  s_mov_b32 s58, 1343488
  buffer_load_dword v68, v18, s[48:51], s58 offen
  s_mov_b32 s59, 1351680
  buffer_load_dword v69, v18, s[48:51], s59 offen
  s_mov_b32 s60, 1359872
  buffer_load_dword v70, v18, s[48:51], s60 offen
  s_mov_b32 s61, 1368064
  buffer_load_dword v71, v18, s[48:51], s61 offen
  s_mov_b32 s58, 1572864
  buffer_load_dword v72, v18, s[48:51], s58 offen
  s_mov_b32 s59, 1581056
  buffer_load_dword v73, v18, s[48:51], s59 offen
  s_mov_b32 s60, 1589248
  buffer_load_dword v74, v18, s[48:51], s60 offen
  s_mov_b32 s61, 1597440
  buffer_load_dword v75, v18, s[48:51], s61 offen
  s_mov_b32 s58, 1605632
  buffer_load_dword v76, v18, s[48:51], s58 offen
  s_mov_b32 s59, 1613824
  buffer_load_dword v77, v18, s[48:51], s59 offen
  s_mov_b32 s60, 1622016
  buffer_load_dword v78, v18, s[48:51], s60 offen
  s_mov_b32 s61, 1630208
  buffer_load_dword v79, v18, s[48:51], s61 offen
  s_mov_b32 s58, 1835008
  buffer_load_dword v80, v18, s[48:51], s58 offen
  s_mov_b32 s59, 1843200
  buffer_load_dword v81, v18, s[48:51], s59 offen
  s_mov_b32 s60, 1851392
  buffer_load_dword v82, v18, s[48:51], s60 offen
  s_mov_b32 s61, 1859584
  buffer_load_dword v83, v18, s[48:51], s61 offen
  s_mov_b32 s58, 1867776
  buffer_load_dword v84, v18, s[48:51], s58 offen
  s_mov_b32 s59, 1875968
  buffer_load_dword v85, v18, s[48:51], s59 offen
  s_mov_b32 s60, 1884160
  buffer_load_dword v86, v18, s[48:51], s60 offen
  s_mov_b32 s61, 1892352
  buffer_load_dword v87, v18, s[48:51], s61 offen
  s_mov_b32 s58, 2097152
  buffer_load_dword v88, v18, s[48:51], s58 offen
  s_mov_b32 s59, 2105344
  buffer_load_dword v89, v18, s[48:51], s59 offen
  s_mov_b32 s60, 2113536
  buffer_load_dword v90, v18, s[48:51], s60 offen
  s_mov_b32 s61, 2121728
  buffer_load_dword v91, v18, s[48:51], s61 offen
  s_mov_b32 s58, 2129920
  buffer_load_dword v92, v18, s[48:51], s58 offen
  s_mov_b32 s59, 2138112
  buffer_load_dword v93, v18, s[48:51], s59 offen
  s_mov_b32 s60, 2146304
  buffer_load_dword v94, v18, s[48:51], s60 offen
  s_mov_b32 s61, 2154496
  buffer_load_dword v95, v18, s[48:51], s61 offen
  s_mov_b32 s58, 2359296
  buffer_load_dword v96, v18, s[48:51], s58 offen
  s_mov_b32 s59, 2367488
  buffer_load_dword v97, v18, s[48:51], s59 offen
  s_mov_b32 s60, 2375680
  buffer_load_dword v98, v18, s[48:51], s60 offen
  s_mov_b32 s61, 2383872
  buffer_load_dword v99, v18, s[48:51], s61 offen
  s_mov_b32 s58, 2392064
  buffer_load_dword v100, v18, s[48:51], s58 offen
  s_mov_b32 s59, 2400256
  buffer_load_dword v101, v18, s[48:51], s59 offen
  s_mov_b32 s60, 2408448
  buffer_load_dword v102, v18, s[48:51], s60 offen
  s_mov_b32 s61, 2416640
  buffer_load_dword v103, v18, s[48:51], s61 offen
  s_mov_b32 s58, 2621440
  buffer_load_dword v104, v18, s[48:51], s58 offen
  s_mov_b32 s59, 2629632
  buffer_load_dword v105, v18, s[48:51], s59 offen
  s_mov_b32 s60, 2637824
  buffer_load_dword v106, v18, s[48:51], s60 offen
  s_mov_b32 s61, 2646016
  buffer_load_dword v107, v18, s[48:51], s61 offen
  s_mov_b32 s58, 2654208
  buffer_load_dword v108, v18, s[48:51], s58 offen
  s_mov_b32 s59, 2662400
  buffer_load_dword v109, v18, s[48:51], s59 offen
  s_mov_b32 s60, 2670592
  buffer_load_dword v110, v18, s[48:51], s60 offen
  s_mov_b32 s61, 2678784
  buffer_load_dword v111, v18, s[48:51], s61 offen
  s_mov_b32 s58, 2883584
  buffer_load_dword v112, v18, s[48:51], s58 offen
  s_mov_b32 s59, 2891776
  buffer_load_dword v113, v18, s[48:51], s59 offen
  s_mov_b32 s60, 2899968
  buffer_load_dword v114, v18, s[48:51], s60 offen
  s_mov_b32 s61, 2908160
  buffer_load_dword v115, v18, s[48:51], s61 offen
  s_mov_b32 s58, 2916352
  buffer_load_dword v116, v18, s[48:51], s58 offen
  s_mov_b32 s59, 2924544
  buffer_load_dword v117, v18, s[48:51], s59 offen
  s_mov_b32 s60, 2932736
  buffer_load_dword v118, v18, s[48:51], s60 offen
  s_mov_b32 s61, 2940928
  buffer_load_dword v119, v18, s[48:51], s61 offen
  s_waitcnt vmcnt(63)
  v_perm_b32 v120, v25, v24, s70
  v_accvgpr_write_b32 a0, v120
  s_waitcnt vmcnt(63)
  v_perm_b32 v122, v27, v26, s70
  v_accvgpr_write_b32 a1, v122
  s_waitcnt vmcnt(63)
  v_perm_b32 v120, v29, v28, s70
  v_accvgpr_write_b32 a2, v120
  s_waitcnt vmcnt(63)
  v_perm_b32 v122, v31, v30, s70
  v_accvgpr_write_b32 a3, v122
  v_perm_b32 v121, v25, v24, s71
  v_accvgpr_write_b32 a64, v121
  v_perm_b32 v123, v27, v26, s71
  v_accvgpr_write_b32 a65, v123
  v_perm_b32 v121, v29, v28, s71
  v_accvgpr_write_b32 a66, v121
  v_perm_b32 v123, v31, v30, s71
  v_accvgpr_write_b32 a67, v123
  s_waitcnt vmcnt(63)
  v_perm_b32 v120, v33, v32, s70
  v_accvgpr_write_b32 a4, v120
  s_waitcnt vmcnt(63)
  v_perm_b32 v122, v35, v34, s70
  v_accvgpr_write_b32 a5, v122
  s_waitcnt vmcnt(63)
  v_perm_b32 v120, v37, v36, s70
  v_accvgpr_write_b32 a6, v120
  s_waitcnt vmcnt(63)
  v_perm_b32 v122, v39, v38, s70
  v_accvgpr_write_b32 a7, v122
  v_perm_b32 v121, v33, v32, s71
  v_accvgpr_write_b32 a68, v121
  v_perm_b32 v123, v35, v34, s71
  v_accvgpr_write_b32 a69, v123
  v_perm_b32 v121, v37, v36, s71
  v_accvgpr_write_b32 a70, v121
  v_perm_b32 v123, v39, v38, s71
  v_accvgpr_write_b32 a71, v123
  s_mov_b32 s58, 3145728
  buffer_load_dword v24, v18, s[48:51], s58 offen
  s_mov_b32 s59, 3153920
  buffer_load_dword v25, v18, s[48:51], s59 offen
  s_mov_b32 s60, 3162112
  buffer_load_dword v26, v18, s[48:51], s60 offen
  s_mov_b32 s61, 3170304
  buffer_load_dword v27, v18, s[48:51], s61 offen
  s_mov_b32 s58, 3178496
  buffer_load_dword v28, v18, s[48:51], s58 offen
  s_mov_b32 s59, 3186688
  buffer_load_dword v29, v18, s[48:51], s59 offen
  s_mov_b32 s60, 3194880
  buffer_load_dword v30, v18, s[48:51], s60 offen
  s_mov_b32 s61, 3203072
  buffer_load_dword v31, v18, s[48:51], s61 offen
  s_mov_b32 s58, 3407872
  buffer_load_dword v32, v18, s[48:51], s58 offen
  s_mov_b32 s59, 3416064
  buffer_load_dword v33, v18, s[48:51], s59 offen
  s_mov_b32 s60, 3424256
  buffer_load_dword v34, v18, s[48:51], s60 offen
  s_mov_b32 s61, 3432448
  buffer_load_dword v35, v18, s[48:51], s61 offen
  s_mov_b32 s58, 3440640
  buffer_load_dword v36, v18, s[48:51], s58 offen
  s_mov_b32 s59, 3448832
  buffer_load_dword v37, v18, s[48:51], s59 offen
  s_mov_b32 s60, 3457024
  buffer_load_dword v38, v18, s[48:51], s60 offen
  s_mov_b32 s61, 3465216
  buffer_load_dword v39, v18, s[48:51], s61 offen
  s_waitcnt vmcnt(63)
  v_perm_b32 v120, v41, v40, s70
  v_accvgpr_write_b32 a8, v120
  s_waitcnt vmcnt(63)
  v_perm_b32 v122, v43, v42, s70
  v_accvgpr_write_b32 a9, v122
  s_waitcnt vmcnt(63)
  v_perm_b32 v120, v45, v44, s70
  v_accvgpr_write_b32 a10, v120
  s_waitcnt vmcnt(63)
  v_perm_b32 v122, v47, v46, s70
  v_accvgpr_write_b32 a11, v122
  v_perm_b32 v121, v41, v40, s71
  v_accvgpr_write_b32 a72, v121
  v_perm_b32 v123, v43, v42, s71
  v_accvgpr_write_b32 a73, v123
  v_perm_b32 v121, v45, v44, s71
  v_accvgpr_write_b32 a74, v121
  v_perm_b32 v123, v47, v46, s71
  v_accvgpr_write_b32 a75, v123
  s_waitcnt vmcnt(63)
  v_perm_b32 v120, v49, v48, s70
  v_accvgpr_write_b32 a12, v120
  s_waitcnt vmcnt(63)
  v_perm_b32 v122, v51, v50, s70
  v_accvgpr_write_b32 a13, v122
  s_waitcnt vmcnt(63)
  v_perm_b32 v120, v53, v52, s70
  v_accvgpr_write_b32 a14, v120
  s_waitcnt vmcnt(63)
  v_perm_b32 v122, v55, v54, s70
  v_accvgpr_write_b32 a15, v122
  v_perm_b32 v121, v49, v48, s71
  v_accvgpr_write_b32 a76, v121
  v_perm_b32 v123, v51, v50, s71
  v_accvgpr_write_b32 a77, v123
  v_perm_b32 v121, v53, v52, s71
  v_accvgpr_write_b32 a78, v121
  v_perm_b32 v123, v55, v54, s71
  v_accvgpr_write_b32 a79, v123
  s_mov_b32 s58, 3670016
  buffer_load_dword v40, v18, s[48:51], s58 offen
  s_mov_b32 s59, 3678208
  buffer_load_dword v41, v18, s[48:51], s59 offen
  s_mov_b32 s60, 3686400
  buffer_load_dword v42, v18, s[48:51], s60 offen
  s_mov_b32 s61, 3694592
  buffer_load_dword v43, v18, s[48:51], s61 offen
  s_mov_b32 s58, 3702784
  buffer_load_dword v44, v18, s[48:51], s58 offen
  s_mov_b32 s59, 3710976
  buffer_load_dword v45, v18, s[48:51], s59 offen
  s_mov_b32 s60, 3719168
  buffer_load_dword v46, v18, s[48:51], s60 offen
  s_mov_b32 s61, 3727360
  buffer_load_dword v47, v18, s[48:51], s61 offen
  s_mov_b32 s58, 3932160
  buffer_load_dword v48, v18, s[48:51], s58 offen
  s_mov_b32 s59, 3940352
  buffer_load_dword v49, v18, s[48:51], s59 offen
  s_mov_b32 s60, 3948544
  buffer_load_dword v50, v18, s[48:51], s60 offen
  s_mov_b32 s61, 3956736
  buffer_load_dword v51, v18, s[48:51], s61 offen
  s_mov_b32 s58, 3964928
  buffer_load_dword v52, v18, s[48:51], s58 offen
  s_mov_b32 s59, 3973120
  buffer_load_dword v53, v18, s[48:51], s59 offen
  s_mov_b32 s60, 3981312
  buffer_load_dword v54, v18, s[48:51], s60 offen
  s_mov_b32 s61, 3989504
  buffer_load_dword v55, v18, s[48:51], s61 offen
  s_waitcnt vmcnt(63)
  v_perm_b32 v120, v57, v56, s70
  v_accvgpr_write_b32 a16, v120
  s_waitcnt vmcnt(63)
  v_perm_b32 v122, v59, v58, s70
  v_accvgpr_write_b32 a17, v122
  s_waitcnt vmcnt(63)
  v_perm_b32 v120, v61, v60, s70
  v_accvgpr_write_b32 a18, v120
  s_waitcnt vmcnt(63)
  v_perm_b32 v122, v63, v62, s70
  v_accvgpr_write_b32 a19, v122
  v_perm_b32 v121, v57, v56, s71
  v_accvgpr_write_b32 a80, v121
  v_perm_b32 v123, v59, v58, s71
  v_accvgpr_write_b32 a81, v123
  v_perm_b32 v121, v61, v60, s71
  v_accvgpr_write_b32 a82, v121
  v_perm_b32 v123, v63, v62, s71
  v_accvgpr_write_b32 a83, v123
  s_waitcnt vmcnt(63)
  v_perm_b32 v120, v65, v64, s70
  v_accvgpr_write_b32 a20, v120
  s_waitcnt vmcnt(63)
  v_perm_b32 v122, v67, v66, s70
  v_accvgpr_write_b32 a21, v122
  s_waitcnt vmcnt(63)
  v_perm_b32 v120, v69, v68, s70
  v_accvgpr_write_b32 a22, v120
  s_waitcnt vmcnt(63)
  v_perm_b32 v122, v71, v70, s70
  v_accvgpr_write_b32 a23, v122
  v_perm_b32 v121, v65, v64, s71
  v_accvgpr_write_b32 a84, v121
  v_perm_b32 v123, v67, v66, s71
  v_accvgpr_write_b32 a85, v123
  v_perm_b32 v121, v69, v68, s71
  v_accvgpr_write_b32 a86, v121
  v_perm_b32 v123, v71, v70, s71
  v_accvgpr_write_b32 a87, v123
  s_waitcnt vmcnt(63)
  v_perm_b32 v120, v73, v72, s70
  v_accvgpr_write_b32 a24, v120
  s_waitcnt vmcnt(63)
  v_perm_b32 v122, v75, v74, s70
  v_accvgpr_write_b32 a25, v122
  s_waitcnt vmcnt(63)
  v_perm_b32 v120, v77, v76, s70
  v_accvgpr_write_b32 a26, v120
  s_waitcnt vmcnt(63)
  v_perm_b32 v122, v79, v78, s70
  v_accvgpr_write_b32 a27, v122
  v_perm_b32 v121, v73, v72, s71
  v_accvgpr_write_b32 a88, v121
  v_perm_b32 v123, v75, v74, s71
  v_accvgpr_write_b32 a89, v123
  v_perm_b32 v121, v77, v76, s71
  v_accvgpr_write_b32 a90, v121
  v_perm_b32 v123, v79, v78, s71
  v_accvgpr_write_b32 a91, v123
  s_waitcnt vmcnt(63)
  v_perm_b32 v120, v81, v80, s70
  v_accvgpr_write_b32 a28, v120
  s_waitcnt vmcnt(63)
  v_perm_b32 v122, v83, v82, s70
  v_accvgpr_write_b32 a29, v122
  s_waitcnt vmcnt(63)
  v_perm_b32 v120, v85, v84, s70
  v_accvgpr_write_b32 a30, v120
  s_waitcnt vmcnt(63)
  v_perm_b32 v122, v87, v86, s70
  v_accvgpr_write_b32 a31, v122
  v_perm_b32 v121, v81, v80, s71
  v_accvgpr_write_b32 a92, v121
  v_perm_b32 v123, v83, v82, s71
  v_accvgpr_write_b32 a93, v123
  v_perm_b32 v121, v85, v84, s71
  v_accvgpr_write_b32 a94, v121
  v_perm_b32 v123, v87, v86, s71
  v_accvgpr_write_b32 a95, v123
  s_waitcnt vmcnt(62)
  v_perm_b32 v120, v89, v88, s70
  v_accvgpr_write_b32 a32, v120
  s_waitcnt vmcnt(60)
  v_perm_b32 v122, v91, v90, s70
  v_accvgpr_write_b32 a33, v122
  s_waitcnt vmcnt(58)
  v_perm_b32 v120, v93, v92, s70
  v_accvgpr_write_b32 a34, v120
  s_waitcnt vmcnt(56)
  v_perm_b32 v122, v95, v94, s70
  v_accvgpr_write_b32 a35, v122
  v_perm_b32 v121, v89, v88, s71
  v_accvgpr_write_b32 a96, v121
  v_perm_b32 v123, v91, v90, s71
  v_accvgpr_write_b32 a97, v123
  v_perm_b32 v121, v93, v92, s71
  v_accvgpr_write_b32 a98, v121
  v_perm_b32 v123, v95, v94, s71
  v_accvgpr_write_b32 a99, v123
  s_waitcnt vmcnt(54)
  v_perm_b32 v120, v97, v96, s70
  v_accvgpr_write_b32 a36, v120
  s_waitcnt vmcnt(52)
  v_perm_b32 v122, v99, v98, s70
  v_accvgpr_write_b32 a37, v122
  s_waitcnt vmcnt(50)
  v_perm_b32 v120, v101, v100, s70
  v_accvgpr_write_b32 a38, v120
  s_waitcnt vmcnt(48)
  v_perm_b32 v122, v103, v102, s70
  v_accvgpr_write_b32 a39, v122
  v_perm_b32 v121, v97, v96, s71
  v_accvgpr_write_b32 a100, v121
  v_perm_b32 v123, v99, v98, s71
  v_accvgpr_write_b32 a101, v123
  v_perm_b32 v121, v101, v100, s71
  v_accvgpr_write_b32 a102, v121
  v_perm_b32 v123, v103, v102, s71
  v_accvgpr_write_b32 a103, v123
  s_waitcnt vmcnt(46)
  v_perm_b32 v120, v105, v104, s70
  v_accvgpr_write_b32 a40, v120
  s_waitcnt vmcnt(44)
  v_perm_b32 v122, v107, v106, s70
  v_accvgpr_write_b32 a41, v122
  s_waitcnt vmcnt(42)
  v_perm_b32 v120, v109, v108, s70
  v_accvgpr_write_b32 a42, v120
  s_waitcnt vmcnt(40)
  v_perm_b32 v122, v111, v110, s70
  v_accvgpr_write_b32 a43, v122
  v_perm_b32 v121, v105, v104, s71
  v_accvgpr_write_b32 a104, v121
  v_perm_b32 v123, v107, v106, s71
  v_accvgpr_write_b32 a105, v123
  v_perm_b32 v121, v109, v108, s71
  v_accvgpr_write_b32 a106, v121
  v_perm_b32 v123, v111, v110, s71
  v_accvgpr_write_b32 a107, v123
  s_waitcnt vmcnt(38)
  v_perm_b32 v120, v113, v112, s70
  v_accvgpr_write_b32 a44, v120
  s_waitcnt vmcnt(36)
  v_perm_b32 v122, v115, v114, s70
  v_accvgpr_write_b32 a45, v122
  s_waitcnt vmcnt(34)
  v_perm_b32 v120, v117, v116, s70
  v_accvgpr_write_b32 a46, v120
  s_waitcnt vmcnt(32)
  v_perm_b32 v122, v119, v118, s70
  v_accvgpr_write_b32 a47, v122
  v_perm_b32 v121, v113, v112, s71
  v_accvgpr_write_b32 a108, v121
  v_perm_b32 v123, v115, v114, s71
  v_accvgpr_write_b32 a109, v123
  v_perm_b32 v121, v117, v116, s71
  v_accvgpr_write_b32 a110, v121
  v_perm_b32 v123, v119, v118, s71
  v_accvgpr_write_b32 a111, v123
  s_waitcnt vmcnt(30)
  v_perm_b32 v120, v25, v24, s70
  v_accvgpr_write_b32 a48, v120
  s_waitcnt vmcnt(28)
  v_perm_b32 v122, v27, v26, s70
  v_accvgpr_write_b32 a49, v122
  s_waitcnt vmcnt(26)
  v_perm_b32 v120, v29, v28, s70
  v_accvgpr_write_b32 a50, v120
  s_waitcnt vmcnt(24)
  v_perm_b32 v122, v31, v30, s70
  v_accvgpr_write_b32 a51, v122
  v_perm_b32 v121, v25, v24, s71
  v_accvgpr_write_b32 a112, v121
  v_perm_b32 v123, v27, v26, s71
  v_accvgpr_write_b32 a113, v123
  v_perm_b32 v121, v29, v28, s71
  v_accvgpr_write_b32 a114, v121
  v_perm_b32 v123, v31, v30, s71
  v_accvgpr_write_b32 a115, v123
  s_waitcnt vmcnt(22)
  v_perm_b32 v120, v33, v32, s70
  v_accvgpr_write_b32 a52, v120
  s_waitcnt vmcnt(20)
  v_perm_b32 v122, v35, v34, s70
  v_accvgpr_write_b32 a53, v122
  s_waitcnt vmcnt(18)
  v_perm_b32 v120, v37, v36, s70
  v_accvgpr_write_b32 a54, v120
  s_waitcnt vmcnt(16)
  v_perm_b32 v122, v39, v38, s70
  v_accvgpr_write_b32 a55, v122
  v_perm_b32 v121, v33, v32, s71
  v_accvgpr_write_b32 a116, v121
  v_perm_b32 v123, v35, v34, s71
  v_accvgpr_write_b32 a117, v123
  v_perm_b32 v121, v37, v36, s71
  v_accvgpr_write_b32 a118, v121
  v_perm_b32 v123, v39, v38, s71
  v_accvgpr_write_b32 a119, v123
  s_waitcnt vmcnt(14)
  v_perm_b32 v120, v41, v40, s70
  v_accvgpr_write_b32 a56, v120
  s_waitcnt vmcnt(12)
  v_perm_b32 v122, v43, v42, s70
  v_accvgpr_write_b32 a57, v122
  s_waitcnt vmcnt(10)
  v_perm_b32 v120, v45, v44, s70
  v_accvgpr_write_b32 a58, v120
  s_waitcnt vmcnt(8)
  v_perm_b32 v122, v47, v46, s70
  v_accvgpr_write_b32 a59, v122
  v_perm_b32 v121, v41, v40, s71
  v_accvgpr_write_b32 a120, v121
  v_perm_b32 v123, v43, v42, s71
  v_accvgpr_write_b32 a121, v123
  v_perm_b32 v121, v45, v44, s71
  v_accvgpr_write_b32 a122, v121
  v_perm_b32 v123, v47, v46, s71
  v_accvgpr_write_b32 a123, v123
  s_waitcnt vmcnt(6)
  v_perm_b32 v120, v49, v48, s70
  v_accvgpr_write_b32 a60, v120
  s_waitcnt vmcnt(4)
  v_perm_b32 v122, v51, v50, s70
  v_accvgpr_write_b32 a61, v122
  s_waitcnt vmcnt(2)
  v_perm_b32 v120, v53, v52, s70
  v_accvgpr_write_b32 a62, v120
  s_waitcnt vmcnt(0)
  v_perm_b32 v122, v55, v54, s70
  v_accvgpr_write_b32 a63, v122
  v_perm_b32 v121, v49, v48, s71
  v_accvgpr_write_b32 a124, v121
  v_perm_b32 v123, v51, v50, s71
  v_accvgpr_write_b32 a125, v123
  v_perm_b32 v121, v53, v52, s71
  v_accvgpr_write_b32 a126, v121
  v_perm_b32 v123, v55, v54, s71
  v_accvgpr_write_b32 a127, v123
  s_load_dwordx2 s[48:49], s[0:1], 32
  s_waitcnt lgkmcnt(0)
  s_mov_b32 s50, 4194304
  s_mov_b32 s51, 0x20000
  v_and_b32 v16, 15, v1
  v_lshrrev_b32 v17, 4, v1
  v_lshlrev_b32 v18, 16, v17
  v_lshlrev_b32 v19, 2, v16
  v_add_u32 v18, v18, v19
  s_lshl_b32 s56, s20, 8
  s_lshl_b32 s57, s9, 6
  s_add_u32 s56, s56, s57
  v_add_u32 v18, s56, v18
  s_mov_b32 s70, 0x05040100
  s_mov_b32 s71, 0x07060302
  s_mov_b32 s58, 0
  buffer_load_dword v24, v18, s[48:51], s58 offen
  s_mov_b32 s59, 8192
  buffer_load_dword v25, v18, s[48:51], s59 offen
  s_mov_b32 s60, 16384
  buffer_load_dword v26, v18, s[48:51], s60 offen
  s_mov_b32 s61, 24576
  buffer_load_dword v27, v18, s[48:51], s61 offen
  s_mov_b32 s58, 32768
  buffer_load_dword v28, v18, s[48:51], s58 offen
  s_mov_b32 s59, 40960
  buffer_load_dword v29, v18, s[48:51], s59 offen
  s_mov_b32 s60, 49152
  buffer_load_dword v30, v18, s[48:51], s60 offen
  s_mov_b32 s61, 57344
  buffer_load_dword v31, v18, s[48:51], s61 offen
  s_mov_b32 s58, 262144
  buffer_load_dword v32, v18, s[48:51], s58 offen
  s_mov_b32 s59, 270336
  buffer_load_dword v33, v18, s[48:51], s59 offen
  s_mov_b32 s60, 278528
  buffer_load_dword v34, v18, s[48:51], s60 offen
  s_mov_b32 s61, 286720
  buffer_load_dword v35, v18, s[48:51], s61 offen
  s_mov_b32 s58, 294912
  buffer_load_dword v36, v18, s[48:51], s58 offen
  s_mov_b32 s59, 303104
  buffer_load_dword v37, v18, s[48:51], s59 offen
  s_mov_b32 s60, 311296
  buffer_load_dword v38, v18, s[48:51], s60 offen
  s_mov_b32 s61, 319488
  buffer_load_dword v39, v18, s[48:51], s61 offen
  s_mov_b32 s58, 524288
  buffer_load_dword v40, v18, s[48:51], s58 offen
  s_mov_b32 s59, 532480
  buffer_load_dword v41, v18, s[48:51], s59 offen
  s_mov_b32 s60, 540672
  buffer_load_dword v42, v18, s[48:51], s60 offen
  s_mov_b32 s61, 548864
  buffer_load_dword v43, v18, s[48:51], s61 offen
  s_mov_b32 s58, 557056
  buffer_load_dword v44, v18, s[48:51], s58 offen
  s_mov_b32 s59, 565248
  buffer_load_dword v45, v18, s[48:51], s59 offen
  s_mov_b32 s60, 573440
  buffer_load_dword v46, v18, s[48:51], s60 offen
  s_mov_b32 s61, 581632
  buffer_load_dword v47, v18, s[48:51], s61 offen
  s_mov_b32 s58, 786432
  buffer_load_dword v48, v18, s[48:51], s58 offen
  s_mov_b32 s59, 794624
  buffer_load_dword v49, v18, s[48:51], s59 offen
  s_mov_b32 s60, 802816
  buffer_load_dword v50, v18, s[48:51], s60 offen
  s_mov_b32 s61, 811008
  buffer_load_dword v51, v18, s[48:51], s61 offen
  s_mov_b32 s58, 819200
  buffer_load_dword v52, v18, s[48:51], s58 offen
  s_mov_b32 s59, 827392
  buffer_load_dword v53, v18, s[48:51], s59 offen
  s_mov_b32 s60, 835584
  buffer_load_dword v54, v18, s[48:51], s60 offen
  s_mov_b32 s61, 843776
  buffer_load_dword v55, v18, s[48:51], s61 offen
  s_mov_b32 s58, 1048576
  buffer_load_dword v56, v18, s[48:51], s58 offen
  s_mov_b32 s59, 1056768
  buffer_load_dword v57, v18, s[48:51], s59 offen
  s_mov_b32 s60, 1064960
  buffer_load_dword v58, v18, s[48:51], s60 offen
  s_mov_b32 s61, 1073152
  buffer_load_dword v59, v18, s[48:51], s61 offen
  s_mov_b32 s58, 1081344
  buffer_load_dword v60, v18, s[48:51], s58 offen
  s_mov_b32 s59, 1089536
  buffer_load_dword v61, v18, s[48:51], s59 offen
  s_mov_b32 s60, 1097728
  buffer_load_dword v62, v18, s[48:51], s60 offen
  s_mov_b32 s61, 1105920
  buffer_load_dword v63, v18, s[48:51], s61 offen
  s_mov_b32 s58, 1310720
  buffer_load_dword v64, v18, s[48:51], s58 offen
  s_mov_b32 s59, 1318912
  buffer_load_dword v65, v18, s[48:51], s59 offen
  s_mov_b32 s60, 1327104
  buffer_load_dword v66, v18, s[48:51], s60 offen
  s_mov_b32 s61, 1335296
  buffer_load_dword v67, v18, s[48:51], s61 offen
  s_mov_b32 s58, 1343488
  buffer_load_dword v68, v18, s[48:51], s58 offen
  s_mov_b32 s59, 1351680
  buffer_load_dword v69, v18, s[48:51], s59 offen
  s_mov_b32 s60, 1359872
  buffer_load_dword v70, v18, s[48:51], s60 offen
  s_mov_b32 s61, 1368064
  buffer_load_dword v71, v18, s[48:51], s61 offen
  s_mov_b32 s58, 1572864
  buffer_load_dword v72, v18, s[48:51], s58 offen
  s_mov_b32 s59, 1581056
  buffer_load_dword v73, v18, s[48:51], s59 offen
  s_mov_b32 s60, 1589248
  buffer_load_dword v74, v18, s[48:51], s60 offen
  s_mov_b32 s61, 1597440
  buffer_load_dword v75, v18, s[48:51], s61 offen
  s_mov_b32 s58, 1605632
  buffer_load_dword v76, v18, s[48:51], s58 offen
  s_mov_b32 s59, 1613824
  buffer_load_dword v77, v18, s[48:51], s59 offen
  s_mov_b32 s60, 1622016
  buffer_load_dword v78, v18, s[48:51], s60 offen
  s_mov_b32 s61, 1630208
  buffer_load_dword v79, v18, s[48:51], s61 offen
  s_mov_b32 s58, 1835008
  buffer_load_dword v80, v18, s[48:51], s58 offen
  s_mov_b32 s59, 1843200
  buffer_load_dword v81, v18, s[48:51], s59 offen
  s_mov_b32 s60, 1851392
  buffer_load_dword v82, v18, s[48:51], s60 offen
  s_mov_b32 s61, 1859584
  buffer_load_dword v83, v18, s[48:51], s61 offen
  s_mov_b32 s58, 1867776
  buffer_load_dword v84, v18, s[48:51], s58 offen
  s_mov_b32 s59, 1875968
  buffer_load_dword v85, v18, s[48:51], s59 offen
  s_mov_b32 s60, 1884160
  buffer_load_dword v86, v18, s[48:51], s60 offen
  s_mov_b32 s61, 1892352
  buffer_load_dword v87, v18, s[48:51], s61 offen
  s_mov_b32 s58, 2097152
  buffer_load_dword v88, v18, s[48:51], s58 offen
  s_mov_b32 s59, 2105344
  buffer_load_dword v89, v18, s[48:51], s59 offen
  s_mov_b32 s60, 2113536
  buffer_load_dword v90, v18, s[48:51], s60 offen
  s_mov_b32 s61, 2121728
  buffer_load_dword v91, v18, s[48:51], s61 offen
  s_mov_b32 s58, 2129920
  buffer_load_dword v92, v18, s[48:51], s58 offen
  s_mov_b32 s59, 2138112
  buffer_load_dword v93, v18, s[48:51], s59 offen
  s_mov_b32 s60, 2146304
  buffer_load_dword v94, v18, s[48:51], s60 offen
  s_mov_b32 s61, 2154496
  buffer_load_dword v95, v18, s[48:51], s61 offen
  s_mov_b32 s58, 2359296
  buffer_load_dword v96, v18, s[48:51], s58 offen
  s_mov_b32 s59, 2367488
  buffer_load_dword v97, v18, s[48:51], s59 offen
  s_mov_b32 s60, 2375680
  buffer_load_dword v98, v18, s[48:51], s60 offen
  s_mov_b32 s61, 2383872
  buffer_load_dword v99, v18, s[48:51], s61 offen
  s_mov_b32 s58, 2392064
  buffer_load_dword v100, v18, s[48:51], s58 offen
  s_mov_b32 s59, 2400256
  buffer_load_dword v101, v18, s[48:51], s59 offen
  s_mov_b32 s60, 2408448
  buffer_load_dword v102, v18, s[48:51], s60 offen
  s_mov_b32 s61, 2416640
  buffer_load_dword v103, v18, s[48:51], s61 offen
  s_mov_b32 s58, 2621440
  buffer_load_dword v104, v18, s[48:51], s58 offen
  s_mov_b32 s59, 2629632
  buffer_load_dword v105, v18, s[48:51], s59 offen
  s_mov_b32 s60, 2637824
  buffer_load_dword v106, v18, s[48:51], s60 offen
  s_mov_b32 s61, 2646016
  buffer_load_dword v107, v18, s[48:51], s61 offen
  s_mov_b32 s58, 2654208
  buffer_load_dword v108, v18, s[48:51], s58 offen
  s_mov_b32 s59, 2662400
  buffer_load_dword v109, v18, s[48:51], s59 offen
  s_mov_b32 s60, 2670592
  buffer_load_dword v110, v18, s[48:51], s60 offen
  s_mov_b32 s61, 2678784
  buffer_load_dword v111, v18, s[48:51], s61 offen
  s_mov_b32 s58, 2883584
  buffer_load_dword v112, v18, s[48:51], s58 offen
  s_mov_b32 s59, 2891776
  buffer_load_dword v113, v18, s[48:51], s59 offen
  s_mov_b32 s60, 2899968
  buffer_load_dword v114, v18, s[48:51], s60 offen
  s_mov_b32 s61, 2908160
  buffer_load_dword v115, v18, s[48:51], s61 offen
  s_mov_b32 s58, 2916352
  buffer_load_dword v116, v18, s[48:51], s58 offen
  s_mov_b32 s59, 2924544
  buffer_load_dword v117, v18, s[48:51], s59 offen
  s_mov_b32 s60, 2932736
  buffer_load_dword v118, v18, s[48:51], s60 offen
  s_mov_b32 s61, 2940928
  buffer_load_dword v119, v18, s[48:51], s61 offen
  s_waitcnt vmcnt(63)
  v_perm_b32 v120, v25, v24, s70
  v_accvgpr_write_b32 a128, v120
  s_waitcnt vmcnt(63)
  v_perm_b32 v122, v27, v26, s70
  v_accvgpr_write_b32 a129, v122
  s_waitcnt vmcnt(63)
  v_perm_b32 v120, v29, v28, s70
  v_accvgpr_write_b32 a130, v120
  s_waitcnt vmcnt(63)
  v_perm_b32 v122, v31, v30, s70
  v_accvgpr_write_b32 a131, v122
  v_perm_b32 v121, v25, v24, s71
  v_accvgpr_write_b32 a192, v121
  v_perm_b32 v123, v27, v26, s71
  v_accvgpr_write_b32 a193, v123
  v_perm_b32 v121, v29, v28, s71
  v_accvgpr_write_b32 a194, v121
  v_perm_b32 v123, v31, v30, s71
  v_accvgpr_write_b32 a195, v123
  s_waitcnt vmcnt(63)
  v_perm_b32 v120, v33, v32, s70
  v_accvgpr_write_b32 a132, v120
  s_waitcnt vmcnt(63)
  v_perm_b32 v122, v35, v34, s70
  v_accvgpr_write_b32 a133, v122
  s_waitcnt vmcnt(63)
  v_perm_b32 v120, v37, v36, s70
  v_accvgpr_write_b32 a134, v120
  s_waitcnt vmcnt(63)
  v_perm_b32 v122, v39, v38, s70
  v_accvgpr_write_b32 a135, v122
  v_perm_b32 v121, v33, v32, s71
  v_accvgpr_write_b32 a196, v121
  v_perm_b32 v123, v35, v34, s71
  v_accvgpr_write_b32 a197, v123
  v_perm_b32 v121, v37, v36, s71
  v_accvgpr_write_b32 a198, v121
  v_perm_b32 v123, v39, v38, s71
  v_accvgpr_write_b32 a199, v123
  s_mov_b32 s58, 3145728
  buffer_load_dword v24, v18, s[48:51], s58 offen
  s_mov_b32 s59, 3153920
  buffer_load_dword v25, v18, s[48:51], s59 offen
  s_mov_b32 s60, 3162112
  buffer_load_dword v26, v18, s[48:51], s60 offen
  s_mov_b32 s61, 3170304
  buffer_load_dword v27, v18, s[48:51], s61 offen
  s_mov_b32 s58, 3178496
  buffer_load_dword v28, v18, s[48:51], s58 offen
  s_mov_b32 s59, 3186688
  buffer_load_dword v29, v18, s[48:51], s59 offen
  s_mov_b32 s60, 3194880
  buffer_load_dword v30, v18, s[48:51], s60 offen
  s_mov_b32 s61, 3203072
  buffer_load_dword v31, v18, s[48:51], s61 offen
  s_mov_b32 s58, 3407872
  buffer_load_dword v32, v18, s[48:51], s58 offen
  s_mov_b32 s59, 3416064
  buffer_load_dword v33, v18, s[48:51], s59 offen
  s_mov_b32 s60, 3424256
  buffer_load_dword v34, v18, s[48:51], s60 offen
  s_mov_b32 s61, 3432448
  buffer_load_dword v35, v18, s[48:51], s61 offen
  s_mov_b32 s58, 3440640
  buffer_load_dword v36, v18, s[48:51], s58 offen
  s_mov_b32 s59, 3448832
  buffer_load_dword v37, v18, s[48:51], s59 offen
  s_mov_b32 s60, 3457024
  buffer_load_dword v38, v18, s[48:51], s60 offen
  s_mov_b32 s61, 3465216
  buffer_load_dword v39, v18, s[48:51], s61 offen
  s_waitcnt vmcnt(63)
  v_perm_b32 v120, v41, v40, s70
  v_accvgpr_write_b32 a136, v120
  s_waitcnt vmcnt(63)
  v_perm_b32 v122, v43, v42, s70
  v_accvgpr_write_b32 a137, v122
  s_waitcnt vmcnt(63)
  v_perm_b32 v120, v45, v44, s70
  v_accvgpr_write_b32 a138, v120
  s_waitcnt vmcnt(63)
  v_perm_b32 v122, v47, v46, s70
  v_accvgpr_write_b32 a139, v122
  v_perm_b32 v121, v41, v40, s71
  v_accvgpr_write_b32 a200, v121
  v_perm_b32 v123, v43, v42, s71
  v_accvgpr_write_b32 a201, v123
  v_perm_b32 v121, v45, v44, s71
  v_accvgpr_write_b32 a202, v121
  v_perm_b32 v123, v47, v46, s71
  v_accvgpr_write_b32 a203, v123
  s_waitcnt vmcnt(63)
  v_perm_b32 v120, v49, v48, s70
  v_accvgpr_write_b32 a140, v120
  s_waitcnt vmcnt(63)
  v_perm_b32 v122, v51, v50, s70
  v_accvgpr_write_b32 a141, v122
  s_waitcnt vmcnt(63)
  v_perm_b32 v120, v53, v52, s70
  v_accvgpr_write_b32 a142, v120
  s_waitcnt vmcnt(63)
  v_perm_b32 v122, v55, v54, s70
  v_accvgpr_write_b32 a143, v122
  v_perm_b32 v121, v49, v48, s71
  v_accvgpr_write_b32 a204, v121
  v_perm_b32 v123, v51, v50, s71
  v_accvgpr_write_b32 a205, v123
  v_perm_b32 v121, v53, v52, s71
  v_accvgpr_write_b32 a206, v121
  v_perm_b32 v123, v55, v54, s71
  v_accvgpr_write_b32 a207, v123
  s_mov_b32 s58, 3670016
  buffer_load_dword v40, v18, s[48:51], s58 offen
  s_mov_b32 s59, 3678208
  buffer_load_dword v41, v18, s[48:51], s59 offen
  s_mov_b32 s60, 3686400
  buffer_load_dword v42, v18, s[48:51], s60 offen
  s_mov_b32 s61, 3694592
  buffer_load_dword v43, v18, s[48:51], s61 offen
  s_mov_b32 s58, 3702784
  buffer_load_dword v44, v18, s[48:51], s58 offen
  s_mov_b32 s59, 3710976
  buffer_load_dword v45, v18, s[48:51], s59 offen
  s_mov_b32 s60, 3719168
  buffer_load_dword v46, v18, s[48:51], s60 offen
  s_mov_b32 s61, 3727360
  buffer_load_dword v47, v18, s[48:51], s61 offen
  s_mov_b32 s58, 3932160
  buffer_load_dword v48, v18, s[48:51], s58 offen
  s_mov_b32 s59, 3940352
  buffer_load_dword v49, v18, s[48:51], s59 offen
  s_mov_b32 s60, 3948544
  buffer_load_dword v50, v18, s[48:51], s60 offen
  s_mov_b32 s61, 3956736
  buffer_load_dword v51, v18, s[48:51], s61 offen
  s_mov_b32 s58, 3964928
  buffer_load_dword v52, v18, s[48:51], s58 offen
  s_mov_b32 s59, 3973120
  buffer_load_dword v53, v18, s[48:51], s59 offen
  s_mov_b32 s60, 3981312
  buffer_load_dword v54, v18, s[48:51], s60 offen
  s_mov_b32 s61, 3989504
  buffer_load_dword v55, v18, s[48:51], s61 offen
  s_waitcnt vmcnt(63)
  v_perm_b32 v120, v57, v56, s70
  v_accvgpr_write_b32 a144, v120
  s_waitcnt vmcnt(63)
  v_perm_b32 v122, v59, v58, s70
  v_accvgpr_write_b32 a145, v122
  s_waitcnt vmcnt(63)
  v_perm_b32 v120, v61, v60, s70
  v_accvgpr_write_b32 a146, v120
  s_waitcnt vmcnt(63)
  v_perm_b32 v122, v63, v62, s70
  v_accvgpr_write_b32 a147, v122
  v_perm_b32 v121, v57, v56, s71
  v_accvgpr_write_b32 a208, v121
  v_perm_b32 v123, v59, v58, s71
  v_accvgpr_write_b32 a209, v123
  v_perm_b32 v121, v61, v60, s71
  v_accvgpr_write_b32 a210, v121
  v_perm_b32 v123, v63, v62, s71
  v_accvgpr_write_b32 a211, v123
  s_waitcnt vmcnt(63)
  v_perm_b32 v120, v65, v64, s70
  v_accvgpr_write_b32 a148, v120
  s_waitcnt vmcnt(63)
  v_perm_b32 v122, v67, v66, s70
  v_accvgpr_write_b32 a149, v122
  s_waitcnt vmcnt(63)
  v_perm_b32 v120, v69, v68, s70
  v_accvgpr_write_b32 a150, v120
  s_waitcnt vmcnt(63)
  v_perm_b32 v122, v71, v70, s70
  v_accvgpr_write_b32 a151, v122
  v_perm_b32 v121, v65, v64, s71
  v_accvgpr_write_b32 a212, v121
  v_perm_b32 v123, v67, v66, s71
  v_accvgpr_write_b32 a213, v123
  v_perm_b32 v121, v69, v68, s71
  v_accvgpr_write_b32 a214, v121
  v_perm_b32 v123, v71, v70, s71
  v_accvgpr_write_b32 a215, v123
  s_waitcnt vmcnt(63)
  v_perm_b32 v120, v73, v72, s70
  v_accvgpr_write_b32 a152, v120
  s_waitcnt vmcnt(63)
  v_perm_b32 v122, v75, v74, s70
  v_accvgpr_write_b32 a153, v122
  s_waitcnt vmcnt(63)
  v_perm_b32 v120, v77, v76, s70
  v_accvgpr_write_b32 a154, v120
  s_waitcnt vmcnt(63)
  v_perm_b32 v122, v79, v78, s70
  v_accvgpr_write_b32 a155, v122
  v_perm_b32 v121, v73, v72, s71
  v_accvgpr_write_b32 a216, v121
  v_perm_b32 v123, v75, v74, s71
  v_accvgpr_write_b32 a217, v123
  v_perm_b32 v121, v77, v76, s71
  v_accvgpr_write_b32 a218, v121
  v_perm_b32 v123, v79, v78, s71
  v_accvgpr_write_b32 a219, v123
  s_waitcnt vmcnt(63)
  v_perm_b32 v120, v81, v80, s70
  v_accvgpr_write_b32 a156, v120
  s_waitcnt vmcnt(63)
  v_perm_b32 v122, v83, v82, s70
  v_accvgpr_write_b32 a157, v122
  s_waitcnt vmcnt(63)
  v_perm_b32 v120, v85, v84, s70
  v_accvgpr_write_b32 a158, v120
  s_waitcnt vmcnt(63)
  v_perm_b32 v122, v87, v86, s70
  v_accvgpr_write_b32 a159, v122
  v_perm_b32 v121, v81, v80, s71
  v_accvgpr_write_b32 a220, v121
  v_perm_b32 v123, v83, v82, s71
  v_accvgpr_write_b32 a221, v123
  v_perm_b32 v121, v85, v84, s71
  v_accvgpr_write_b32 a222, v121
  v_perm_b32 v123, v87, v86, s71
  v_accvgpr_write_b32 a223, v123
  s_waitcnt vmcnt(62)
  v_perm_b32 v120, v89, v88, s70
  v_accvgpr_write_b32 a160, v120
  s_waitcnt vmcnt(60)
  v_perm_b32 v122, v91, v90, s70
  v_accvgpr_write_b32 a161, v122
  s_waitcnt vmcnt(58)
  v_perm_b32 v120, v93, v92, s70
  v_accvgpr_write_b32 a162, v120
  s_waitcnt vmcnt(56)
  v_perm_b32 v122, v95, v94, s70
  v_accvgpr_write_b32 a163, v122
  v_perm_b32 v121, v89, v88, s71
  v_accvgpr_write_b32 a224, v121
  v_perm_b32 v123, v91, v90, s71
  v_accvgpr_write_b32 a225, v123
  v_perm_b32 v121, v93, v92, s71
  v_accvgpr_write_b32 a226, v121
  v_perm_b32 v123, v95, v94, s71
  v_accvgpr_write_b32 a227, v123
  s_waitcnt vmcnt(54)
  v_perm_b32 v120, v97, v96, s70
  v_accvgpr_write_b32 a164, v120
  s_waitcnt vmcnt(52)
  v_perm_b32 v122, v99, v98, s70
  v_accvgpr_write_b32 a165, v122
  s_waitcnt vmcnt(50)
  v_perm_b32 v120, v101, v100, s70
  v_accvgpr_write_b32 a166, v120
  s_waitcnt vmcnt(48)
  v_perm_b32 v122, v103, v102, s70
  v_accvgpr_write_b32 a167, v122
  v_perm_b32 v121, v97, v96, s71
  v_accvgpr_write_b32 a228, v121
  v_perm_b32 v123, v99, v98, s71
  v_accvgpr_write_b32 a229, v123
  v_perm_b32 v121, v101, v100, s71
  v_accvgpr_write_b32 a230, v121
  v_perm_b32 v123, v103, v102, s71
  v_accvgpr_write_b32 a231, v123
  s_waitcnt vmcnt(46)
  v_perm_b32 v120, v105, v104, s70
  v_accvgpr_write_b32 a168, v120
  s_waitcnt vmcnt(44)
  v_perm_b32 v122, v107, v106, s70
  v_accvgpr_write_b32 a169, v122
  s_waitcnt vmcnt(42)
  v_perm_b32 v120, v109, v108, s70
  v_accvgpr_write_b32 a170, v120
  s_waitcnt vmcnt(40)
  v_perm_b32 v122, v111, v110, s70
  v_accvgpr_write_b32 a171, v122
  v_perm_b32 v121, v105, v104, s71
  v_accvgpr_write_b32 a232, v121
  v_perm_b32 v123, v107, v106, s71
  v_accvgpr_write_b32 a233, v123
  v_perm_b32 v121, v109, v108, s71
  v_accvgpr_write_b32 a234, v121
  v_perm_b32 v123, v111, v110, s71
  v_accvgpr_write_b32 a235, v123
  s_waitcnt vmcnt(38)
  v_perm_b32 v120, v113, v112, s70
  v_accvgpr_write_b32 a172, v120
  s_waitcnt vmcnt(36)
  v_perm_b32 v122, v115, v114, s70
  v_accvgpr_write_b32 a173, v122
  s_waitcnt vmcnt(34)
  v_perm_b32 v120, v117, v116, s70
  v_accvgpr_write_b32 a174, v120
  s_waitcnt vmcnt(32)
  v_perm_b32 v122, v119, v118, s70
  v_accvgpr_write_b32 a175, v122
  v_perm_b32 v121, v113, v112, s71
  v_accvgpr_write_b32 a236, v121
  v_perm_b32 v123, v115, v114, s71
  v_accvgpr_write_b32 a237, v123
  v_perm_b32 v121, v117, v116, s71
  v_accvgpr_write_b32 a238, v121
  v_perm_b32 v123, v119, v118, s71
  v_accvgpr_write_b32 a239, v123
  s_waitcnt vmcnt(30)
  v_perm_b32 v120, v25, v24, s70
  v_accvgpr_write_b32 a176, v120
  s_waitcnt vmcnt(28)
  v_perm_b32 v122, v27, v26, s70
  v_accvgpr_write_b32 a177, v122
  s_waitcnt vmcnt(26)
  v_perm_b32 v120, v29, v28, s70
  v_accvgpr_write_b32 a178, v120
  s_waitcnt vmcnt(24)
  v_perm_b32 v122, v31, v30, s70
  v_accvgpr_write_b32 a179, v122
  v_perm_b32 v121, v25, v24, s71
  v_accvgpr_write_b32 a240, v121
  v_perm_b32 v123, v27, v26, s71
  v_accvgpr_write_b32 a241, v123
  v_perm_b32 v121, v29, v28, s71
  v_accvgpr_write_b32 a242, v121
  v_perm_b32 v123, v31, v30, s71
  v_accvgpr_write_b32 a243, v123
  s_waitcnt vmcnt(22)
  v_perm_b32 v120, v33, v32, s70
  v_accvgpr_write_b32 a180, v120
  s_waitcnt vmcnt(20)
  v_perm_b32 v122, v35, v34, s70
  v_accvgpr_write_b32 a181, v122
  s_waitcnt vmcnt(18)
  v_perm_b32 v120, v37, v36, s70
  v_accvgpr_write_b32 a182, v120
  s_waitcnt vmcnt(16)
  v_perm_b32 v122, v39, v38, s70
  v_accvgpr_write_b32 a183, v122
  v_perm_b32 v121, v33, v32, s71
  v_accvgpr_write_b32 a244, v121
  v_perm_b32 v123, v35, v34, s71
  v_accvgpr_write_b32 a245, v123
  v_perm_b32 v121, v37, v36, s71
  v_accvgpr_write_b32 a246, v121
  v_perm_b32 v123, v39, v38, s71
  v_accvgpr_write_b32 a247, v123
  s_waitcnt vmcnt(14)
  v_perm_b32 v120, v41, v40, s70
  v_accvgpr_write_b32 a184, v120
  s_waitcnt vmcnt(12)
  v_perm_b32 v122, v43, v42, s70
  v_accvgpr_write_b32 a185, v122
  s_waitcnt vmcnt(10)
  v_perm_b32 v120, v45, v44, s70
  v_accvgpr_write_b32 a186, v120
  s_waitcnt vmcnt(8)
  v_perm_b32 v122, v47, v46, s70
  v_accvgpr_write_b32 a187, v122
  v_perm_b32 v121, v41, v40, s71
  v_accvgpr_write_b32 a248, v121
  v_perm_b32 v123, v43, v42, s71
  v_accvgpr_write_b32 a249, v123
  v_perm_b32 v121, v45, v44, s71
  v_accvgpr_write_b32 a250, v121
  v_perm_b32 v123, v47, v46, s71
  v_accvgpr_write_b32 a251, v123
  s_waitcnt vmcnt(6)
  v_perm_b32 v120, v49, v48, s70
  v_accvgpr_write_b32 a188, v120
  s_waitcnt vmcnt(4)
  v_perm_b32 v122, v51, v50, s70
  v_accvgpr_write_b32 a189, v122
  s_waitcnt vmcnt(2)
  v_perm_b32 v120, v53, v52, s70
  v_accvgpr_write_b32 a190, v120
  s_waitcnt vmcnt(0)
  v_perm_b32 v122, v55, v54, s70
  v_accvgpr_write_b32 a191, v122
  v_perm_b32 v121, v49, v48, s71
  v_accvgpr_write_b32 a252, v121
  v_perm_b32 v123, v51, v50, s71
  v_accvgpr_write_b32 a253, v123
  v_perm_b32 v121, v53, v52, s71
  v_accvgpr_write_b32 a254, v121
  v_perm_b32 v123, v55, v54, s71
  v_accvgpr_write_b32 a255, v123
  s_lshl_b32 s56, s20, 19
  s_add_u32 s22, s56, 8388608
  s_add_u32 s23, s56, 25165824
  s_lshl_b32 s17, s20, 7
  s_add_u32 s17, s17, 8192
  s_cmp_lg_u32 s9, 0
  s_cbranch_scc1 L_cp1d
  v_mov_b32 v125, 20
  s_mov_b32 s43, 0
L_cp1:
    buffer_load_dword v124, v125, s[52:55], 0 offen sc1
    s_waitcnt vmcnt(0)
  v_readfirstlane_b32 s63, v124
  s_nop 0
  s_cmp_ge_u32 s63, 16
  s_nop 1
  s_cbranch_scc1 L_cp1d
  s_sleep 6
  s_add_u32 s43, s43, 1
  s_cmp_lt_u32 s43, 400000
  s_cbranch_scc1 L_cp1
  s_branch L_bail
L_cp1d:
  s_barrier
  v_lshlrev_b32 v6, 4, v1
  v_and_b32 v8, 15, v1
  v_lshlrev_b32 v7, 6, v8
  v_lshrrev_b32 v8, 4, v1
  v_lshlrev_b32 v8, 4, v8
  v_add_u32 v7, v7, v8
  s_lshl_b32 s56, s9, 11
  v_add_u32 v7, s56, v7
  v_cmp_eq_u32 vcc, 0, v1
  v_mov_b32 v10, 0x7ffffff0
  s_lshl_b32 s56, s9, 2
  v_mov_b32 v9, s56
  v_cndmask_b32 v9, v10, v9, vcc
  s_mov_b32 s10, 0
  s_mov_b32 s25, 0
  v_lshlrev_b32 v11, 7, v1
  s_mov_b32 s43, 0
  s_mov_b32 s30, 0
L_h1all2:
  buffer_load_dwordx2 v[12:13], v11, s[4:7], s30 offen sc1
  s_waitcnt vmcnt(0)
  v_min_u32 v12, v12, v13
  v_cmp_eq_u32 vcc, 0, v12
  s_cbranch_vccz L_h1all2d
  s_sleep 2
  s_add_u32 s43, s43, 1
  s_cmp_lt_u32 s43, 400000
  s_cbranch_scc1 L_h1all2
  s_branch L_bail
L_h1all2d:
  s_lshl_b32 s57, s10, 15
  s_lshl_b32 s58, s9, 13
  s_add_u32 s57, s57, s58
  s_add_u32 s57, s57, 1048576
  s_add_u32 s59, s25, s58
  s_add_u32 m0, s59, 0
  s_add_u32 s60, s57, 0
  buffer_load_dwordx4 v6, s[4:7], s60 offen sc1 lds
  s_add_u32 m0, s59, 1024
  s_add_u32 s60, s57, 1024
  buffer_load_dwordx4 v6, s[4:7], s60 offen sc1 lds
  s_add_u32 m0, s59, 2048
  s_add_u32 s60, s57, 2048
  buffer_load_dwordx4 v6, s[4:7], s60 offen sc1 lds
  s_add_u32 m0, s59, 3072
  s_add_u32 s60, s57, 3072
  buffer_load_dwordx4 v6, s[4:7], s60 offen sc1 lds
  s_add_u32 m0, s59, 4096
  s_add_u32 s60, s57, 4096
  buffer_load_dwordx4 v6, s[4:7], s60 offen sc1 lds
  s_add_u32 m0, s59, 5120
  s_add_u32 s60, s57, 5120
  buffer_load_dwordx4 v6, s[4:7], s60 offen sc1 lds
  s_add_u32 m0, s59, 6144
  s_add_u32 s60, s57, 6144
  buffer_load_dwordx4 v6, s[4:7], s60 offen sc1 lds
  s_add_u32 m0, s59, 7168
  s_add_u32 s60, s57, 7168
  buffer_load_dwordx4 v6, s[4:7], s60 offen sc1 lds
  s_waitcnt vmcnt(0)
L_pkv_loop:
  s_waitcnt vmcnt(5)
  s_barrier
  s_add_u32 s28, s10, 1
  s_cmp_ge_u32 s28, 64
  s_cbranch_scc1 L_pkv_nodma
  s_xor_b32 s29, s25, 32768
  s_lshl_b32 s57, s28, 15
  s_lshl_b32 s58, s9, 13
  s_add_u32 s57, s57, s58
  s_add_u32 s57, s57, 1048576
  s_add_u32 s59, s29, s58
  s_add_u32 m0, s59, 0
  s_add_u32 s60, s57, 0
  buffer_load_dwordx4 v6, s[4:7], s60 offen sc1 lds
  s_add_u32 m0, s59, 1024
  s_add_u32 s60, s57, 1024
  buffer_load_dwordx4 v6, s[4:7], s60 offen sc1 lds
  s_add_u32 m0, s59, 2048
  s_add_u32 s60, s57, 2048
  buffer_load_dwordx4 v6, s[4:7], s60 offen sc1 lds
  s_add_u32 m0, s59, 3072
  s_add_u32 s60, s57, 3072
  buffer_load_dwordx4 v6, s[4:7], s60 offen sc1 lds
  s_add_u32 m0, s59, 4096
  s_add_u32 s60, s57, 4096
  buffer_load_dwordx4 v6, s[4:7], s60 offen sc1 lds
  s_add_u32 m0, s59, 5120
  s_add_u32 s60, s57, 5120
  buffer_load_dwordx4 v6, s[4:7], s60 offen sc1 lds
  s_add_u32 m0, s59, 6144
  s_add_u32 s60, s57, 6144
  buffer_load_dwordx4 v6, s[4:7], s60 offen sc1 lds
  s_add_u32 m0, s59, 7168
  s_add_u32 s60, s57, 7168
  buffer_load_dwordx4 v6, s[4:7], s60 offen sc1 lds
L_pkv_nodma:
  v_add_u32 v8, s25, v6
  ds_read_b128 v[16:19], v8 offset:0
  s_nop 2
  ds_read_b128 v[20:23], v8 offset:1024
  s_nop 2
  ds_read_b128 v[24:27], v8 offset:2048
  s_nop 2
  ds_read_b128 v[28:31], v8 offset:3072
  s_nop 2
  ds_read_b128 v[32:35], v8 offset:4096
  s_waitcnt lgkmcnt(4)
  v_mfma_f32_16x16x32_bf16 v[64:67], a[0:3], v[16:19], 0
  s_nop 0
  ds_read_b128 v[36:39], v8 offset:5120
  v_mfma_f32_16x16x32_bf16 v[68:71], a[64:67], v[16:19], 0
  s_nop 0
  ds_read_b128 v[40:43], v8 offset:6144
  v_mfma_f32_16x16x32_bf16 v[80:83], v[16:19], a[128:131], 0
  s_nop 0
  ds_read_b128 v[44:47], v8 offset:7168
  v_mfma_f32_16x16x32_bf16 v[84:87], v[16:19], a[192:195], 0
  s_nop 0
  ds_read_b128 v[16:19], v8 offset:8192
  s_waitcnt lgkmcnt(7)
  v_mfma_f32_16x16x32_bf16 v[64:67], a[4:7], v[20:23], v[64:67]
  v_mfma_f32_16x16x32_bf16 v[68:71], a[68:71], v[20:23], v[68:71]
  v_mfma_f32_16x16x32_bf16 v[80:83], v[20:23], a[132:135], v[80:83]
  v_mfma_f32_16x16x32_bf16 v[84:87], v[20:23], a[196:199], v[84:87]
  ds_read_b128 v[20:23], v8 offset:9216
  s_waitcnt lgkmcnt(7)
  v_mfma_f32_16x16x32_bf16 v[64:67], a[8:11], v[24:27], v[64:67]
  v_mfma_f32_16x16x32_bf16 v[68:71], a[72:75], v[24:27], v[68:71]
  v_mfma_f32_16x16x32_bf16 v[80:83], v[24:27], a[136:139], v[80:83]
  v_mfma_f32_16x16x32_bf16 v[84:87], v[24:27], a[200:203], v[84:87]
  ds_read_b128 v[24:27], v8 offset:10240
  s_waitcnt lgkmcnt(7)
  v_mfma_f32_16x16x32_bf16 v[64:67], a[12:15], v[28:31], v[64:67]
  v_mfma_f32_16x16x32_bf16 v[68:71], a[76:79], v[28:31], v[68:71]
  v_mfma_f32_16x16x32_bf16 v[80:83], v[28:31], a[140:143], v[80:83]
  v_mfma_f32_16x16x32_bf16 v[84:87], v[28:31], a[204:207], v[84:87]
  ds_read_b128 v[28:31], v8 offset:11264
  s_waitcnt lgkmcnt(7)
  v_mfma_f32_16x16x32_bf16 v[64:67], a[16:19], v[32:35], v[64:67]
  v_mfma_f32_16x16x32_bf16 v[68:71], a[80:83], v[32:35], v[68:71]
  v_mfma_f32_16x16x32_bf16 v[80:83], v[32:35], a[144:147], v[80:83]
  v_mfma_f32_16x16x32_bf16 v[84:87], v[32:35], a[208:211], v[84:87]
  ds_read_b128 v[32:35], v8 offset:12288
  s_waitcnt lgkmcnt(7)
  v_mfma_f32_16x16x32_bf16 v[64:67], a[20:23], v[36:39], v[64:67]
  v_mfma_f32_16x16x32_bf16 v[68:71], a[84:87], v[36:39], v[68:71]
  v_mfma_f32_16x16x32_bf16 v[80:83], v[36:39], a[148:151], v[80:83]
  v_mfma_f32_16x16x32_bf16 v[84:87], v[36:39], a[212:215], v[84:87]
  ds_read_b128 v[36:39], v8 offset:13312
  s_waitcnt lgkmcnt(7)
  v_mfma_f32_16x16x32_bf16 v[64:67], a[24:27], v[40:43], v[64:67]
  v_mfma_f32_16x16x32_bf16 v[68:71], a[88:91], v[40:43], v[68:71]
  v_mfma_f32_16x16x32_bf16 v[80:83], v[40:43], a[152:155], v[80:83]
  v_mfma_f32_16x16x32_bf16 v[84:87], v[40:43], a[216:219], v[84:87]
  ds_read_b128 v[40:43], v8 offset:14336
  s_waitcnt lgkmcnt(7)
  v_mfma_f32_16x16x32_bf16 v[64:67], a[28:31], v[44:47], v[64:67]
  v_mfma_f32_16x16x32_bf16 v[68:71], a[92:95], v[44:47], v[68:71]
  v_mfma_f32_16x16x32_bf16 v[80:83], v[44:47], a[156:159], v[80:83]
  v_mfma_f32_16x16x32_bf16 v[84:87], v[44:47], a[220:223], v[84:87]
  ds_read_b128 v[44:47], v8 offset:15360
  s_waitcnt lgkmcnt(7)
  v_mfma_f32_16x16x32_bf16 v[64:67], a[32:35], v[16:19], v[64:67]
  v_mfma_f32_16x16x32_bf16 v[68:71], a[96:99], v[16:19], v[68:71]
  v_mfma_f32_16x16x32_bf16 v[80:83], v[16:19], a[160:163], v[80:83]
  v_mfma_f32_16x16x32_bf16 v[84:87], v[16:19], a[224:227], v[84:87]
  ds_read_b128 v[16:19], v8 offset:16384
  s_waitcnt lgkmcnt(7)
  v_mfma_f32_16x16x32_bf16 v[64:67], a[36:39], v[20:23], v[64:67]
  v_mfma_f32_16x16x32_bf16 v[68:71], a[100:103], v[20:23], v[68:71]
  v_mfma_f32_16x16x32_bf16 v[80:83], v[20:23], a[164:167], v[80:83]
  v_mfma_f32_16x16x32_bf16 v[84:87], v[20:23], a[228:231], v[84:87]
  ds_read_b128 v[20:23], v8 offset:17408
  s_waitcnt lgkmcnt(7)
  v_mfma_f32_16x16x32_bf16 v[64:67], a[40:43], v[24:27], v[64:67]
  v_mfma_f32_16x16x32_bf16 v[68:71], a[104:107], v[24:27], v[68:71]
  v_mfma_f32_16x16x32_bf16 v[80:83], v[24:27], a[168:171], v[80:83]
  v_mfma_f32_16x16x32_bf16 v[84:87], v[24:27], a[232:235], v[84:87]
  ds_read_b128 v[24:27], v8 offset:18432
  s_waitcnt lgkmcnt(7)
  v_mfma_f32_16x16x32_bf16 v[64:67], a[44:47], v[28:31], v[64:67]
  v_mfma_f32_16x16x32_bf16 v[68:71], a[108:111], v[28:31], v[68:71]
  v_mfma_f32_16x16x32_bf16 v[80:83], v[28:31], a[172:175], v[80:83]
  v_mfma_f32_16x16x32_bf16 v[84:87], v[28:31], a[236:239], v[84:87]
  ds_read_b128 v[28:31], v8 offset:19456
  s_waitcnt lgkmcnt(3)
  v_mfma_f32_16x16x32_bf16 v[72:75], a[0:3], v[16:19], 0
  v_mfma_f32_16x16x32_bf16 v[76:79], a[64:67], v[16:19], 0
  v_mfma_f32_16x16x32_bf16 v[88:91], v[16:19], a[128:131], 0
  v_mfma_f32_16x16x32_bf16 v[92:95], v[16:19], a[192:195], 0
  ds_read_b128 v[16:19], v8 offset:24576
  v_mfma_f32_16x16x32_bf16 v[64:67], a[48:51], v[32:35], v[64:67]
  v_mfma_f32_16x16x32_bf16 v[68:71], a[112:115], v[32:35], v[68:71]
  v_mfma_f32_16x16x32_bf16 v[80:83], v[32:35], a[176:179], v[80:83]
  v_mfma_f32_16x16x32_bf16 v[84:87], v[32:35], a[240:243], v[84:87]
  ds_read_b128 v[32:35], v8 offset:20480
  s_waitcnt lgkmcnt(4)
  v_mfma_f32_16x16x32_bf16 v[72:75], a[4:7], v[20:23], v[72:75]
  v_mfma_f32_16x16x32_bf16 v[76:79], a[68:71], v[20:23], v[76:79]
  v_mfma_f32_16x16x32_bf16 v[88:91], v[20:23], a[132:135], v[88:91]
  v_mfma_f32_16x16x32_bf16 v[92:95], v[20:23], a[196:199], v[92:95]
  ds_read_b128 v[20:23], v8 offset:25600
  v_mfma_f32_16x16x32_bf16 v[64:67], a[52:55], v[36:39], v[64:67]
  v_mfma_f32_16x16x32_bf16 v[68:71], a[116:119], v[36:39], v[68:71]
  v_mfma_f32_16x16x32_bf16 v[80:83], v[36:39], a[180:183], v[80:83]
  v_mfma_f32_16x16x32_bf16 v[84:87], v[36:39], a[244:247], v[84:87]
  ds_read_b128 v[36:39], v8 offset:21504
  s_waitcnt lgkmcnt(5)
  v_mfma_f32_16x16x32_bf16 v[72:75], a[8:11], v[24:27], v[72:75]
  v_mfma_f32_16x16x32_bf16 v[76:79], a[72:75], v[24:27], v[76:79]
  v_mfma_f32_16x16x32_bf16 v[88:91], v[24:27], a[136:139], v[88:91]
  v_mfma_f32_16x16x32_bf16 v[92:95], v[24:27], a[200:203], v[92:95]
  ds_read_b128 v[24:27], v8 offset:26624
  v_mfma_f32_16x16x32_bf16 v[64:67], a[56:59], v[40:43], v[64:67]
  v_mfma_f32_16x16x32_bf16 v[68:71], a[120:123], v[40:43], v[68:71]
  v_mfma_f32_16x16x32_bf16 v[80:83], v[40:43], a[184:187], v[80:83]
  v_mfma_f32_16x16x32_bf16 v[84:87], v[40:43], a[248:251], v[84:87]
  ds_read_b128 v[40:43], v8 offset:22528
  s_waitcnt lgkmcnt(6)
  v_mfma_f32_16x16x32_bf16 v[72:75], a[12:15], v[28:31], v[72:75]
  v_mfma_f32_16x16x32_bf16 v[76:79], a[76:79], v[28:31], v[76:79]
  v_mfma_f32_16x16x32_bf16 v[88:91], v[28:31], a[140:143], v[88:91]
  v_mfma_f32_16x16x32_bf16 v[92:95], v[28:31], a[204:207], v[92:95]
  ds_read_b128 v[28:31], v8 offset:27648
  v_mfma_f32_16x16x32_bf16 v[64:67], a[60:63], v[44:47], v[64:67]
  v_mfma_f32_16x16x32_bf16 v[68:71], a[124:127], v[44:47], v[68:71]
  v_mfma_f32_16x16x32_bf16 v[80:83], v[44:47], a[188:191], v[80:83]
  v_mfma_f32_16x16x32_bf16 v[84:87], v[44:47], a[252:255], v[84:87]
  ds_read_b128 v[44:47], v8 offset:23552
  v_cvt_pk_bf16_f32 v96, v64, v68
  v_cvt_pk_bf16_f32 v97, v65, v69
  s_waitcnt lgkmcnt(6)
  v_mfma_f32_16x16x32_bf16 v[72:75], a[16:19], v[32:35], v[72:75]
  v_cvt_pk_bf16_f32 v98, v66, v70
  v_cvt_pk_bf16_f32 v99, v67, v71
  v_mfma_f32_16x16x32_bf16 v[76:79], a[80:83], v[32:35], v[76:79]
  v_cvt_pk_bf16_f32 v104, v80, v81
  v_cvt_pk_bf16_f32 v105, v82, v83
  v_mfma_f32_16x16x32_bf16 v[88:91], v[32:35], a[144:147], v[88:91]
  v_cvt_pk_bf16_f32 v108, v84, v85
  v_cvt_pk_bf16_f32 v109, v86, v87
  v_mfma_f32_16x16x32_bf16 v[92:95], v[32:35], a[208:211], v[92:95]
  ds_read_b128 v[32:35], v8 offset:28672
  s_waitcnt lgkmcnt(5)
  v_mfma_f32_16x16x32_bf16 v[72:75], a[20:23], v[36:39], v[72:75]
  v_mfma_f32_16x16x32_bf16 v[76:79], a[84:87], v[36:39], v[76:79]
  v_mfma_f32_16x16x32_bf16 v[88:91], v[36:39], a[148:151], v[88:91]
  v_mfma_f32_16x16x32_bf16 v[92:95], v[36:39], a[212:215], v[92:95]
  ds_read_b128 v[36:39], v8 offset:29696
  s_waitcnt lgkmcnt(4)
  v_mfma_f32_16x16x32_bf16 v[72:75], a[24:27], v[40:43], v[72:75]
  v_mfma_f32_16x16x32_bf16 v[76:79], a[88:91], v[40:43], v[76:79]
  v_mfma_f32_16x16x32_bf16 v[88:91], v[40:43], a[152:155], v[88:91]
  v_mfma_f32_16x16x32_bf16 v[92:95], v[40:43], a[216:219], v[92:95]
  ds_read_b128 v[40:43], v8 offset:30720
  s_waitcnt lgkmcnt(3)
  v_mfma_f32_16x16x32_bf16 v[72:75], a[28:31], v[44:47], v[72:75]
  v_mfma_f32_16x16x32_bf16 v[76:79], a[92:95], v[44:47], v[76:79]
  v_mfma_f32_16x16x32_bf16 v[88:91], v[44:47], a[156:159], v[88:91]
  v_mfma_f32_16x16x32_bf16 v[92:95], v[44:47], a[220:223], v[92:95]
  ds_read_b128 v[44:47], v8 offset:31744
  v_mfma_f32_16x16x32_bf16 v[72:75], a[32:35], v[16:19], v[72:75]
  v_mfma_f32_16x16x32_bf16 v[76:79], a[96:99], v[16:19], v[76:79]
  v_mfma_f32_16x16x32_bf16 v[88:91], v[16:19], a[160:163], v[88:91]
  v_mfma_f32_16x16x32_bf16 v[92:95], v[16:19], a[224:227], v[92:95]
  v_mfma_f32_16x16x32_bf16 v[72:75], a[36:39], v[20:23], v[72:75]
  v_mfma_f32_16x16x32_bf16 v[76:79], a[100:103], v[20:23], v[76:79]
  v_mfma_f32_16x16x32_bf16 v[88:91], v[20:23], a[164:167], v[88:91]
  v_mfma_f32_16x16x32_bf16 v[92:95], v[20:23], a[228:231], v[92:95]
  v_mfma_f32_16x16x32_bf16 v[72:75], a[40:43], v[24:27], v[72:75]
  v_mfma_f32_16x16x32_bf16 v[76:79], a[104:107], v[24:27], v[76:79]
  v_mfma_f32_16x16x32_bf16 v[88:91], v[24:27], a[168:171], v[88:91]
  v_mfma_f32_16x16x32_bf16 v[92:95], v[24:27], a[232:235], v[92:95]
  v_mfma_f32_16x16x32_bf16 v[72:75], a[44:47], v[28:31], v[72:75]
  v_mfma_f32_16x16x32_bf16 v[76:79], a[108:111], v[28:31], v[76:79]
  v_mfma_f32_16x16x32_bf16 v[88:91], v[28:31], a[172:175], v[88:91]
  v_mfma_f32_16x16x32_bf16 v[92:95], v[28:31], a[236:239], v[92:95]
  s_waitcnt lgkmcnt(3)
  v_mfma_f32_16x16x32_bf16 v[72:75], a[48:51], v[32:35], v[72:75]
  v_mfma_f32_16x16x32_bf16 v[76:79], a[112:115], v[32:35], v[76:79]
  v_mfma_f32_16x16x32_bf16 v[88:91], v[32:35], a[176:179], v[88:91]
  v_mfma_f32_16x16x32_bf16 v[92:95], v[32:35], a[240:243], v[92:95]
  s_waitcnt lgkmcnt(2)
  v_mfma_f32_16x16x32_bf16 v[72:75], a[52:55], v[36:39], v[72:75]
  v_mfma_f32_16x16x32_bf16 v[76:79], a[116:119], v[36:39], v[76:79]
  v_mfma_f32_16x16x32_bf16 v[88:91], v[36:39], a[180:183], v[88:91]
  v_mfma_f32_16x16x32_bf16 v[92:95], v[36:39], a[244:247], v[92:95]
  s_waitcnt lgkmcnt(1)
  v_mfma_f32_16x16x32_bf16 v[72:75], a[56:59], v[40:43], v[72:75]
  v_mfma_f32_16x16x32_bf16 v[76:79], a[120:123], v[40:43], v[76:79]
  v_mfma_f32_16x16x32_bf16 v[88:91], v[40:43], a[184:187], v[88:91]
  v_mfma_f32_16x16x32_bf16 v[92:95], v[40:43], a[248:251], v[92:95]
  s_waitcnt lgkmcnt(0)
  v_mfma_f32_16x16x32_bf16 v[72:75], a[60:63], v[44:47], v[72:75]
  v_mfma_f32_16x16x32_bf16 v[76:79], a[124:127], v[44:47], v[76:79]
  v_mfma_f32_16x16x32_bf16 v[88:91], v[44:47], a[188:191], v[88:91]
  v_mfma_f32_16x16x32_bf16 v[92:95], v[44:47], a[252:255], v[92:95]
  v_cvt_pk_bf16_f32 v100, v72, v76
  v_cvt_pk_bf16_f32 v101, v73, v77
  v_cvt_pk_bf16_f32 v102, v74, v78
  v_cvt_pk_bf16_f32 v103, v75, v79
  v_cvt_pk_bf16_f32 v106, v88, v89
  v_cvt_pk_bf16_f32 v107, v90, v91
  s_nop 1
  v_cvt_pk_bf16_f32 v110, v92, v93
  v_cvt_pk_bf16_f32 v111, v94, v95
  s_cmp_ge_u32 s28, 64
  s_cbranch_scc0 L_pkv_w8
  s_waitcnt vmcnt(0)
L_pkv_w8:
  s_waitcnt vmcnt(8)
  v_mov_b32 v10, s10
  buffer_store_dword v10, v9, s[4:7], s17 offen sc1
  s_lshl_b32 s56, s10, 13
  s_add_u32 s26, s22, s56
  buffer_store_dwordx4 v[96:99], v7, s[4:7], s26 offen offset:0 sc1
  buffer_store_dwordx4 v[100:103], v7, s[4:7], s26 offen offset:1024 sc1
  s_add_u32 s27, s23, s56
  buffer_store_dwordx4 v[104:107], v7, s[4:7], s27 offen offset:0 sc1
  buffer_store_dwordx4 v[108:111], v7, s[4:7], s27 offen offset:1024 sc1
  s_xor_b32 s25, s25, 32768
  s_add_u32 s10, s10, 1
  s_cmp_gt_u32 s10, 2
  s_cbranch_scc1 L_pkv_noearly
  s_waitcnt vmcnt(0)
  v_mov_b32 v10, s10
  buffer_store_dword v10, v9, s[4:7], s17 offen sc1
L_pkv_noearly:
  s_cmp_lt_u32 s10, 64
  s_cbranch_scc1 L_pkv_loop
  s_waitcnt vmcnt(0)
  v_mov_b32 v10, s10
  buffer_store_dword v10, v9, s[4:7], s17 offen sc1
  s_waitcnt vmcnt(0)
  s_branch L_p_done
L_p_q:
  s_lshl_b32 s20, s16, 3
  s_add_u32 s20, s20, s14
  s_sub_u32 s20, s20, 16
  s_lshl_b32 s20, s20, 1
  s_add_u32 s21, s20, 1
  s_cmp_lg_u32 s9, 0
  s_cbranch_scc1 L_cq3d
  v_mov_b32 v125, 20
  s_mov_b32 s43, 0
L_cq3:
    buffer_load_dword v124, v125, s[52:55], 0 offen sc1
    s_waitcnt vmcnt(0)
  v_readfirstlane_b32 s63, v124
  s_nop 0
  s_cmp_ge_u32 s63, 16
  s_nop 1
  s_cbranch_scc1 L_cq3d
  s_sleep 6
  s_add_u32 s43, s43, 1
  s_cmp_lt_u32 s43, 400000
  s_cbranch_scc1 L_cq3
  s_branch L_bail
L_cq3d:
  s_barrier
  s_load_dwordx2 s[48:49], s[0:1], 16
  s_waitcnt lgkmcnt(0)
  s_mov_b32 s50, 4194304
  s_mov_b32 s51, 0x20000
  v_and_b32 v16, 15, v1
  v_lshrrev_b32 v17, 4, v1
  v_lshlrev_b32 v18, 16, v17
  v_lshlrev_b32 v19, 2, v16
  v_add_u32 v18, v18, v19
  s_lshl_b32 s56, s20, 8
  s_lshl_b32 s57, s9, 6
  s_add_u32 s56, s56, s57
  v_add_u32 v18, s56, v18
  s_mov_b32 s70, 0x05040100
  s_mov_b32 s71, 0x07060302
  s_mov_b32 s58, 0
  buffer_load_dword v24, v18, s[48:51], s58 offen
  s_mov_b32 s59, 8192
  buffer_load_dword v25, v18, s[48:51], s59 offen
  s_mov_b32 s60, 16384
  buffer_load_dword v26, v18, s[48:51], s60 offen
  s_mov_b32 s61, 24576
  buffer_load_dword v27, v18, s[48:51], s61 offen
  s_mov_b32 s58, 32768
  buffer_load_dword v28, v18, s[48:51], s58 offen
  s_mov_b32 s59, 40960
  buffer_load_dword v29, v18, s[48:51], s59 offen
  s_mov_b32 s60, 49152
  buffer_load_dword v30, v18, s[48:51], s60 offen
  s_mov_b32 s61, 57344
  buffer_load_dword v31, v18, s[48:51], s61 offen
  s_mov_b32 s58, 262144
  buffer_load_dword v32, v18, s[48:51], s58 offen
  s_mov_b32 s59, 270336
  buffer_load_dword v33, v18, s[48:51], s59 offen
  s_mov_b32 s60, 278528
  buffer_load_dword v34, v18, s[48:51], s60 offen
  s_mov_b32 s61, 286720
  buffer_load_dword v35, v18, s[48:51], s61 offen
  s_mov_b32 s58, 294912
  buffer_load_dword v36, v18, s[48:51], s58 offen
  s_mov_b32 s59, 303104
  buffer_load_dword v37, v18, s[48:51], s59 offen
  s_mov_b32 s60, 311296
  buffer_load_dword v38, v18, s[48:51], s60 offen
  s_mov_b32 s61, 319488
  buffer_load_dword v39, v18, s[48:51], s61 offen
  s_mov_b32 s58, 524288
  buffer_load_dword v40, v18, s[48:51], s58 offen
  s_mov_b32 s59, 532480
  buffer_load_dword v41, v18, s[48:51], s59 offen
  s_mov_b32 s60, 540672
  buffer_load_dword v42, v18, s[48:51], s60 offen
  s_mov_b32 s61, 548864
  buffer_load_dword v43, v18, s[48:51], s61 offen
  s_mov_b32 s58, 557056
  buffer_load_dword v44, v18, s[48:51], s58 offen
  s_mov_b32 s59, 565248
  buffer_load_dword v45, v18, s[48:51], s59 offen
  s_mov_b32 s60, 573440
  buffer_load_dword v46, v18, s[48:51], s60 offen
  s_mov_b32 s61, 581632
  buffer_load_dword v47, v18, s[48:51], s61 offen
  s_mov_b32 s58, 786432
  buffer_load_dword v48, v18, s[48:51], s58 offen
  s_mov_b32 s59, 794624
  buffer_load_dword v49, v18, s[48:51], s59 offen
  s_mov_b32 s60, 802816
  buffer_load_dword v50, v18, s[48:51], s60 offen
  s_mov_b32 s61, 811008
  buffer_load_dword v51, v18, s[48:51], s61 offen
  s_mov_b32 s58, 819200
  buffer_load_dword v52, v18, s[48:51], s58 offen
  s_mov_b32 s59, 827392
  buffer_load_dword v53, v18, s[48:51], s59 offen
  s_mov_b32 s60, 835584
  buffer_load_dword v54, v18, s[48:51], s60 offen
  s_mov_b32 s61, 843776
  buffer_load_dword v55, v18, s[48:51], s61 offen
  s_mov_b32 s58, 1048576
  buffer_load_dword v56, v18, s[48:51], s58 offen
  s_mov_b32 s59, 1056768
  buffer_load_dword v57, v18, s[48:51], s59 offen
  s_mov_b32 s60, 1064960
  buffer_load_dword v58, v18, s[48:51], s60 offen
  s_mov_b32 s61, 1073152
  buffer_load_dword v59, v18, s[48:51], s61 offen
  s_mov_b32 s58, 1081344
  buffer_load_dword v60, v18, s[48:51], s58 offen
  s_mov_b32 s59, 1089536
  buffer_load_dword v61, v18, s[48:51], s59 offen
  s_mov_b32 s60, 1097728
  buffer_load_dword v62, v18, s[48:51], s60 offen
  s_mov_b32 s61, 1105920
  buffer_load_dword v63, v18, s[48:51], s61 offen
  s_mov_b32 s58, 1310720
  buffer_load_dword v64, v18, s[48:51], s58 offen
  s_mov_b32 s59, 1318912
  buffer_load_dword v65, v18, s[48:51], s59 offen
  s_mov_b32 s60, 1327104
  buffer_load_dword v66, v18, s[48:51], s60 offen
  s_mov_b32 s61, 1335296
  buffer_load_dword v67, v18, s[48:51], s61 offen
  s_mov_b32 s58, 1343488
  buffer_load_dword v68, v18, s[48:51], s58 offen
  s_mov_b32 s59, 1351680
  buffer_load_dword v69, v18, s[48:51], s59 offen
  s_mov_b32 s60, 1359872
  buffer_load_dword v70, v18, s[48:51], s60 offen
  s_mov_b32 s61, 1368064
  buffer_load_dword v71, v18, s[48:51], s61 offen
  s_mov_b32 s58, 1572864
  buffer_load_dword v72, v18, s[48:51], s58 offen
  s_mov_b32 s59, 1581056
  buffer_load_dword v73, v18, s[48:51], s59 offen
  s_mov_b32 s60, 1589248
  buffer_load_dword v74, v18, s[48:51], s60 offen
  s_mov_b32 s61, 1597440
  buffer_load_dword v75, v18, s[48:51], s61 offen
  s_mov_b32 s58, 1605632
  buffer_load_dword v76, v18, s[48:51], s58 offen
  s_mov_b32 s59, 1613824
  buffer_load_dword v77, v18, s[48:51], s59 offen
  s_mov_b32 s60, 1622016
  buffer_load_dword v78, v18, s[48:51], s60 offen
  s_mov_b32 s61, 1630208
  buffer_load_dword v79, v18, s[48:51], s61 offen
  s_mov_b32 s58, 1835008
  buffer_load_dword v80, v18, s[48:51], s58 offen
  s_mov_b32 s59, 1843200
  buffer_load_dword v81, v18, s[48:51], s59 offen
  s_mov_b32 s60, 1851392
  buffer_load_dword v82, v18, s[48:51], s60 offen
  s_mov_b32 s61, 1859584
  buffer_load_dword v83, v18, s[48:51], s61 offen
  s_mov_b32 s58, 1867776
  buffer_load_dword v84, v18, s[48:51], s58 offen
  s_mov_b32 s59, 1875968
  buffer_load_dword v85, v18, s[48:51], s59 offen
  s_mov_b32 s60, 1884160
  buffer_load_dword v86, v18, s[48:51], s60 offen
  s_mov_b32 s61, 1892352
  buffer_load_dword v87, v18, s[48:51], s61 offen
  s_mov_b32 s58, 2097152
  buffer_load_dword v88, v18, s[48:51], s58 offen
  s_mov_b32 s59, 2105344
  buffer_load_dword v89, v18, s[48:51], s59 offen
  s_mov_b32 s60, 2113536
  buffer_load_dword v90, v18, s[48:51], s60 offen
  s_mov_b32 s61, 2121728
  buffer_load_dword v91, v18, s[48:51], s61 offen
  s_mov_b32 s58, 2129920
  buffer_load_dword v92, v18, s[48:51], s58 offen
  s_mov_b32 s59, 2138112
  buffer_load_dword v93, v18, s[48:51], s59 offen
  s_mov_b32 s60, 2146304
  buffer_load_dword v94, v18, s[48:51], s60 offen
  s_mov_b32 s61, 2154496
  buffer_load_dword v95, v18, s[48:51], s61 offen
  s_mov_b32 s58, 2359296
  buffer_load_dword v96, v18, s[48:51], s58 offen
  s_mov_b32 s59, 2367488
  buffer_load_dword v97, v18, s[48:51], s59 offen
  s_mov_b32 s60, 2375680
  buffer_load_dword v98, v18, s[48:51], s60 offen
  s_mov_b32 s61, 2383872
  buffer_load_dword v99, v18, s[48:51], s61 offen
  s_mov_b32 s58, 2392064
  buffer_load_dword v100, v18, s[48:51], s58 offen
  s_mov_b32 s59, 2400256
  buffer_load_dword v101, v18, s[48:51], s59 offen
  s_mov_b32 s60, 2408448
  buffer_load_dword v102, v18, s[48:51], s60 offen
  s_mov_b32 s61, 2416640
  buffer_load_dword v103, v18, s[48:51], s61 offen
  s_mov_b32 s58, 2621440
  buffer_load_dword v104, v18, s[48:51], s58 offen
  s_mov_b32 s59, 2629632
  buffer_load_dword v105, v18, s[48:51], s59 offen
  s_mov_b32 s60, 2637824
  buffer_load_dword v106, v18, s[48:51], s60 offen
  s_mov_b32 s61, 2646016
  buffer_load_dword v107, v18, s[48:51], s61 offen
  s_mov_b32 s58, 2654208
  buffer_load_dword v108, v18, s[48:51], s58 offen
  s_mov_b32 s59, 2662400
  buffer_load_dword v109, v18, s[48:51], s59 offen
  s_mov_b32 s60, 2670592
  buffer_load_dword v110, v18, s[48:51], s60 offen
  s_mov_b32 s61, 2678784
  buffer_load_dword v111, v18, s[48:51], s61 offen
  s_mov_b32 s58, 2883584
  buffer_load_dword v112, v18, s[48:51], s58 offen
  s_mov_b32 s59, 2891776
  buffer_load_dword v113, v18, s[48:51], s59 offen
  s_mov_b32 s60, 2899968
  buffer_load_dword v114, v18, s[48:51], s60 offen
  s_mov_b32 s61, 2908160
  buffer_load_dword v115, v18, s[48:51], s61 offen
  s_mov_b32 s58, 2916352
  buffer_load_dword v116, v18, s[48:51], s58 offen
  s_mov_b32 s59, 2924544
  buffer_load_dword v117, v18, s[48:51], s59 offen
  s_mov_b32 s60, 2932736
  buffer_load_dword v118, v18, s[48:51], s60 offen
  s_mov_b32 s61, 2940928
  buffer_load_dword v119, v18, s[48:51], s61 offen
  s_waitcnt vmcnt(63)
  v_perm_b32 v120, v25, v24, s70
  v_accvgpr_write_b32 a0, v120
  s_waitcnt vmcnt(63)
  v_perm_b32 v122, v27, v26, s70
  v_accvgpr_write_b32 a1, v122
  s_waitcnt vmcnt(63)
  v_perm_b32 v120, v29, v28, s70
  v_accvgpr_write_b32 a2, v120
  s_waitcnt vmcnt(63)
  v_perm_b32 v122, v31, v30, s70
  v_accvgpr_write_b32 a3, v122
  v_perm_b32 v121, v25, v24, s71
  v_accvgpr_write_b32 a64, v121
  v_perm_b32 v123, v27, v26, s71
  v_accvgpr_write_b32 a65, v123
  v_perm_b32 v121, v29, v28, s71
  v_accvgpr_write_b32 a66, v121
  v_perm_b32 v123, v31, v30, s71
  v_accvgpr_write_b32 a67, v123
  s_waitcnt vmcnt(63)
  v_perm_b32 v120, v33, v32, s70
  v_accvgpr_write_b32 a4, v120
  s_waitcnt vmcnt(63)
  v_perm_b32 v122, v35, v34, s70
  v_accvgpr_write_b32 a5, v122
  s_waitcnt vmcnt(63)
  v_perm_b32 v120, v37, v36, s70
  v_accvgpr_write_b32 a6, v120
  s_waitcnt vmcnt(63)
  v_perm_b32 v122, v39, v38, s70
  v_accvgpr_write_b32 a7, v122
  v_perm_b32 v121, v33, v32, s71
  v_accvgpr_write_b32 a68, v121
  v_perm_b32 v123, v35, v34, s71
  v_accvgpr_write_b32 a69, v123
  v_perm_b32 v121, v37, v36, s71
  v_accvgpr_write_b32 a70, v121
  v_perm_b32 v123, v39, v38, s71
  v_accvgpr_write_b32 a71, v123
  s_mov_b32 s58, 3145728
  buffer_load_dword v24, v18, s[48:51], s58 offen
  s_mov_b32 s59, 3153920
  buffer_load_dword v25, v18, s[48:51], s59 offen
  s_mov_b32 s60, 3162112
  buffer_load_dword v26, v18, s[48:51], s60 offen
  s_mov_b32 s61, 3170304
  buffer_load_dword v27, v18, s[48:51], s61 offen
  s_mov_b32 s58, 3178496
  buffer_load_dword v28, v18, s[48:51], s58 offen
  s_mov_b32 s59, 3186688
  buffer_load_dword v29, v18, s[48:51], s59 offen
  s_mov_b32 s60, 3194880
  buffer_load_dword v30, v18, s[48:51], s60 offen
  s_mov_b32 s61, 3203072
  buffer_load_dword v31, v18, s[48:51], s61 offen
  s_mov_b32 s58, 3407872
  buffer_load_dword v32, v18, s[48:51], s58 offen
  s_mov_b32 s59, 3416064
  buffer_load_dword v33, v18, s[48:51], s59 offen
  s_mov_b32 s60, 3424256
  buffer_load_dword v34, v18, s[48:51], s60 offen
  s_mov_b32 s61, 3432448
  buffer_load_dword v35, v18, s[48:51], s61 offen
  s_mov_b32 s58, 3440640
  buffer_load_dword v36, v18, s[48:51], s58 offen
  s_mov_b32 s59, 3448832
  buffer_load_dword v37, v18, s[48:51], s59 offen
  s_mov_b32 s60, 3457024
  buffer_load_dword v38, v18, s[48:51], s60 offen
  s_mov_b32 s61, 3465216
  buffer_load_dword v39, v18, s[48:51], s61 offen
  s_waitcnt vmcnt(63)
  v_perm_b32 v120, v41, v40, s70
  v_accvgpr_write_b32 a8, v120
  s_waitcnt vmcnt(63)
  v_perm_b32 v122, v43, v42, s70
  v_accvgpr_write_b32 a9, v122
  s_waitcnt vmcnt(63)
  v_perm_b32 v120, v45, v44, s70
  v_accvgpr_write_b32 a10, v120
  s_waitcnt vmcnt(63)
  v_perm_b32 v122, v47, v46, s70
  v_accvgpr_write_b32 a11, v122
  v_perm_b32 v121, v41, v40, s71
  v_accvgpr_write_b32 a72, v121
  v_perm_b32 v123, v43, v42, s71
  v_accvgpr_write_b32 a73, v123
  v_perm_b32 v121, v45, v44, s71
  v_accvgpr_write_b32 a74, v121
  v_perm_b32 v123, v47, v46, s71
  v_accvgpr_write_b32 a75, v123
  s_waitcnt vmcnt(63)
  v_perm_b32 v120, v49, v48, s70
  v_accvgpr_write_b32 a12, v120
  s_waitcnt vmcnt(63)
  v_perm_b32 v122, v51, v50, s70
  v_accvgpr_write_b32 a13, v122
  s_waitcnt vmcnt(63)
  v_perm_b32 v120, v53, v52, s70
  v_accvgpr_write_b32 a14, v120
  s_waitcnt vmcnt(63)
  v_perm_b32 v122, v55, v54, s70
  v_accvgpr_write_b32 a15, v122
  v_perm_b32 v121, v49, v48, s71
  v_accvgpr_write_b32 a76, v121
  v_perm_b32 v123, v51, v50, s71
  v_accvgpr_write_b32 a77, v123
  v_perm_b32 v121, v53, v52, s71
  v_accvgpr_write_b32 a78, v121
  v_perm_b32 v123, v55, v54, s71
  v_accvgpr_write_b32 a79, v123
  s_mov_b32 s58, 3670016
  buffer_load_dword v40, v18, s[48:51], s58 offen
  s_mov_b32 s59, 3678208
  buffer_load_dword v41, v18, s[48:51], s59 offen
  s_mov_b32 s60, 3686400
  buffer_load_dword v42, v18, s[48:51], s60 offen
  s_mov_b32 s61, 3694592
  buffer_load_dword v43, v18, s[48:51], s61 offen
  s_mov_b32 s58, 3702784
  buffer_load_dword v44, v18, s[48:51], s58 offen
  s_mov_b32 s59, 3710976
  buffer_load_dword v45, v18, s[48:51], s59 offen
  s_mov_b32 s60, 3719168
  buffer_load_dword v46, v18, s[48:51], s60 offen
  s_mov_b32 s61, 3727360
  buffer_load_dword v47, v18, s[48:51], s61 offen
  s_mov_b32 s58, 3932160
  buffer_load_dword v48, v18, s[48:51], s58 offen
  s_mov_b32 s59, 3940352
  buffer_load_dword v49, v18, s[48:51], s59 offen
  s_mov_b32 s60, 3948544
  buffer_load_dword v50, v18, s[48:51], s60 offen
  s_mov_b32 s61, 3956736
  buffer_load_dword v51, v18, s[48:51], s61 offen
  s_mov_b32 s58, 3964928
  buffer_load_dword v52, v18, s[48:51], s58 offen
  s_mov_b32 s59, 3973120
  buffer_load_dword v53, v18, s[48:51], s59 offen
  s_mov_b32 s60, 3981312
  buffer_load_dword v54, v18, s[48:51], s60 offen
  s_mov_b32 s61, 3989504
  buffer_load_dword v55, v18, s[48:51], s61 offen
  s_waitcnt vmcnt(63)
  v_perm_b32 v120, v57, v56, s70
  v_accvgpr_write_b32 a16, v120
  s_waitcnt vmcnt(63)
  v_perm_b32 v122, v59, v58, s70
  v_accvgpr_write_b32 a17, v122
  s_waitcnt vmcnt(63)
  v_perm_b32 v120, v61, v60, s70
  v_accvgpr_write_b32 a18, v120
  s_waitcnt vmcnt(63)
  v_perm_b32 v122, v63, v62, s70
  v_accvgpr_write_b32 a19, v122
  v_perm_b32 v121, v57, v56, s71
  v_accvgpr_write_b32 a80, v121
  v_perm_b32 v123, v59, v58, s71
  v_accvgpr_write_b32 a81, v123
  v_perm_b32 v121, v61, v60, s71
  v_accvgpr_write_b32 a82, v121
  v_perm_b32 v123, v63, v62, s71
  v_accvgpr_write_b32 a83, v123
  s_waitcnt vmcnt(63)
  v_perm_b32 v120, v65, v64, s70
  v_accvgpr_write_b32 a20, v120
  s_waitcnt vmcnt(63)
  v_perm_b32 v122, v67, v66, s70
  v_accvgpr_write_b32 a21, v122
  s_waitcnt vmcnt(63)
  v_perm_b32 v120, v69, v68, s70
  v_accvgpr_write_b32 a22, v120
  s_waitcnt vmcnt(63)
  v_perm_b32 v122, v71, v70, s70
  v_accvgpr_write_b32 a23, v122
  v_perm_b32 v121, v65, v64, s71
  v_accvgpr_write_b32 a84, v121
  v_perm_b32 v123, v67, v66, s71
  v_accvgpr_write_b32 a85, v123
  v_perm_b32 v121, v69, v68, s71
  v_accvgpr_write_b32 a86, v121
  v_perm_b32 v123, v71, v70, s71
  v_accvgpr_write_b32 a87, v123
  s_waitcnt vmcnt(63)
  v_perm_b32 v120, v73, v72, s70
  v_accvgpr_write_b32 a24, v120
  s_waitcnt vmcnt(63)
  v_perm_b32 v122, v75, v74, s70
  v_accvgpr_write_b32 a25, v122
  s_waitcnt vmcnt(63)
  v_perm_b32 v120, v77, v76, s70
  v_accvgpr_write_b32 a26, v120
  s_waitcnt vmcnt(63)
  v_perm_b32 v122, v79, v78, s70
  v_accvgpr_write_b32 a27, v122
  v_perm_b32 v121, v73, v72, s71
  v_accvgpr_write_b32 a88, v121
  v_perm_b32 v123, v75, v74, s71
  v_accvgpr_write_b32 a89, v123
  v_perm_b32 v121, v77, v76, s71
  v_accvgpr_write_b32 a90, v121
  v_perm_b32 v123, v79, v78, s71
  v_accvgpr_write_b32 a91, v123
  s_waitcnt vmcnt(63)
  v_perm_b32 v120, v81, v80, s70
  v_accvgpr_write_b32 a28, v120
  s_waitcnt vmcnt(63)
  v_perm_b32 v122, v83, v82, s70
  v_accvgpr_write_b32 a29, v122
  s_waitcnt vmcnt(63)
  v_perm_b32 v120, v85, v84, s70
  v_accvgpr_write_b32 a30, v120
  s_waitcnt vmcnt(63)
  v_perm_b32 v122, v87, v86, s70
  v_accvgpr_write_b32 a31, v122
  v_perm_b32 v121, v81, v80, s71
  v_accvgpr_write_b32 a92, v121
  v_perm_b32 v123, v83, v82, s71
  v_accvgpr_write_b32 a93, v123
  v_perm_b32 v121, v85, v84, s71
  v_accvgpr_write_b32 a94, v121
  v_perm_b32 v123, v87, v86, s71
  v_accvgpr_write_b32 a95, v123
  s_waitcnt vmcnt(62)
  v_perm_b32 v120, v89, v88, s70
  v_accvgpr_write_b32 a32, v120
  s_waitcnt vmcnt(60)
  v_perm_b32 v122, v91, v90, s70
  v_accvgpr_write_b32 a33, v122
  s_waitcnt vmcnt(58)
  v_perm_b32 v120, v93, v92, s70
  v_accvgpr_write_b32 a34, v120
  s_waitcnt vmcnt(56)
  v_perm_b32 v122, v95, v94, s70
  v_accvgpr_write_b32 a35, v122
  v_perm_b32 v121, v89, v88, s71
  v_accvgpr_write_b32 a96, v121
  v_perm_b32 v123, v91, v90, s71
  v_accvgpr_write_b32 a97, v123
  v_perm_b32 v121, v93, v92, s71
  v_accvgpr_write_b32 a98, v121
  v_perm_b32 v123, v95, v94, s71
  v_accvgpr_write_b32 a99, v123
  s_waitcnt vmcnt(54)
  v_perm_b32 v120, v97, v96, s70
  v_accvgpr_write_b32 a36, v120
  s_waitcnt vmcnt(52)
  v_perm_b32 v122, v99, v98, s70
  v_accvgpr_write_b32 a37, v122
  s_waitcnt vmcnt(50)
  v_perm_b32 v120, v101, v100, s70
  v_accvgpr_write_b32 a38, v120
  s_waitcnt vmcnt(48)
  v_perm_b32 v122, v103, v102, s70
  v_accvgpr_write_b32 a39, v122
  v_perm_b32 v121, v97, v96, s71
  v_accvgpr_write_b32 a100, v121
  v_perm_b32 v123, v99, v98, s71
  v_accvgpr_write_b32 a101, v123
  v_perm_b32 v121, v101, v100, s71
  v_accvgpr_write_b32 a102, v121
  v_perm_b32 v123, v103, v102, s71
  v_accvgpr_write_b32 a103, v123
  s_waitcnt vmcnt(46)
  v_perm_b32 v120, v105, v104, s70
  v_accvgpr_write_b32 a40, v120
  s_waitcnt vmcnt(44)
  v_perm_b32 v122, v107, v106, s70
  v_accvgpr_write_b32 a41, v122
  s_waitcnt vmcnt(42)
  v_perm_b32 v120, v109, v108, s70
  v_accvgpr_write_b32 a42, v120
  s_waitcnt vmcnt(40)
  v_perm_b32 v122, v111, v110, s70
  v_accvgpr_write_b32 a43, v122
  v_perm_b32 v121, v105, v104, s71
  v_accvgpr_write_b32 a104, v121
  v_perm_b32 v123, v107, v106, s71
  v_accvgpr_write_b32 a105, v123
  v_perm_b32 v121, v109, v108, s71
  v_accvgpr_write_b32 a106, v121
  v_perm_b32 v123, v111, v110, s71
  v_accvgpr_write_b32 a107, v123
  s_waitcnt vmcnt(38)
  v_perm_b32 v120, v113, v112, s70
  v_accvgpr_write_b32 a44, v120
  s_waitcnt vmcnt(36)
  v_perm_b32 v122, v115, v114, s70
  v_accvgpr_write_b32 a45, v122
  s_waitcnt vmcnt(34)
  v_perm_b32 v120, v117, v116, s70
  v_accvgpr_write_b32 a46, v120
  s_waitcnt vmcnt(32)
  v_perm_b32 v122, v119, v118, s70
  v_accvgpr_write_b32 a47, v122
  v_perm_b32 v121, v113, v112, s71
  v_accvgpr_write_b32 a108, v121
  v_perm_b32 v123, v115, v114, s71
  v_accvgpr_write_b32 a109, v123
  v_perm_b32 v121, v117, v116, s71
  v_accvgpr_write_b32 a110, v121
  v_perm_b32 v123, v119, v118, s71
  v_accvgpr_write_b32 a111, v123
  s_waitcnt vmcnt(30)
  v_perm_b32 v120, v25, v24, s70
  v_accvgpr_write_b32 a48, v120
  s_waitcnt vmcnt(28)
  v_perm_b32 v122, v27, v26, s70
  v_accvgpr_write_b32 a49, v122
  s_waitcnt vmcnt(26)
  v_perm_b32 v120, v29, v28, s70
  v_accvgpr_write_b32 a50, v120
  s_waitcnt vmcnt(24)
  v_perm_b32 v122, v31, v30, s70
  v_accvgpr_write_b32 a51, v122
  v_perm_b32 v121, v25, v24, s71
  v_accvgpr_write_b32 a112, v121
  v_perm_b32 v123, v27, v26, s71
  v_accvgpr_write_b32 a113, v123
  v_perm_b32 v121, v29, v28, s71
  v_accvgpr_write_b32 a114, v121
  v_perm_b32 v123, v31, v30, s71
  v_accvgpr_write_b32 a115, v123
  s_waitcnt vmcnt(22)
  v_perm_b32 v120, v33, v32, s70
  v_accvgpr_write_b32 a52, v120
  s_waitcnt vmcnt(20)
  v_perm_b32 v122, v35, v34, s70
  v_accvgpr_write_b32 a53, v122
  s_waitcnt vmcnt(18)
  v_perm_b32 v120, v37, v36, s70
  v_accvgpr_write_b32 a54, v120
  s_waitcnt vmcnt(16)
  v_perm_b32 v122, v39, v38, s70
  v_accvgpr_write_b32 a55, v122
  v_perm_b32 v121, v33, v32, s71
  v_accvgpr_write_b32 a116, v121
  v_perm_b32 v123, v35, v34, s71
  v_accvgpr_write_b32 a117, v123
  v_perm_b32 v121, v37, v36, s71
  v_accvgpr_write_b32 a118, v121
  v_perm_b32 v123, v39, v38, s71
  v_accvgpr_write_b32 a119, v123
  s_waitcnt vmcnt(14)
  v_perm_b32 v120, v41, v40, s70
  v_accvgpr_write_b32 a56, v120
  s_waitcnt vmcnt(12)
  v_perm_b32 v122, v43, v42, s70
  v_accvgpr_write_b32 a57, v122
  s_waitcnt vmcnt(10)
  v_perm_b32 v120, v45, v44, s70
  v_accvgpr_write_b32 a58, v120
  s_waitcnt vmcnt(8)
  v_perm_b32 v122, v47, v46, s70
  v_accvgpr_write_b32 a59, v122
  v_perm_b32 v121, v41, v40, s71
  v_accvgpr_write_b32 a120, v121
  v_perm_b32 v123, v43, v42, s71
  v_accvgpr_write_b32 a121, v123
  v_perm_b32 v121, v45, v44, s71
  v_accvgpr_write_b32 a122, v121
  v_perm_b32 v123, v47, v46, s71
  v_accvgpr_write_b32 a123, v123
  s_waitcnt vmcnt(6)
  v_perm_b32 v120, v49, v48, s70
  v_accvgpr_write_b32 a60, v120
  s_waitcnt vmcnt(4)
  v_perm_b32 v122, v51, v50, s70
  v_accvgpr_write_b32 a61, v122
  s_waitcnt vmcnt(2)
  v_perm_b32 v120, v53, v52, s70
  v_accvgpr_write_b32 a62, v120
  s_waitcnt vmcnt(0)
  v_perm_b32 v122, v55, v54, s70
  v_accvgpr_write_b32 a63, v122
  v_perm_b32 v121, v49, v48, s71
  v_accvgpr_write_b32 a124, v121
  v_perm_b32 v123, v51, v50, s71
  v_accvgpr_write_b32 a125, v123
  v_perm_b32 v121, v53, v52, s71
  v_accvgpr_write_b32 a126, v121
  v_perm_b32 v123, v55, v54, s71
  v_accvgpr_write_b32 a127, v123
  s_load_dwordx2 s[48:49], s[0:1], 16
  s_waitcnt lgkmcnt(0)
  s_mov_b32 s50, 4194304
  s_mov_b32 s51, 0x20000
  v_and_b32 v16, 15, v1
  v_lshrrev_b32 v17, 4, v1
  v_lshlrev_b32 v18, 16, v17
  v_lshlrev_b32 v19, 2, v16
  v_add_u32 v18, v18, v19
  s_lshl_b32 s56, s21, 8
  s_lshl_b32 s57, s9, 6
  s_add_u32 s56, s56, s57
  v_add_u32 v18, s56, v18
  s_mov_b32 s70, 0x05040100
  s_mov_b32 s71, 0x07060302
  s_mov_b32 s58, 0
  buffer_load_dword v24, v18, s[48:51], s58 offen
  s_mov_b32 s59, 8192
  buffer_load_dword v25, v18, s[48:51], s59 offen
  s_mov_b32 s60, 16384
  buffer_load_dword v26, v18, s[48:51], s60 offen
  s_mov_b32 s61, 24576
  buffer_load_dword v27, v18, s[48:51], s61 offen
  s_mov_b32 s58, 32768
  buffer_load_dword v28, v18, s[48:51], s58 offen
  s_mov_b32 s59, 40960
  buffer_load_dword v29, v18, s[48:51], s59 offen
  s_mov_b32 s60, 49152
  buffer_load_dword v30, v18, s[48:51], s60 offen
  s_mov_b32 s61, 57344
  buffer_load_dword v31, v18, s[48:51], s61 offen
  s_mov_b32 s58, 262144
  buffer_load_dword v32, v18, s[48:51], s58 offen
  s_mov_b32 s59, 270336
  buffer_load_dword v33, v18, s[48:51], s59 offen
  s_mov_b32 s60, 278528
  buffer_load_dword v34, v18, s[48:51], s60 offen
  s_mov_b32 s61, 286720
  buffer_load_dword v35, v18, s[48:51], s61 offen
  s_mov_b32 s58, 294912
  buffer_load_dword v36, v18, s[48:51], s58 offen
  s_mov_b32 s59, 303104
  buffer_load_dword v37, v18, s[48:51], s59 offen
  s_mov_b32 s60, 311296
  buffer_load_dword v38, v18, s[48:51], s60 offen
  s_mov_b32 s61, 319488
  buffer_load_dword v39, v18, s[48:51], s61 offen
  s_mov_b32 s58, 524288
  buffer_load_dword v40, v18, s[48:51], s58 offen
  s_mov_b32 s59, 532480
  buffer_load_dword v41, v18, s[48:51], s59 offen
  s_mov_b32 s60, 540672
  buffer_load_dword v42, v18, s[48:51], s60 offen
  s_mov_b32 s61, 548864
  buffer_load_dword v43, v18, s[48:51], s61 offen
  s_mov_b32 s58, 557056
  buffer_load_dword v44, v18, s[48:51], s58 offen
  s_mov_b32 s59, 565248
  buffer_load_dword v45, v18, s[48:51], s59 offen
  s_mov_b32 s60, 573440
  buffer_load_dword v46, v18, s[48:51], s60 offen
  s_mov_b32 s61, 581632
  buffer_load_dword v47, v18, s[48:51], s61 offen
  s_mov_b32 s58, 786432
  buffer_load_dword v48, v18, s[48:51], s58 offen
  s_mov_b32 s59, 794624
  buffer_load_dword v49, v18, s[48:51], s59 offen
  s_mov_b32 s60, 802816
  buffer_load_dword v50, v18, s[48:51], s60 offen
  s_mov_b32 s61, 811008
  buffer_load_dword v51, v18, s[48:51], s61 offen
  s_mov_b32 s58, 819200
  buffer_load_dword v52, v18, s[48:51], s58 offen
  s_mov_b32 s59, 827392
  buffer_load_dword v53, v18, s[48:51], s59 offen
  s_mov_b32 s60, 835584
  buffer_load_dword v54, v18, s[48:51], s60 offen
  s_mov_b32 s61, 843776
  buffer_load_dword v55, v18, s[48:51], s61 offen
  s_mov_b32 s58, 1048576
  buffer_load_dword v56, v18, s[48:51], s58 offen
  s_mov_b32 s59, 1056768
  buffer_load_dword v57, v18, s[48:51], s59 offen
  s_mov_b32 s60, 1064960
  buffer_load_dword v58, v18, s[48:51], s60 offen
  s_mov_b32 s61, 1073152
  buffer_load_dword v59, v18, s[48:51], s61 offen
  s_mov_b32 s58, 1081344
  buffer_load_dword v60, v18, s[48:51], s58 offen
  s_mov_b32 s59, 1089536
  buffer_load_dword v61, v18, s[48:51], s59 offen
  s_mov_b32 s60, 1097728
  buffer_load_dword v62, v18, s[48:51], s60 offen
  s_mov_b32 s61, 1105920
  buffer_load_dword v63, v18, s[48:51], s61 offen
  s_mov_b32 s58, 1310720
  buffer_load_dword v64, v18, s[48:51], s58 offen
  s_mov_b32 s59, 1318912
  buffer_load_dword v65, v18, s[48:51], s59 offen
  s_mov_b32 s60, 1327104
  buffer_load_dword v66, v18, s[48:51], s60 offen
  s_mov_b32 s61, 1335296
  buffer_load_dword v67, v18, s[48:51], s61 offen
  s_mov_b32 s58, 1343488
  buffer_load_dword v68, v18, s[48:51], s58 offen
  s_mov_b32 s59, 1351680
  buffer_load_dword v69, v18, s[48:51], s59 offen
  s_mov_b32 s60, 1359872
  buffer_load_dword v70, v18, s[48:51], s60 offen
  s_mov_b32 s61, 1368064
  buffer_load_dword v71, v18, s[48:51], s61 offen
  s_mov_b32 s58, 1572864
  buffer_load_dword v72, v18, s[48:51], s58 offen
  s_mov_b32 s59, 1581056
  buffer_load_dword v73, v18, s[48:51], s59 offen
  s_mov_b32 s60, 1589248
  buffer_load_dword v74, v18, s[48:51], s60 offen
  s_mov_b32 s61, 1597440
  buffer_load_dword v75, v18, s[48:51], s61 offen
  s_mov_b32 s58, 1605632
  buffer_load_dword v76, v18, s[48:51], s58 offen
  s_mov_b32 s59, 1613824
  buffer_load_dword v77, v18, s[48:51], s59 offen
  s_mov_b32 s60, 1622016
  buffer_load_dword v78, v18, s[48:51], s60 offen
  s_mov_b32 s61, 1630208
  buffer_load_dword v79, v18, s[48:51], s61 offen
  s_mov_b32 s58, 1835008
  buffer_load_dword v80, v18, s[48:51], s58 offen
  s_mov_b32 s59, 1843200
  buffer_load_dword v81, v18, s[48:51], s59 offen
  s_mov_b32 s60, 1851392
  buffer_load_dword v82, v18, s[48:51], s60 offen
  s_mov_b32 s61, 1859584
  buffer_load_dword v83, v18, s[48:51], s61 offen
  s_mov_b32 s58, 1867776
  buffer_load_dword v84, v18, s[48:51], s58 offen
  s_mov_b32 s59, 1875968
  buffer_load_dword v85, v18, s[48:51], s59 offen
  s_mov_b32 s60, 1884160
  buffer_load_dword v86, v18, s[48:51], s60 offen
  s_mov_b32 s61, 1892352
  buffer_load_dword v87, v18, s[48:51], s61 offen
  s_mov_b32 s58, 2097152
  buffer_load_dword v88, v18, s[48:51], s58 offen
  s_mov_b32 s59, 2105344
  buffer_load_dword v89, v18, s[48:51], s59 offen
  s_mov_b32 s60, 2113536
  buffer_load_dword v90, v18, s[48:51], s60 offen
  s_mov_b32 s61, 2121728
  buffer_load_dword v91, v18, s[48:51], s61 offen
  s_mov_b32 s58, 2129920
  buffer_load_dword v92, v18, s[48:51], s58 offen
  s_mov_b32 s59, 2138112
  buffer_load_dword v93, v18, s[48:51], s59 offen
  s_mov_b32 s60, 2146304
  buffer_load_dword v94, v18, s[48:51], s60 offen
  s_mov_b32 s61, 2154496
  buffer_load_dword v95, v18, s[48:51], s61 offen
  s_mov_b32 s58, 2359296
  buffer_load_dword v96, v18, s[48:51], s58 offen
  s_mov_b32 s59, 2367488
  buffer_load_dword v97, v18, s[48:51], s59 offen
  s_mov_b32 s60, 2375680
  buffer_load_dword v98, v18, s[48:51], s60 offen
  s_mov_b32 s61, 2383872
  buffer_load_dword v99, v18, s[48:51], s61 offen
  s_mov_b32 s58, 2392064
  buffer_load_dword v100, v18, s[48:51], s58 offen
  s_mov_b32 s59, 2400256
  buffer_load_dword v101, v18, s[48:51], s59 offen
  s_mov_b32 s60, 2408448
  buffer_load_dword v102, v18, s[48:51], s60 offen
  s_mov_b32 s61, 2416640
  buffer_load_dword v103, v18, s[48:51], s61 offen
  s_mov_b32 s58, 2621440
  buffer_load_dword v104, v18, s[48:51], s58 offen
  s_mov_b32 s59, 2629632
  buffer_load_dword v105, v18, s[48:51], s59 offen
  s_mov_b32 s60, 2637824
  buffer_load_dword v106, v18, s[48:51], s60 offen
  s_mov_b32 s61, 2646016
  buffer_load_dword v107, v18, s[48:51], s61 offen
  s_mov_b32 s58, 2654208
  buffer_load_dword v108, v18, s[48:51], s58 offen
  s_mov_b32 s59, 2662400
  buffer_load_dword v109, v18, s[48:51], s59 offen
  s_mov_b32 s60, 2670592
  buffer_load_dword v110, v18, s[48:51], s60 offen
  s_mov_b32 s61, 2678784
  buffer_load_dword v111, v18, s[48:51], s61 offen
  s_mov_b32 s58, 2883584
  buffer_load_dword v112, v18, s[48:51], s58 offen
  s_mov_b32 s59, 2891776
  buffer_load_dword v113, v18, s[48:51], s59 offen
  s_mov_b32 s60, 2899968
  buffer_load_dword v114, v18, s[48:51], s60 offen
  s_mov_b32 s61, 2908160
  buffer_load_dword v115, v18, s[48:51], s61 offen
  s_mov_b32 s58, 2916352
  buffer_load_dword v116, v18, s[48:51], s58 offen
  s_mov_b32 s59, 2924544
  buffer_load_dword v117, v18, s[48:51], s59 offen
  s_mov_b32 s60, 2932736
  buffer_load_dword v118, v18, s[48:51], s60 offen
  s_mov_b32 s61, 2940928
  buffer_load_dword v119, v18, s[48:51], s61 offen
  s_waitcnt vmcnt(63)
  v_perm_b32 v120, v25, v24, s70
  v_accvgpr_write_b32 a128, v120
  s_waitcnt vmcnt(63)
  v_perm_b32 v122, v27, v26, s70
  v_accvgpr_write_b32 a129, v122
  s_waitcnt vmcnt(63)
  v_perm_b32 v120, v29, v28, s70
  v_accvgpr_write_b32 a130, v120
  s_waitcnt vmcnt(63)
  v_perm_b32 v122, v31, v30, s70
  v_accvgpr_write_b32 a131, v122
  v_perm_b32 v121, v25, v24, s71
  v_accvgpr_write_b32 a192, v121
  v_perm_b32 v123, v27, v26, s71
  v_accvgpr_write_b32 a193, v123
  v_perm_b32 v121, v29, v28, s71
  v_accvgpr_write_b32 a194, v121
  v_perm_b32 v123, v31, v30, s71
  v_accvgpr_write_b32 a195, v123
  s_waitcnt vmcnt(63)
  v_perm_b32 v120, v33, v32, s70
  v_accvgpr_write_b32 a132, v120
  s_waitcnt vmcnt(63)
  v_perm_b32 v122, v35, v34, s70
  v_accvgpr_write_b32 a133, v122
  s_waitcnt vmcnt(63)
  v_perm_b32 v120, v37, v36, s70
  v_accvgpr_write_b32 a134, v120
  s_waitcnt vmcnt(63)
  v_perm_b32 v122, v39, v38, s70
  v_accvgpr_write_b32 a135, v122
  v_perm_b32 v121, v33, v32, s71
  v_accvgpr_write_b32 a196, v121
  v_perm_b32 v123, v35, v34, s71
  v_accvgpr_write_b32 a197, v123
  v_perm_b32 v121, v37, v36, s71
  v_accvgpr_write_b32 a198, v121
  v_perm_b32 v123, v39, v38, s71
  v_accvgpr_write_b32 a199, v123
  s_mov_b32 s58, 3145728
  buffer_load_dword v24, v18, s[48:51], s58 offen
  s_mov_b32 s59, 3153920
  buffer_load_dword v25, v18, s[48:51], s59 offen
  s_mov_b32 s60, 3162112
  buffer_load_dword v26, v18, s[48:51], s60 offen
  s_mov_b32 s61, 3170304
  buffer_load_dword v27, v18, s[48:51], s61 offen
  s_mov_b32 s58, 3178496
  buffer_load_dword v28, v18, s[48:51], s58 offen
  s_mov_b32 s59, 3186688
  buffer_load_dword v29, v18, s[48:51], s59 offen
  s_mov_b32 s60, 3194880
  buffer_load_dword v30, v18, s[48:51], s60 offen
  s_mov_b32 s61, 3203072
  buffer_load_dword v31, v18, s[48:51], s61 offen
  s_mov_b32 s58, 3407872
  buffer_load_dword v32, v18, s[48:51], s58 offen
  s_mov_b32 s59, 3416064
  buffer_load_dword v33, v18, s[48:51], s59 offen
  s_mov_b32 s60, 3424256
  buffer_load_dword v34, v18, s[48:51], s60 offen
  s_mov_b32 s61, 3432448
  buffer_load_dword v35, v18, s[48:51], s61 offen
  s_mov_b32 s58, 3440640
  buffer_load_dword v36, v18, s[48:51], s58 offen
  s_mov_b32 s59, 3448832
  buffer_load_dword v37, v18, s[48:51], s59 offen
  s_mov_b32 s60, 3457024
  buffer_load_dword v38, v18, s[48:51], s60 offen
  s_mov_b32 s61, 3465216
  buffer_load_dword v39, v18, s[48:51], s61 offen
  s_waitcnt vmcnt(63)
  v_perm_b32 v120, v41, v40, s70
  v_accvgpr_write_b32 a136, v120
  s_waitcnt vmcnt(63)
  v_perm_b32 v122, v43, v42, s70
  v_accvgpr_write_b32 a137, v122
  s_waitcnt vmcnt(63)
  v_perm_b32 v120, v45, v44, s70
  v_accvgpr_write_b32 a138, v120
  s_waitcnt vmcnt(63)
  v_perm_b32 v122, v47, v46, s70
  v_accvgpr_write_b32 a139, v122
  v_perm_b32 v121, v41, v40, s71
  v_accvgpr_write_b32 a200, v121
  v_perm_b32 v123, v43, v42, s71
  v_accvgpr_write_b32 a201, v123
  v_perm_b32 v121, v45, v44, s71
  v_accvgpr_write_b32 a202, v121
  v_perm_b32 v123, v47, v46, s71
  v_accvgpr_write_b32 a203, v123
  s_waitcnt vmcnt(63)
  v_perm_b32 v120, v49, v48, s70
  v_accvgpr_write_b32 a140, v120
  s_waitcnt vmcnt(63)
  v_perm_b32 v122, v51, v50, s70
  v_accvgpr_write_b32 a141, v122
  s_waitcnt vmcnt(63)
  v_perm_b32 v120, v53, v52, s70
  v_accvgpr_write_b32 a142, v120
  s_waitcnt vmcnt(63)
  v_perm_b32 v122, v55, v54, s70
  v_accvgpr_write_b32 a143, v122
  v_perm_b32 v121, v49, v48, s71
  v_accvgpr_write_b32 a204, v121
  v_perm_b32 v123, v51, v50, s71
  v_accvgpr_write_b32 a205, v123
  v_perm_b32 v121, v53, v52, s71
  v_accvgpr_write_b32 a206, v121
  v_perm_b32 v123, v55, v54, s71
  v_accvgpr_write_b32 a207, v123
  s_mov_b32 s58, 3670016
  buffer_load_dword v40, v18, s[48:51], s58 offen
  s_mov_b32 s59, 3678208
  buffer_load_dword v41, v18, s[48:51], s59 offen
  s_mov_b32 s60, 3686400
  buffer_load_dword v42, v18, s[48:51], s60 offen
  s_mov_b32 s61, 3694592
  buffer_load_dword v43, v18, s[48:51], s61 offen
  s_mov_b32 s58, 3702784
  buffer_load_dword v44, v18, s[48:51], s58 offen
  s_mov_b32 s59, 3710976
  buffer_load_dword v45, v18, s[48:51], s59 offen
  s_mov_b32 s60, 3719168
  buffer_load_dword v46, v18, s[48:51], s60 offen
  s_mov_b32 s61, 3727360
  buffer_load_dword v47, v18, s[48:51], s61 offen
  s_mov_b32 s58, 3932160
  buffer_load_dword v48, v18, s[48:51], s58 offen
  s_mov_b32 s59, 3940352
  buffer_load_dword v49, v18, s[48:51], s59 offen
  s_mov_b32 s60, 3948544
  buffer_load_dword v50, v18, s[48:51], s60 offen
  s_mov_b32 s61, 3956736
  buffer_load_dword v51, v18, s[48:51], s61 offen
  s_mov_b32 s58, 3964928
  buffer_load_dword v52, v18, s[48:51], s58 offen
  s_mov_b32 s59, 3973120
  buffer_load_dword v53, v18, s[48:51], s59 offen
  s_mov_b32 s60, 3981312
  buffer_load_dword v54, v18, s[48:51], s60 offen
  s_mov_b32 s61, 3989504
  buffer_load_dword v55, v18, s[48:51], s61 offen
  s_waitcnt vmcnt(63)
  v_perm_b32 v120, v57, v56, s70
  v_accvgpr_write_b32 a144, v120
  s_waitcnt vmcnt(63)
  v_perm_b32 v122, v59, v58, s70
  v_accvgpr_write_b32 a145, v122
  s_waitcnt vmcnt(63)
  v_perm_b32 v120, v61, v60, s70
  v_accvgpr_write_b32 a146, v120
  s_waitcnt vmcnt(63)
  v_perm_b32 v122, v63, v62, s70
  v_accvgpr_write_b32 a147, v122
  v_perm_b32 v121, v57, v56, s71
  v_accvgpr_write_b32 a208, v121
  v_perm_b32 v123, v59, v58, s71
  v_accvgpr_write_b32 a209, v123
  v_perm_b32 v121, v61, v60, s71
  v_accvgpr_write_b32 a210, v121
  v_perm_b32 v123, v63, v62, s71
  v_accvgpr_write_b32 a211, v123
  s_waitcnt vmcnt(63)
  v_perm_b32 v120, v65, v64, s70
  v_accvgpr_write_b32 a148, v120
  s_waitcnt vmcnt(63)
  v_perm_b32 v122, v67, v66, s70
  v_accvgpr_write_b32 a149, v122
  s_waitcnt vmcnt(63)
  v_perm_b32 v120, v69, v68, s70
  v_accvgpr_write_b32 a150, v120
  s_waitcnt vmcnt(63)
  v_perm_b32 v122, v71, v70, s70
  v_accvgpr_write_b32 a151, v122
  v_perm_b32 v121, v65, v64, s71
  v_accvgpr_write_b32 a212, v121
  v_perm_b32 v123, v67, v66, s71
  v_accvgpr_write_b32 a213, v123
  v_perm_b32 v121, v69, v68, s71
  v_accvgpr_write_b32 a214, v121
  v_perm_b32 v123, v71, v70, s71
  v_accvgpr_write_b32 a215, v123
  s_waitcnt vmcnt(63)
  v_perm_b32 v120, v73, v72, s70
  v_accvgpr_write_b32 a152, v120
  s_waitcnt vmcnt(63)
  v_perm_b32 v122, v75, v74, s70
  v_accvgpr_write_b32 a153, v122
  s_waitcnt vmcnt(63)
  v_perm_b32 v120, v77, v76, s70
  v_accvgpr_write_b32 a154, v120
  s_waitcnt vmcnt(63)
  v_perm_b32 v122, v79, v78, s70
  v_accvgpr_write_b32 a155, v122
  v_perm_b32 v121, v73, v72, s71
  v_accvgpr_write_b32 a216, v121
  v_perm_b32 v123, v75, v74, s71
  v_accvgpr_write_b32 a217, v123
  v_perm_b32 v121, v77, v76, s71
  v_accvgpr_write_b32 a218, v121
  v_perm_b32 v123, v79, v78, s71
  v_accvgpr_write_b32 a219, v123
  s_waitcnt vmcnt(63)
  v_perm_b32 v120, v81, v80, s70
  v_accvgpr_write_b32 a156, v120
  s_waitcnt vmcnt(63)
  v_perm_b32 v122, v83, v82, s70
  v_accvgpr_write_b32 a157, v122
  s_waitcnt vmcnt(63)
  v_perm_b32 v120, v85, v84, s70
  v_accvgpr_write_b32 a158, v120
  s_waitcnt vmcnt(63)
  v_perm_b32 v122, v87, v86, s70
  v_accvgpr_write_b32 a159, v122
  v_perm_b32 v121, v81, v80, s71
  v_accvgpr_write_b32 a220, v121
  v_perm_b32 v123, v83, v82, s71
  v_accvgpr_write_b32 a221, v123
  v_perm_b32 v121, v85, v84, s71
  v_accvgpr_write_b32 a222, v121
  v_perm_b32 v123, v87, v86, s71
  v_accvgpr_write_b32 a223, v123
  s_waitcnt vmcnt(62)
  v_perm_b32 v120, v89, v88, s70
  v_accvgpr_write_b32 a160, v120
  s_waitcnt vmcnt(60)
  v_perm_b32 v122, v91, v90, s70
  v_accvgpr_write_b32 a161, v122
  s_waitcnt vmcnt(58)
  v_perm_b32 v120, v93, v92, s70
  v_accvgpr_write_b32 a162, v120
  s_waitcnt vmcnt(56)
  v_perm_b32 v122, v95, v94, s70
  v_accvgpr_write_b32 a163, v122
  v_perm_b32 v121, v89, v88, s71
  v_accvgpr_write_b32 a224, v121
  v_perm_b32 v123, v91, v90, s71
  v_accvgpr_write_b32 a225, v123
  v_perm_b32 v121, v93, v92, s71
  v_accvgpr_write_b32 a226, v121
  v_perm_b32 v123, v95, v94, s71
  v_accvgpr_write_b32 a227, v123
  s_waitcnt vmcnt(54)
  v_perm_b32 v120, v97, v96, s70
  v_accvgpr_write_b32 a164, v120
  s_waitcnt vmcnt(52)
  v_perm_b32 v122, v99, v98, s70
  v_accvgpr_write_b32 a165, v122
  s_waitcnt vmcnt(50)
  v_perm_b32 v120, v101, v100, s70
  v_accvgpr_write_b32 a166, v120
  s_waitcnt vmcnt(48)
  v_perm_b32 v122, v103, v102, s70
  v_accvgpr_write_b32 a167, v122
  v_perm_b32 v121, v97, v96, s71
  v_accvgpr_write_b32 a228, v121
  v_perm_b32 v123, v99, v98, s71
  v_accvgpr_write_b32 a229, v123
  v_perm_b32 v121, v101, v100, s71
  v_accvgpr_write_b32 a230, v121
  v_perm_b32 v123, v103, v102, s71
  v_accvgpr_write_b32 a231, v123
  s_waitcnt vmcnt(46)
  v_perm_b32 v120, v105, v104, s70
  v_accvgpr_write_b32 a168, v120
  s_waitcnt vmcnt(44)
  v_perm_b32 v122, v107, v106, s70
  v_accvgpr_write_b32 a169, v122
  s_waitcnt vmcnt(42)
  v_perm_b32 v120, v109, v108, s70
  v_accvgpr_write_b32 a170, v120
  s_waitcnt vmcnt(40)
  v_perm_b32 v122, v111, v110, s70
  v_accvgpr_write_b32 a171, v122
  v_perm_b32 v121, v105, v104, s71
  v_accvgpr_write_b32 a232, v121
  v_perm_b32 v123, v107, v106, s71
  v_accvgpr_write_b32 a233, v123
  v_perm_b32 v121, v109, v108, s71
  v_accvgpr_write_b32 a234, v121
  v_perm_b32 v123, v111, v110, s71
  v_accvgpr_write_b32 a235, v123
  s_waitcnt vmcnt(38)
  v_perm_b32 v120, v113, v112, s70
  v_accvgpr_write_b32 a172, v120
  s_waitcnt vmcnt(36)
  v_perm_b32 v122, v115, v114, s70
  v_accvgpr_write_b32 a173, v122
  s_waitcnt vmcnt(34)
  v_perm_b32 v120, v117, v116, s70
  v_accvgpr_write_b32 a174, v120
  s_waitcnt vmcnt(32)
  v_perm_b32 v122, v119, v118, s70
  v_accvgpr_write_b32 a175, v122
  v_perm_b32 v121, v113, v112, s71
  v_accvgpr_write_b32 a236, v121
  v_perm_b32 v123, v115, v114, s71
  v_accvgpr_write_b32 a237, v123
  v_perm_b32 v121, v117, v116, s71
  v_accvgpr_write_b32 a238, v121
  v_perm_b32 v123, v119, v118, s71
  v_accvgpr_write_b32 a239, v123
  s_waitcnt vmcnt(30)
  v_perm_b32 v120, v25, v24, s70
  v_accvgpr_write_b32 a176, v120
  s_waitcnt vmcnt(28)
  v_perm_b32 v122, v27, v26, s70
  v_accvgpr_write_b32 a177, v122
  s_waitcnt vmcnt(26)
  v_perm_b32 v120, v29, v28, s70
  v_accvgpr_write_b32 a178, v120
  s_waitcnt vmcnt(24)
  v_perm_b32 v122, v31, v30, s70
  v_accvgpr_write_b32 a179, v122
  v_perm_b32 v121, v25, v24, s71
  v_accvgpr_write_b32 a240, v121
  v_perm_b32 v123, v27, v26, s71
  v_accvgpr_write_b32 a241, v123
  v_perm_b32 v121, v29, v28, s71
  v_accvgpr_write_b32 a242, v121
  v_perm_b32 v123, v31, v30, s71
  v_accvgpr_write_b32 a243, v123
  s_waitcnt vmcnt(22)
  v_perm_b32 v120, v33, v32, s70
  v_accvgpr_write_b32 a180, v120
  s_waitcnt vmcnt(20)
  v_perm_b32 v122, v35, v34, s70
  v_accvgpr_write_b32 a181, v122
  s_waitcnt vmcnt(18)
  v_perm_b32 v120, v37, v36, s70
  v_accvgpr_write_b32 a182, v120
  s_waitcnt vmcnt(16)
  v_perm_b32 v122, v39, v38, s70
  v_accvgpr_write_b32 a183, v122
  v_perm_b32 v121, v33, v32, s71
  v_accvgpr_write_b32 a244, v121
  v_perm_b32 v123, v35, v34, s71
  v_accvgpr_write_b32 a245, v123
  v_perm_b32 v121, v37, v36, s71
  v_accvgpr_write_b32 a246, v121
  v_perm_b32 v123, v39, v38, s71
  v_accvgpr_write_b32 a247, v123
  s_waitcnt vmcnt(14)
  v_perm_b32 v120, v41, v40, s70
  v_accvgpr_write_b32 a184, v120
  s_waitcnt vmcnt(12)
  v_perm_b32 v122, v43, v42, s70
  v_accvgpr_write_b32 a185, v122
  s_waitcnt vmcnt(10)
  v_perm_b32 v120, v45, v44, s70
  v_accvgpr_write_b32 a186, v120
  s_waitcnt vmcnt(8)
  v_perm_b32 v122, v47, v46, s70
  v_accvgpr_write_b32 a187, v122
  v_perm_b32 v121, v41, v40, s71
  v_accvgpr_write_b32 a248, v121
  v_perm_b32 v123, v43, v42, s71
  v_accvgpr_write_b32 a249, v123
  v_perm_b32 v121, v45, v44, s71
  v_accvgpr_write_b32 a250, v121
  v_perm_b32 v123, v47, v46, s71
  v_accvgpr_write_b32 a251, v123
  s_waitcnt vmcnt(6)
  v_perm_b32 v120, v49, v48, s70
  v_accvgpr_write_b32 a188, v120
  s_waitcnt vmcnt(4)
  v_perm_b32 v122, v51, v50, s70
  v_accvgpr_write_b32 a189, v122
  s_waitcnt vmcnt(2)
  v_perm_b32 v120, v53, v52, s70
  v_accvgpr_write_b32 a190, v120
  s_waitcnt vmcnt(0)
  v_perm_b32 v122, v55, v54, s70
  v_accvgpr_write_b32 a191, v122
  v_perm_b32 v121, v49, v48, s71
  v_accvgpr_write_b32 a252, v121
  v_perm_b32 v123, v51, v50, s71
  v_accvgpr_write_b32 a253, v123
  v_perm_b32 v121, v53, v52, s71
  v_accvgpr_write_b32 a254, v121
  v_perm_b32 v123, v55, v54, s71
  v_accvgpr_write_b32 a255, v123
  s_lshl_b32 s56, s20, 19
  s_add_u32 s22, s56, 41943040
  s_add_u32 s23, s22, 524288
  s_lshl_b32 s17, s20, 7
  s_add_u32 s17, s17, 12288
  s_add_u32 s18, s17, 128
  v_lshlrev_b32 v6, 4, v1
  v_and_b32 v8, 15, v1
  v_lshlrev_b32 v7, 6, v8
  v_lshrrev_b32 v8, 4, v1
  v_lshlrev_b32 v8, 4, v8
  v_add_u32 v7, v7, v8
  s_lshl_b32 s56, s9, 11
  v_add_u32 v7, s56, v7
  v_cmp_eq_u32 vcc, 0, v1
  v_mov_b32 v10, 0x7ffffff0
  s_lshl_b32 s56, s9, 2
  v_mov_b32 v9, s56
  v_cndmask_b32 v9, v10, v9, vcc
  s_mov_b32 s10, 0
  s_mov_b32 s25, 0
  v_lshlrev_b32 v11, 7, v1
  s_mov_b32 s43, 0
  s_mov_b32 s30, 0
L_h1all4:
  buffer_load_dwordx2 v[12:13], v11, s[4:7], s30 offen sc1
  s_waitcnt vmcnt(0)
  v_min_u32 v12, v12, v13
  v_cmp_eq_u32 vcc, 0, v12
  s_cbranch_vccz L_h1all4d
  s_sleep 2
  s_add_u32 s43, s43, 1
  s_cmp_lt_u32 s43, 400000
  s_cbranch_scc1 L_h1all4
  s_branch L_bail
L_h1all4d:
  s_lshl_b32 s57, s10, 15
  s_lshl_b32 s58, s9, 13
  s_add_u32 s57, s57, s58
  s_add_u32 s57, s57, 1048576
  s_add_u32 s59, s25, s58
  s_add_u32 m0, s59, 0
  s_add_u32 s60, s57, 0
  buffer_load_dwordx4 v6, s[4:7], s60 offen sc1 lds
  s_add_u32 m0, s59, 1024
  s_add_u32 s60, s57, 1024
  buffer_load_dwordx4 v6, s[4:7], s60 offen sc1 lds
  s_add_u32 m0, s59, 2048
  s_add_u32 s60, s57, 2048
  buffer_load_dwordx4 v6, s[4:7], s60 offen sc1 lds
  s_add_u32 m0, s59, 3072
  s_add_u32 s60, s57, 3072
  buffer_load_dwordx4 v6, s[4:7], s60 offen sc1 lds
  s_add_u32 m0, s59, 4096
  s_add_u32 s60, s57, 4096
  buffer_load_dwordx4 v6, s[4:7], s60 offen sc1 lds
  s_add_u32 m0, s59, 5120
  s_add_u32 s60, s57, 5120
  buffer_load_dwordx4 v6, s[4:7], s60 offen sc1 lds
  s_add_u32 m0, s59, 6144
  s_add_u32 s60, s57, 6144
  buffer_load_dwordx4 v6, s[4:7], s60 offen sc1 lds
  s_add_u32 m0, s59, 7168
  s_add_u32 s60, s57, 7168
  buffer_load_dwordx4 v6, s[4:7], s60 offen sc1 lds
  s_waitcnt vmcnt(0)
L_pq_loop:
  s_waitcnt vmcnt(6)
  s_barrier
  s_add_u32 s28, s10, 1
  s_cmp_ge_u32 s28, 64
  s_cbranch_scc1 L_pq_nodma
  s_xor_b32 s29, s25, 32768
  s_lshl_b32 s57, s28, 15
  s_lshl_b32 s58, s9, 13
  s_add_u32 s57, s57, s58
  s_add_u32 s57, s57, 1048576
  s_add_u32 s59, s29, s58
  s_add_u32 m0, s59, 0
  s_add_u32 s60, s57, 0
  buffer_load_dwordx4 v6, s[4:7], s60 offen sc1 lds
  s_add_u32 m0, s59, 1024
  s_add_u32 s60, s57, 1024
  buffer_load_dwordx4 v6, s[4:7], s60 offen sc1 lds
  s_add_u32 m0, s59, 2048
  s_add_u32 s60, s57, 2048
  buffer_load_dwordx4 v6, s[4:7], s60 offen sc1 lds
  s_add_u32 m0, s59, 3072
  s_add_u32 s60, s57, 3072
  buffer_load_dwordx4 v6, s[4:7], s60 offen sc1 lds
  s_add_u32 m0, s59, 4096
  s_add_u32 s60, s57, 4096
  buffer_load_dwordx4 v6, s[4:7], s60 offen sc1 lds
  s_add_u32 m0, s59, 5120
  s_add_u32 s60, s57, 5120
  buffer_load_dwordx4 v6, s[4:7], s60 offen sc1 lds
  s_add_u32 m0, s59, 6144
  s_add_u32 s60, s57, 6144
  buffer_load_dwordx4 v6, s[4:7], s60 offen sc1 lds
  s_add_u32 m0, s59, 7168
  s_add_u32 s60, s57, 7168
  buffer_load_dwordx4 v6, s[4:7], s60 offen sc1 lds
L_pq_nodma:
  v_add_u32 v8, s25, v6
  ds_read_b128 v[16:19], v8 offset:0
  s_nop 2
  ds_read_b128 v[20:23], v8 offset:1024
  s_nop 2
  ds_read_b128 v[24:27], v8 offset:2048
  s_nop 2
  ds_read_b128 v[28:31], v8 offset:3072
  s_nop 2
  ds_read_b128 v[32:35], v8 offset:4096
  s_waitcnt lgkmcnt(4)
  v_mfma_f32_16x16x32_bf16 v[64:67], a[0:3], v[16:19], 0
  s_nop 0
  ds_read_b128 v[36:39], v8 offset:5120
  v_mfma_f32_16x16x32_bf16 v[68:71], a[64:67], v[16:19], 0
  s_nop 0
  ds_read_b128 v[40:43], v8 offset:6144
  v_mfma_f32_16x16x32_bf16 v[80:83], a[128:131], v[16:19], 0
  s_nop 0
  ds_read_b128 v[44:47], v8 offset:7168
  v_mfma_f32_16x16x32_bf16 v[84:87], a[192:195], v[16:19], 0
  s_nop 0
  ds_read_b128 v[16:19], v8 offset:8192
  s_waitcnt lgkmcnt(7)
  v_mfma_f32_16x16x32_bf16 v[64:67], a[4:7], v[20:23], v[64:67]
  v_mfma_f32_16x16x32_bf16 v[68:71], a[68:71], v[20:23], v[68:71]
  v_mfma_f32_16x16x32_bf16 v[80:83], a[132:135], v[20:23], v[80:83]
  v_mfma_f32_16x16x32_bf16 v[84:87], a[196:199], v[20:23], v[84:87]
  ds_read_b128 v[20:23], v8 offset:9216
  s_waitcnt lgkmcnt(7)
  v_mfma_f32_16x16x32_bf16 v[64:67], a[8:11], v[24:27], v[64:67]
  v_mfma_f32_16x16x32_bf16 v[68:71], a[72:75], v[24:27], v[68:71]
  v_mfma_f32_16x16x32_bf16 v[80:83], a[136:139], v[24:27], v[80:83]
  v_mfma_f32_16x16x32_bf16 v[84:87], a[200:203], v[24:27], v[84:87]
  ds_read_b128 v[24:27], v8 offset:10240
  s_waitcnt lgkmcnt(7)
  v_mfma_f32_16x16x32_bf16 v[64:67], a[12:15], v[28:31], v[64:67]
  v_mfma_f32_16x16x32_bf16 v[68:71], a[76:79], v[28:31], v[68:71]
  v_mfma_f32_16x16x32_bf16 v[80:83], a[140:143], v[28:31], v[80:83]
  v_mfma_f32_16x16x32_bf16 v[84:87], a[204:207], v[28:31], v[84:87]
  ds_read_b128 v[28:31], v8 offset:11264
  s_waitcnt lgkmcnt(7)
  v_mfma_f32_16x16x32_bf16 v[64:67], a[16:19], v[32:35], v[64:67]
  v_mfma_f32_16x16x32_bf16 v[68:71], a[80:83], v[32:35], v[68:71]
  v_mfma_f32_16x16x32_bf16 v[80:83], a[144:147], v[32:35], v[80:83]
  v_mfma_f32_16x16x32_bf16 v[84:87], a[208:211], v[32:35], v[84:87]
  ds_read_b128 v[32:35], v8 offset:12288
  s_waitcnt lgkmcnt(7)
  v_mfma_f32_16x16x32_bf16 v[64:67], a[20:23], v[36:39], v[64:67]
  v_mfma_f32_16x16x32_bf16 v[68:71], a[84:87], v[36:39], v[68:71]
  v_mfma_f32_16x16x32_bf16 v[80:83], a[148:151], v[36:39], v[80:83]
  v_mfma_f32_16x16x32_bf16 v[84:87], a[212:215], v[36:39], v[84:87]
  ds_read_b128 v[36:39], v8 offset:13312
  s_waitcnt lgkmcnt(7)
  v_mfma_f32_16x16x32_bf16 v[64:67], a[24:27], v[40:43], v[64:67]
  v_mfma_f32_16x16x32_bf16 v[68:71], a[88:91], v[40:43], v[68:71]
  v_mfma_f32_16x16x32_bf16 v[80:83], a[152:155], v[40:43], v[80:83]
  v_mfma_f32_16x16x32_bf16 v[84:87], a[216:219], v[40:43], v[84:87]
  ds_read_b128 v[40:43], v8 offset:14336
  s_waitcnt lgkmcnt(7)
  v_mfma_f32_16x16x32_bf16 v[64:67], a[28:31], v[44:47], v[64:67]
  v_mfma_f32_16x16x32_bf16 v[68:71], a[92:95], v[44:47], v[68:71]
  v_mfma_f32_16x16x32_bf16 v[80:83], a[156:159], v[44:47], v[80:83]
  v_mfma_f32_16x16x32_bf16 v[84:87], a[220:223], v[44:47], v[84:87]
  ds_read_b128 v[44:47], v8 offset:15360
  s_waitcnt lgkmcnt(7)
  v_mfma_f32_16x16x32_bf16 v[64:67], a[32:35], v[16:19], v[64:67]
  v_mfma_f32_16x16x32_bf16 v[68:71], a[96:99], v[16:19], v[68:71]
  v_mfma_f32_16x16x32_bf16 v[80:83], a[160:163], v[16:19], v[80:83]
  v_mfma_f32_16x16x32_bf16 v[84:87], a[224:227], v[16:19], v[84:87]
  ds_read_b128 v[16:19], v8 offset:16384
  s_waitcnt lgkmcnt(7)
  v_mfma_f32_16x16x32_bf16 v[64:67], a[36:39], v[20:23], v[64:67]
  v_mfma_f32_16x16x32_bf16 v[68:71], a[100:103], v[20:23], v[68:71]
  v_mfma_f32_16x16x32_bf16 v[80:83], a[164:167], v[20:23], v[80:83]
  v_mfma_f32_16x16x32_bf16 v[84:87], a[228:231], v[20:23], v[84:87]
  ds_read_b128 v[20:23], v8 offset:17408
  s_waitcnt lgkmcnt(7)
  v_mfma_f32_16x16x32_bf16 v[64:67], a[40:43], v[24:27], v[64:67]
  v_mfma_f32_16x16x32_bf16 v[68:71], a[104:107], v[24:27], v[68:71]
  v_mfma_f32_16x16x32_bf16 v[80:83], a[168:171], v[24:27], v[80:83]
  v_mfma_f32_16x16x32_bf16 v[84:87], a[232:235], v[24:27], v[84:87]
  ds_read_b128 v[24:27], v8 offset:18432
  s_waitcnt lgkmcnt(7)
  v_mfma_f32_16x16x32_bf16 v[64:67], a[44:47], v[28:31], v[64:67]
  v_mfma_f32_16x16x32_bf16 v[68:71], a[108:111], v[28:31], v[68:71]
  v_mfma_f32_16x16x32_bf16 v[80:83], a[172:175], v[28:31], v[80:83]
  v_mfma_f32_16x16x32_bf16 v[84:87], a[236:239], v[28:31], v[84:87]
  ds_read_b128 v[28:31], v8 offset:19456
  s_waitcnt lgkmcnt(3)
  v_mfma_f32_16x16x32_bf16 v[72:75], a[0:3], v[16:19], 0
  v_mfma_f32_16x16x32_bf16 v[76:79], a[64:67], v[16:19], 0
  v_mfma_f32_16x16x32_bf16 v[88:91], a[128:131], v[16:19], 0
  v_mfma_f32_16x16x32_bf16 v[92:95], a[192:195], v[16:19], 0
  ds_read_b128 v[16:19], v8 offset:24576
  v_mfma_f32_16x16x32_bf16 v[64:67], a[48:51], v[32:35], v[64:67]
  v_mfma_f32_16x16x32_bf16 v[68:71], a[112:115], v[32:35], v[68:71]
  v_mfma_f32_16x16x32_bf16 v[80:83], a[176:179], v[32:35], v[80:83]
  v_mfma_f32_16x16x32_bf16 v[84:87], a[240:243], v[32:35], v[84:87]
  ds_read_b128 v[32:35], v8 offset:20480
  s_waitcnt lgkmcnt(4)
  v_mfma_f32_16x16x32_bf16 v[72:75], a[4:7], v[20:23], v[72:75]
  v_mfma_f32_16x16x32_bf16 v[76:79], a[68:71], v[20:23], v[76:79]
  v_mfma_f32_16x16x32_bf16 v[88:91], a[132:135], v[20:23], v[88:91]
  v_mfma_f32_16x16x32_bf16 v[92:95], a[196:199], v[20:23], v[92:95]
  ds_read_b128 v[20:23], v8 offset:25600
  v_mfma_f32_16x16x32_bf16 v[64:67], a[52:55], v[36:39], v[64:67]
  v_mfma_f32_16x16x32_bf16 v[68:71], a[116:119], v[36:39], v[68:71]
  v_mfma_f32_16x16x32_bf16 v[80:83], a[180:183], v[36:39], v[80:83]
  v_mfma_f32_16x16x32_bf16 v[84:87], a[244:247], v[36:39], v[84:87]
  ds_read_b128 v[36:39], v8 offset:21504
  s_waitcnt lgkmcnt(5)
  v_mfma_f32_16x16x32_bf16 v[72:75], a[8:11], v[24:27], v[72:75]
  v_mfma_f32_16x16x32_bf16 v[76:79], a[72:75], v[24:27], v[76:79]
  v_mfma_f32_16x16x32_bf16 v[88:91], a[136:139], v[24:27], v[88:91]
  v_mfma_f32_16x16x32_bf16 v[92:95], a[200:203], v[24:27], v[92:95]
  ds_read_b128 v[24:27], v8 offset:26624
  v_mfma_f32_16x16x32_bf16 v[64:67], a[56:59], v[40:43], v[64:67]
  v_mfma_f32_16x16x32_bf16 v[68:71], a[120:123], v[40:43], v[68:71]
  v_mfma_f32_16x16x32_bf16 v[80:83], a[184:187], v[40:43], v[80:83]
  v_mfma_f32_16x16x32_bf16 v[84:87], a[248:251], v[40:43], v[84:87]
  ds_read_b128 v[40:43], v8 offset:22528
  s_waitcnt lgkmcnt(6)
  v_mfma_f32_16x16x32_bf16 v[72:75], a[12:15], v[28:31], v[72:75]
  v_mfma_f32_16x16x32_bf16 v[76:79], a[76:79], v[28:31], v[76:79]
  v_mfma_f32_16x16x32_bf16 v[88:91], a[140:143], v[28:31], v[88:91]
  v_mfma_f32_16x16x32_bf16 v[92:95], a[204:207], v[28:31], v[92:95]
  ds_read_b128 v[28:31], v8 offset:27648
  v_mfma_f32_16x16x32_bf16 v[64:67], a[60:63], v[44:47], v[64:67]
  v_mfma_f32_16x16x32_bf16 v[68:71], a[124:127], v[44:47], v[68:71]
  v_mfma_f32_16x16x32_bf16 v[80:83], a[188:191], v[44:47], v[80:83]
  v_mfma_f32_16x16x32_bf16 v[84:87], a[252:255], v[44:47], v[84:87]
  ds_read_b128 v[44:47], v8 offset:23552
  v_cvt_pk_bf16_f32 v96, v64, v68
  v_cvt_pk_bf16_f32 v97, v65, v69
  s_waitcnt lgkmcnt(6)
  v_mfma_f32_16x16x32_bf16 v[72:75], a[16:19], v[32:35], v[72:75]
  v_cvt_pk_bf16_f32 v98, v66, v70
  v_cvt_pk_bf16_f32 v99, v67, v71
  v_mfma_f32_16x16x32_bf16 v[76:79], a[80:83], v[32:35], v[76:79]
  v_cvt_pk_bf16_f32 v104, v80, v84
  v_cvt_pk_bf16_f32 v105, v81, v85
  v_mfma_f32_16x16x32_bf16 v[88:91], a[144:147], v[32:35], v[88:91]
  v_cvt_pk_bf16_f32 v106, v82, v86
  v_cvt_pk_bf16_f32 v107, v83, v87
  v_mfma_f32_16x16x32_bf16 v[92:95], a[208:211], v[32:35], v[92:95]
  ds_read_b128 v[32:35], v8 offset:28672
  s_waitcnt lgkmcnt(5)
  v_mfma_f32_16x16x32_bf16 v[72:75], a[20:23], v[36:39], v[72:75]
  v_mfma_f32_16x16x32_bf16 v[76:79], a[84:87], v[36:39], v[76:79]
  v_mfma_f32_16x16x32_bf16 v[88:91], a[148:151], v[36:39], v[88:91]
  v_mfma_f32_16x16x32_bf16 v[92:95], a[212:215], v[36:39], v[92:95]
  ds_read_b128 v[36:39], v8 offset:29696
  s_waitcnt lgkmcnt(4)
  v_mfma_f32_16x16x32_bf16 v[72:75], a[24:27], v[40:43], v[72:75]
  v_mfma_f32_16x16x32_bf16 v[76:79], a[88:91], v[40:43], v[76:79]
  v_mfma_f32_16x16x32_bf16 v[88:91], a[152:155], v[40:43], v[88:91]
  v_mfma_f32_16x16x32_bf16 v[92:95], a[216:219], v[40:43], v[92:95]
  ds_read_b128 v[40:43], v8 offset:30720
  s_waitcnt lgkmcnt(3)
  v_mfma_f32_16x16x32_bf16 v[72:75], a[28:31], v[44:47], v[72:75]
  v_mfma_f32_16x16x32_bf16 v[76:79], a[92:95], v[44:47], v[76:79]
  v_mfma_f32_16x16x32_bf16 v[88:91], a[156:159], v[44:47], v[88:91]
  v_mfma_f32_16x16x32_bf16 v[92:95], a[220:223], v[44:47], v[92:95]
  ds_read_b128 v[44:47], v8 offset:31744
  v_mfma_f32_16x16x32_bf16 v[72:75], a[32:35], v[16:19], v[72:75]
  v_mfma_f32_16x16x32_bf16 v[76:79], a[96:99], v[16:19], v[76:79]
  v_mfma_f32_16x16x32_bf16 v[88:91], a[160:163], v[16:19], v[88:91]
  v_mfma_f32_16x16x32_bf16 v[92:95], a[224:227], v[16:19], v[92:95]
  v_mfma_f32_16x16x32_bf16 v[72:75], a[36:39], v[20:23], v[72:75]
  v_mfma_f32_16x16x32_bf16 v[76:79], a[100:103], v[20:23], v[76:79]
  v_mfma_f32_16x16x32_bf16 v[88:91], a[164:167], v[20:23], v[88:91]
  v_mfma_f32_16x16x32_bf16 v[92:95], a[228:231], v[20:23], v[92:95]
  v_mfma_f32_16x16x32_bf16 v[72:75], a[40:43], v[24:27], v[72:75]
  v_mfma_f32_16x16x32_bf16 v[76:79], a[104:107], v[24:27], v[76:79]
  v_mfma_f32_16x16x32_bf16 v[88:91], a[168:171], v[24:27], v[88:91]
  v_mfma_f32_16x16x32_bf16 v[92:95], a[232:235], v[24:27], v[92:95]
  v_mfma_f32_16x16x32_bf16 v[72:75], a[44:47], v[28:31], v[72:75]
  v_mfma_f32_16x16x32_bf16 v[76:79], a[108:111], v[28:31], v[76:79]
  v_mfma_f32_16x16x32_bf16 v[88:91], a[172:175], v[28:31], v[88:91]
  v_mfma_f32_16x16x32_bf16 v[92:95], a[236:239], v[28:31], v[92:95]
  s_waitcnt lgkmcnt(3)
  v_mfma_f32_16x16x32_bf16 v[72:75], a[48:51], v[32:35], v[72:75]
  v_mfma_f32_16x16x32_bf16 v[76:79], a[112:115], v[32:35], v[76:79]
  v_mfma_f32_16x16x32_bf16 v[88:91], a[176:179], v[32:35], v[88:91]
  v_mfma_f32_16x16x32_bf16 v[92:95], a[240:243], v[32:35], v[92:95]
  s_waitcnt lgkmcnt(2)
  v_mfma_f32_16x16x32_bf16 v[72:75], a[52:55], v[36:39], v[72:75]
  v_mfma_f32_16x16x32_bf16 v[76:79], a[116:119], v[36:39], v[76:79]
  v_mfma_f32_16x16x32_bf16 v[88:91], a[180:183], v[36:39], v[88:91]
  v_mfma_f32_16x16x32_bf16 v[92:95], a[244:247], v[36:39], v[92:95]
  s_waitcnt lgkmcnt(1)
  v_mfma_f32_16x16x32_bf16 v[72:75], a[56:59], v[40:43], v[72:75]
  v_mfma_f32_16x16x32_bf16 v[76:79], a[120:123], v[40:43], v[76:79]
  v_mfma_f32_16x16x32_bf16 v[88:91], a[184:187], v[40:43], v[88:91]
  v_mfma_f32_16x16x32_bf16 v[92:95], a[248:251], v[40:43], v[92:95]
  s_waitcnt lgkmcnt(0)
  v_mfma_f32_16x16x32_bf16 v[72:75], a[60:63], v[44:47], v[72:75]
  v_mfma_f32_16x16x32_bf16 v[76:79], a[124:127], v[44:47], v[76:79]
  v_mfma_f32_16x16x32_bf16 v[88:91], a[188:191], v[44:47], v[88:91]
  v_mfma_f32_16x16x32_bf16 v[92:95], a[252:255], v[44:47], v[92:95]
  v_cvt_pk_bf16_f32 v100, v72, v76
  v_cvt_pk_bf16_f32 v101, v73, v77
  v_cvt_pk_bf16_f32 v102, v74, v78
  v_cvt_pk_bf16_f32 v103, v75, v79
  s_nop 3
  v_cvt_pk_bf16_f32 v108, v88, v92
  v_cvt_pk_bf16_f32 v109, v89, v93
  v_cvt_pk_bf16_f32 v110, v90, v94
  v_cvt_pk_bf16_f32 v111, v91, v95
  s_cmp_ge_u32 s28, 64
  s_cbranch_scc0 L_pq_w8
  s_waitcnt vmcnt(0)
L_pq_w8:
  s_waitcnt vmcnt(8)
  v_mov_b32 v10, s10
  buffer_store_dword v10, v9, s[4:7], s17 offen sc1
  buffer_store_dword v10, v9, s[4:7], s18 offen sc1
  s_lshl_b32 s56, s10, 13
  s_add_u32 s26, s22, s56
  buffer_store_dwordx4 v[96:99], v7, s[4:7], s26 offen offset:0 sc1
  buffer_store_dwordx4 v[100:103], v7, s[4:7], s26 offen offset:1024 sc1
  s_add_u32 s27, s23, s56
  buffer_store_dwordx4 v[104:107], v7, s[4:7], s27 offen offset:0 sc1
  buffer_store_dwordx4 v[108:111], v7, s[4:7], s27 offen offset:1024 sc1
  s_xor_b32 s25, s25, 32768
  s_add_u32 s10, s10, 1
  s_cmp_gt_u32 s10, 2
  s_cbranch_scc1 L_pq_noearly
  s_waitcnt vmcnt(0)
  v_mov_b32 v10, s10
  buffer_store_dword v10, v9, s[4:7], s17 offen sc1
  buffer_store_dword v10, v9, s[4:7], s18 offen sc1
L_pq_noearly:
  s_cmp_lt_u32 s10, 64
  s_cbranch_scc1 L_pq_loop
  s_waitcnt vmcnt(0)
  v_mov_b32 v10, s10
  buffer_store_dword v10, v9, s[4:7], s17 offen sc1
  buffer_store_dword v10, v9, s[4:7], s18 offen sc1
  s_waitcnt vmcnt(0)
  s_branch L_p_done
L_p_spare:
  s_lshl_b32 s56, s16, 3
  s_add_u32 s56, s56, s14
  s_sub_u32 s56, s56, 24
  s_lshl_b32 s56, s56, 12
  v_mov_b32 v4, 0
  v_mov_b32 v5, 0
  v_mov_b32 v6, 0
  v_mov_b32 v7, 0
  v_lshlrev_b32 v3, 4, v0
  buffer_store_dwordx4 v[4:7], v3, s[4:7], s56 offen sc1
  s_waitcnt vmcnt(0)
  s_barrier
  s_cmp_lg_u32 s9, 0
  s_cbranch_scc1 L_daclr5
  v_mov_b32 v124, 1
  v_mov_b32 v125, 20
  s_mov_b64 exec, 1
    buffer_atomic_add v124, v125, s[52:55], 0 offen sc1
  s_mov_b64 exec, -1
L_daclr5:
  s_waitcnt vmcnt(0)
  s_cmp_lg_u32 s9, 0
  s_cbranch_scc1 L_csp6d
  v_mov_b32 v125, 20
  s_mov_b32 s43, 0
L_csp6:
    buffer_load_dword v124, v125, s[52:55], 0 offen sc1
    s_waitcnt vmcnt(0)
  v_readfirstlane_b32 s63, v124
  s_nop 0
  s_cmp_ge_u32 s63, 16
  s_nop 1
  s_cbranch_scc1 L_csp6d
  s_sleep 6
  s_add_u32 s43, s43, 1
  s_cmp_lt_u32 s43, 400000
  s_cbranch_scc1 L_csp6
  s_branch L_bail
L_csp6d:
  s_barrier
  s_mov_b32 s18, 60
  s_lshl_b32 s21, s11, 0
  s_mov_b32 s21, 8192
  s_cmp_lg_u32 s9, 0
  s_cbranch_scc1 L_wsp7d
  v_and_b32 v121, 63, v1
  v_cmp_gt_u32 vcc, 4, v121
  v_lshlrev_b32 v121, 2, v121
  s_nop 0
  v_cndmask_b32 v121, 0, v121, vcc
  s_mov_b32 s43, 0
L_wsp7:
    buffer_load_dword v120, v121, s[4:7], s21 offen sc1
    s_waitcnt vmcnt(0)
  v_cmp_gt_u32 vcc, s18, v120
  s_cbranch_vccz L_wsp7d
  s_sleep 60
  s_add_u32 s43, s43, 1
  s_cmp_lt_u32 s43, 400000
  s_cbranch_scc1 L_wsp7
  s_branch L_bail
L_wsp7d:
  s_barrier
L_p_done:
  s_waitcnt vmcnt(0) lgkmcnt(0)
  s_barrier
  s_cmp_eq_u32 s11, 6
  s_cbranch_scc0 L_p_tof
  s_mov_b32 s16, 3
  s_branch L_a_late
L_p_tof:
  s_mov_b32 s16, 2
  s_branch L_f_late
L_role_a:
  s_sub_u32 s16, s11, 1
  s_cmp_lg_u32 s16, 2
  s_cbranch_scc1 L_hot_done
  s_cmp_ge_u32 s14, 24
  s_cbranch_scc1 L_hot_done
  v_lshrrev_b32 v3, 4, v1
  v_lshlrev_b32 v3, 13, v3
  v_and_b32 v4, 15, v1
  v_lshlrev_b32 v4, 4, v4
  v_add_u32 v3, v3, v4
  s_lshl_b32 s56, s9, 15
  v_add_u32 v3, s56, v3
  s_lshr_b32 s21, s14, 3
  s_and_b32 s22, s14, 7
  s_lshl_b32 s22, s22, 10
  s_add_u32 s22, s22, 256
  s_lshl_b32 s21, s21, 3
  s_add_u32 s21, s21, 16
  s_add_u32 s24, s0, s21
  s_addc_u32 s25, s1, 0
  s_load_dwordx2 s[48:49], s[24:25], 0
  s_waitcnt lgkmcnt(0)
  s_mov_b32 s50, 4194304
  s_mov_b32 s51, 0x20000
  s_add_u32 s58, s22, 0
    buffer_load_dwordx4 v[68:71], v3, s[48:51], s58 offen
  s_add_u32 s59, s22, 131072
    buffer_load_dwordx4 v[72:75], v3, s[48:51], s59 offen
  s_add_u32 s58, s22, 262144
    buffer_load_dwordx4 v[76:79], v3, s[48:51], s58 offen
  s_add_u32 s59, s22, 393216
    buffer_load_dwordx4 v[80:83], v3, s[48:51], s59 offen
  s_add_u32 s58, s22, 524288
    buffer_load_dwordx4 v[84:87], v3, s[48:51], s58 offen
  s_add_u32 s59, s22, 655360
    buffer_load_dwordx4 v[88:91], v3, s[48:51], s59 offen
  s_add_u32 s58, s22, 786432
    buffer_load_dwordx4 v[92:95], v3, s[48:51], s58 offen
  s_add_u32 s59, s22, 917504
    buffer_load_dwordx4 v[96:99], v3, s[48:51], s59 offen
  s_add_u32 s58, s22, 1048576
    buffer_load_dwordx4 v[100:103], v3, s[48:51], s58 offen
  s_add_u32 s59, s22, 1179648
    buffer_load_dwordx4 v[104:107], v3, s[48:51], s59 offen
  s_add_u32 s58, s22, 1310720
    buffer_load_dwordx4 v[108:111], v3, s[48:51], s58 offen
  s_add_u32 s59, s22, 1441792
    buffer_load_dwordx4 v[112:115], v3, s[48:51], s59 offen
  s_add_u32 s58, s22, 1572864
    buffer_load_dwordx4 v[116:119], v3, s[48:51], s58 offen
  s_add_u32 s59, s22, 1703936
    buffer_load_dwordx4 v[120:123], v3, s[48:51], s59 offen
  s_add_u32 s58, s22, 1835008
    buffer_load_dwordx4 v[68:71], v3, s[48:51], s58 offen
  s_add_u32 s59, s22, 1966080
    buffer_load_dwordx4 v[72:75], v3, s[48:51], s59 offen
  s_add_u32 s58, s22, 2097152
    buffer_load_dwordx4 v[76:79], v3, s[48:51], s58 offen
  s_add_u32 s59, s22, 2228224
    buffer_load_dwordx4 v[80:83], v3, s[48:51], s59 offen
  s_add_u32 s58, s22, 2359296
    buffer_load_dwordx4 v[84:87], v3, s[48:51], s58 offen
  s_add_u32 s59, s22, 2490368
    buffer_load_dwordx4 v[88:91], v3, s[48:51], s59 offen
  s_add_u32 s58, s22, 2621440
    buffer_load_dwordx4 v[92:95], v3, s[48:51], s58 offen
  s_add_u32 s59, s22, 2752512
    buffer_load_dwordx4 v[96:99], v3, s[48:51], s59 offen
  s_add_u32 s58, s22, 2883584
    buffer_load_dwordx4 v[100:103], v3, s[48:51], s58 offen
  s_add_u32 s59, s22, 3014656
    buffer_load_dwordx4 v[104:107], v3, s[48:51], s59 offen
  s_add_u32 s58, s22, 3145728
    buffer_load_dwordx4 v[108:111], v3, s[48:51], s58 offen
  s_add_u32 s59, s22, 3276800
    buffer_load_dwordx4 v[112:115], v3, s[48:51], s59 offen
  s_add_u32 s58, s22, 3407872
    buffer_load_dwordx4 v[116:119], v3, s[48:51], s58 offen
  s_add_u32 s59, s22, 3538944
    buffer_load_dwordx4 v[120:123], v3, s[48:51], s59 offen
  s_add_u32 s58, s22, 3670016
    buffer_load_dwordx4 v[68:71], v3, s[48:51], s58 offen
  s_add_u32 s59, s22, 3801088
    buffer_load_dwordx4 v[72:75], v3, s[48:51], s59 offen
  s_add_u32 s58, s22, 3932160
    buffer_load_dwordx4 v[76:79], v3, s[48:51], s58 offen
  s_add_u32 s59, s22, 4063232
    buffer_load_dwordx4 v[80:83], v3, s[48:51], s59 offen
    s_waitcnt vmcnt(0)
L_hot_done:
  s_lshl_b32 s8, s16, 5
  s_add_u32 s8, s8, s14
  s_load_dwordx2 s[48:49], s[0:1], 88
  s_waitcnt lgkmcnt(0)
  s_mov_b32 s50, 3145728
  s_mov_b32 s51, 0x20000
  s_load_dwordx2 s[44:45], s[0:1], 80
  s_waitcnt lgkmcnt(0)
  s_mov_b32 s46, 1024
  s_mov_b32 s47, 0x20000
  v_and_b32 v3, 3, v1
  v_lshrrev_b32 v4, 2, v1
  s_mul_i32 s56, s9, 786432
  s_lshl_b32 s57, s8, 6
  s_add_u32 s56, s56, s57
  s_mov_b32 s58, 6144
  v_mul_lo_u32 v5, v4, s58
  v_lshlrev_b32 v7, 4, v3
  v_add_u32 v5, v5, v7
  v_add_u32 v5, s56, v5
  s_mov_b32 s59, 0
  buffer_load_dwordx4 v[16:19], v5, s[48:51], s59 offen
  s_mov_b32 s60, 98304
  buffer_load_dwordx4 v[20:23], v5, s[48:51], s60 offen
  s_mov_b32 s59, 196608
  buffer_load_dwordx4 v[24:27], v5, s[48:51], s59 offen
  s_mov_b32 s60, 294912
  buffer_load_dwordx4 v[28:31], v5, s[48:51], s60 offen
  s_mov_b32 s59, 393216
  buffer_load_dwordx4 v[32:35], v5, s[48:51], s59 offen
  s_mov_b32 s60, 491520
  buffer_load_dwordx4 v[36:39], v5, s[48:51], s60 offen
  s_mov_b32 s59, 589824
  buffer_load_dwordx4 v[40:43], v5, s[48:51], s59 offen
  s_mov_b32 s60, 688128
  buffer_load_dwordx4 v[44:47], v5, s[48:51], s60 offen
  s_lshl_b32 s56, s9, 8
  v_lshlrev_b32 v6, 1, v4
  v_add_u32 v6, s56, v6
  buffer_load_ushort v48, v6, s[44:47], 0 offen offset:0
  buffer_load_ushort v49, v6, s[44:47], 0 offen offset:32
  buffer_load_ushort v50, v6, s[44:47], 0 offen offset:64
  buffer_load_ushort v51, v6, s[44:47], 0 offen offset:96
  buffer_load_ushort v52, v6, s[44:47], 0 offen offset:128
  buffer_load_ushort v53, v6, s[44:47], 0 offen offset:160
  buffer_load_ushort v54, v6, s[44:47], 0 offen offset:192
  buffer_load_ushort v55, v6, s[44:47], 0 offen offset:224
  s_waitcnt vmcnt(7)
  v_lshlrev_b32 v48, 16, v48
  v_mul_f32 v7, 0xbfb8aa3b, v48
  v_exp_f32 v7, v7
  s_nop 0
  v_add_f32 v7, 1.0, v7
  v_rcp_f32 v7, v7
  s_nop 0
  v_mul_f32 v48, v48, v7
  v_cvt_pk_bf16_f32 v48, v48, v48
  v_lshlrev_b32 v48, 16, v48
  s_waitcnt vmcnt(6)
  v_lshlrev_b32 v49, 16, v49
  v_mul_f32 v7, 0xbfb8aa3b, v49
  v_exp_f32 v7, v7
  s_nop 0
  v_add_f32 v7, 1.0, v7
  v_rcp_f32 v7, v7
  s_nop 0
  v_mul_f32 v49, v49, v7
  v_cvt_pk_bf16_f32 v49, v49, v49
  v_lshlrev_b32 v49, 16, v49
  s_waitcnt vmcnt(5)
  v_lshlrev_b32 v50, 16, v50
  v_mul_f32 v7, 0xbfb8aa3b, v50
  v_exp_f32 v7, v7
  s_nop 0
  v_add_f32 v7, 1.0, v7
  v_rcp_f32 v7, v7
  s_nop 0
  v_mul_f32 v50, v50, v7
  v_cvt_pk_bf16_f32 v50, v50, v50
  v_lshlrev_b32 v50, 16, v50
  s_waitcnt vmcnt(4)
  v_lshlrev_b32 v51, 16, v51
  v_mul_f32 v7, 0xbfb8aa3b, v51
  v_exp_f32 v7, v7
  s_nop 0
  v_add_f32 v7, 1.0, v7
  v_rcp_f32 v7, v7
  s_nop 0
  v_mul_f32 v51, v51, v7
  v_cvt_pk_bf16_f32 v51, v51, v51
  v_lshlrev_b32 v51, 16, v51
  s_waitcnt vmcnt(3)
  v_lshlrev_b32 v52, 16, v52
  v_mul_f32 v7, 0xbfb8aa3b, v52
  v_exp_f32 v7, v7
  s_nop 0
  v_add_f32 v7, 1.0, v7
  v_rcp_f32 v7, v7
  s_nop 0
  v_mul_f32 v52, v52, v7
  v_cvt_pk_bf16_f32 v52, v52, v52
  v_lshlrev_b32 v52, 16, v52
  s_waitcnt vmcnt(2)
  v_lshlrev_b32 v53, 16, v53
  v_mul_f32 v7, 0xbfb8aa3b, v53
  v_exp_f32 v7, v7
  s_nop 0
  v_add_f32 v7, 1.0, v7
  v_rcp_f32 v7, v7
  s_nop 0
  v_mul_f32 v53, v53, v7
  v_cvt_pk_bf16_f32 v53, v53, v53
  v_lshlrev_b32 v53, 16, v53
  s_waitcnt vmcnt(1)
  v_lshlrev_b32 v54, 16, v54
  v_mul_f32 v7, 0xbfb8aa3b, v54
  v_exp_f32 v7, v7
  s_nop 0
  v_add_f32 v7, 1.0, v7
  v_rcp_f32 v7, v7
  s_nop 0
  v_mul_f32 v54, v54, v7
  v_cvt_pk_bf16_f32 v54, v54, v54
  v_lshlrev_b32 v54, 16, v54
  s_waitcnt vmcnt(0)
  v_lshlrev_b32 v55, 16, v55
  v_mul_f32 v7, 0xbfb8aa3b, v55
  v_exp_f32 v7, v7
  s_nop 0
  v_add_f32 v7, 1.0, v7
  v_rcp_f32 v7, v7
  s_nop 0
  v_mul_f32 v55, v55, v7
  v_cvt_pk_bf16_f32 v55, v55, v55
  v_lshlrev_b32 v55, 16, v55
  v_mov_b32 v56, 0
  v_mov_b32 v57, 0
  v_mov_b32 v58, 0
  v_mov_b32 v59, 0
  v_mov_b32 v60, 0
  v_mov_b32 v61, 0
  v_mov_b32 v62, 0
  v_mov_b32 v63, 0
  v_lshlrev_b32 v64, 16, v16
  v_and_b32 v65, 0xffff0000, v16
  v_fmac_f32 v56, v64, v48
  v_fmac_f32 v57, v65, v48
  v_lshlrev_b32 v64, 16, v17
  v_and_b32 v65, 0xffff0000, v17
  v_fmac_f32 v58, v64, v48
  v_fmac_f32 v59, v65, v48
  v_lshlrev_b32 v64, 16, v18
  v_and_b32 v65, 0xffff0000, v18
  v_fmac_f32 v60, v64, v48
  v_fmac_f32 v61, v65, v48
  v_lshlrev_b32 v64, 16, v19
  v_and_b32 v65, 0xffff0000, v19
  v_fmac_f32 v62, v64, v48
  v_fmac_f32 v63, v65, v48
  v_lshlrev_b32 v64, 16, v20
  v_and_b32 v65, 0xffff0000, v20
  v_fmac_f32 v56, v64, v49
  v_fmac_f32 v57, v65, v49
  v_lshlrev_b32 v64, 16, v21
  v_and_b32 v65, 0xffff0000, v21
  v_fmac_f32 v58, v64, v49
  v_fmac_f32 v59, v65, v49
  v_lshlrev_b32 v64, 16, v22
  v_and_b32 v65, 0xffff0000, v22
  v_fmac_f32 v60, v64, v49
  v_fmac_f32 v61, v65, v49
  v_lshlrev_b32 v64, 16, v23
  v_and_b32 v65, 0xffff0000, v23
  v_fmac_f32 v62, v64, v49
  v_fmac_f32 v63, v65, v49
  v_lshlrev_b32 v64, 16, v24
  v_and_b32 v65, 0xffff0000, v24
  v_fmac_f32 v56, v64, v50
  v_fmac_f32 v57, v65, v50
  v_lshlrev_b32 v64, 16, v25
  v_and_b32 v65, 0xffff0000, v25
  v_fmac_f32 v58, v64, v50
  v_fmac_f32 v59, v65, v50
  v_lshlrev_b32 v64, 16, v26
  v_and_b32 v65, 0xffff0000, v26
  v_fmac_f32 v60, v64, v50
  v_fmac_f32 v61, v65, v50
  v_lshlrev_b32 v64, 16, v27
  v_and_b32 v65, 0xffff0000, v27
  v_fmac_f32 v62, v64, v50
  v_fmac_f32 v63, v65, v50
  v_lshlrev_b32 v64, 16, v28
  v_and_b32 v65, 0xffff0000, v28
  v_fmac_f32 v56, v64, v51
  v_fmac_f32 v57, v65, v51
  v_lshlrev_b32 v64, 16, v29
  v_and_b32 v65, 0xffff0000, v29
  v_fmac_f32 v58, v64, v51
  v_fmac_f32 v59, v65, v51
  v_lshlrev_b32 v64, 16, v30
  v_and_b32 v65, 0xffff0000, v30
  v_fmac_f32 v60, v64, v51
  v_fmac_f32 v61, v65, v51
  v_lshlrev_b32 v64, 16, v31
  v_and_b32 v65, 0xffff0000, v31
  v_fmac_f32 v62, v64, v51
  v_fmac_f32 v63, v65, v51
  v_lshlrev_b32 v64, 16, v32
  v_and_b32 v65, 0xffff0000, v32
  v_fmac_f32 v56, v64, v52
  v_fmac_f32 v57, v65, v52
  v_lshlrev_b32 v64, 16, v33
  v_and_b32 v65, 0xffff0000, v33
  v_fmac_f32 v58, v64, v52
  v_fmac_f32 v59, v65, v52
  v_lshlrev_b32 v64, 16, v34
  v_and_b32 v65, 0xffff0000, v34
  v_fmac_f32 v60, v64, v52
  v_fmac_f32 v61, v65, v52
  v_lshlrev_b32 v64, 16, v35
  v_and_b32 v65, 0xffff0000, v35
  v_fmac_f32 v62, v64, v52
  v_fmac_f32 v63, v65, v52
  v_lshlrev_b32 v64, 16, v36
  v_and_b32 v65, 0xffff0000, v36
  v_fmac_f32 v56, v64, v53
  v_fmac_f32 v57, v65, v53
  v_lshlrev_b32 v64, 16, v37
  v_and_b32 v65, 0xffff0000, v37
  v_fmac_f32 v58, v64, v53
  v_fmac_f32 v59, v65, v53
  v_lshlrev_b32 v64, 16, v38
  v_and_b32 v65, 0xffff0000, v38
  v_fmac_f32 v60, v64, v53
  v_fmac_f32 v61, v65, v53
  v_lshlrev_b32 v64, 16, v39
  v_and_b32 v65, 0xffff0000, v39
  v_fmac_f32 v62, v64, v53
  v_fmac_f32 v63, v65, v53
  v_lshlrev_b32 v64, 16, v40
  v_and_b32 v65, 0xffff0000, v40
  v_fmac_f32 v56, v64, v54
  v_fmac_f32 v57, v65, v54
  v_lshlrev_b32 v64, 16, v41
  v_and_b32 v65, 0xffff0000, v41
  v_fmac_f32 v58, v64, v54
  v_fmac_f32 v59, v65, v54
  v_lshlrev_b32 v64, 16, v42
  v_and_b32 v65, 0xffff0000, v42
  v_fmac_f32 v60, v64, v54
  v_fmac_f32 v61, v65, v54
  v_lshlrev_b32 v64, 16, v43
  v_and_b32 v65, 0xffff0000, v43
  v_fmac_f32 v62, v64, v54
  v_fmac_f32 v63, v65, v54
  v_lshlrev_b32 v64, 16, v44
  v_and_b32 v65, 0xffff0000, v44
  v_fmac_f32 v56, v64, v55
  v_fmac_f32 v57, v65, v55
  v_lshlrev_b32 v64, 16, v45
  v_and_b32 v65, 0xffff0000, v45
  v_fmac_f32 v58, v64, v55
  v_fmac_f32 v59, v65, v55
  v_lshlrev_b32 v64, 16, v46
  v_and_b32 v65, 0xffff0000, v46
  v_fmac_f32 v60, v64, v55
  v_fmac_f32 v61, v65, v55
  v_lshlrev_b32 v64, 16, v47
  v_and_b32 v65, 0xffff0000, v47
  v_fmac_f32 v62, v64, v55
  v_fmac_f32 v63, v65, v55
  v_add_f32_dpp v56, v56, v56 row_ror:4 row_mask:0xf bank_mask:0xf
  s_nop 1
  v_add_f32_dpp v56, v56, v56 row_ror:8 row_mask:0xf bank_mask:0xf
  v_mov_b32 v7, v56
  s_nop 1
  v_permlane16_swap_b32 v56, v7
  v_add_f32 v56, v56, v7
  v_mov_b32 v7, v56
  s_nop 1
  v_permlane32_swap_b32 v56, v7
  v_add_f32 v56, v56, v7
  v_add_f32_dpp v57, v57, v57 row_ror:4 row_mask:0xf bank_mask:0xf
  s_nop 1
  v_add_f32_dpp v57, v57, v57 row_ror:8 row_mask:0xf bank_mask:0xf
  v_mov_b32 v7, v57
  s_nop 1
  v_permlane16_swap_b32 v57, v7
  v_add_f32 v57, v57, v7
  v_mov_b32 v7, v57
  s_nop 1
  v_permlane32_swap_b32 v57, v7
  v_add_f32 v57, v57, v7
  v_add_f32_dpp v58, v58, v58 row_ror:4 row_mask:0xf bank_mask:0xf
  s_nop 1
  v_add_f32_dpp v58, v58, v58 row_ror:8 row_mask:0xf bank_mask:0xf
  v_mov_b32 v7, v58
  s_nop 1
  v_permlane16_swap_b32 v58, v7
  v_add_f32 v58, v58, v7
  v_mov_b32 v7, v58
  s_nop 1
  v_permlane32_swap_b32 v58, v7
  v_add_f32 v58, v58, v7
  v_add_f32_dpp v59, v59, v59 row_ror:4 row_mask:0xf bank_mask:0xf
  s_nop 1
  v_add_f32_dpp v59, v59, v59 row_ror:8 row_mask:0xf bank_mask:0xf
  v_mov_b32 v7, v59
  s_nop 1
  v_permlane16_swap_b32 v59, v7
  v_add_f32 v59, v59, v7
  v_mov_b32 v7, v59
  s_nop 1
  v_permlane32_swap_b32 v59, v7
  v_add_f32 v59, v59, v7
  v_add_f32_dpp v60, v60, v60 row_ror:4 row_mask:0xf bank_mask:0xf
  s_nop 1
  v_add_f32_dpp v60, v60, v60 row_ror:8 row_mask:0xf bank_mask:0xf
  v_mov_b32 v7, v60
  s_nop 1
  v_permlane16_swap_b32 v60, v7
  v_add_f32 v60, v60, v7
  v_mov_b32 v7, v60
  s_nop 1
  v_permlane32_swap_b32 v60, v7
  v_add_f32 v60, v60, v7
  v_add_f32_dpp v61, v61, v61 row_ror:4 row_mask:0xf bank_mask:0xf
  s_nop 1
  v_add_f32_dpp v61, v61, v61 row_ror:8 row_mask:0xf bank_mask:0xf
  v_mov_b32 v7, v61
  s_nop 1
  v_permlane16_swap_b32 v61, v7
  v_add_f32 v61, v61, v7
  v_mov_b32 v7, v61
  s_nop 1
  v_permlane32_swap_b32 v61, v7
  v_add_f32 v61, v61, v7
  v_add_f32_dpp v62, v62, v62 row_ror:4 row_mask:0xf bank_mask:0xf
  s_nop 1
  v_add_f32_dpp v62, v62, v62 row_ror:8 row_mask:0xf bank_mask:0xf
  v_mov_b32 v7, v62
  s_nop 1
  v_permlane16_swap_b32 v62, v7
  v_add_f32 v62, v62, v7
  v_mov_b32 v7, v62
  s_nop 1
  v_permlane32_swap_b32 v62, v7
  v_add_f32 v62, v62, v7
  v_add_f32_dpp v63, v63, v63 row_ror:4 row_mask:0xf bank_mask:0xf
  s_nop 1
  v_add_f32_dpp v63, v63, v63 row_ror:8 row_mask:0xf bank_mask:0xf
  v_mov_b32 v7, v63
  s_nop 1
  v_permlane16_swap_b32 v63, v7
  v_add_f32 v63, v63, v7
  v_mov_b32 v7, v63
  s_nop 1
  v_permlane32_swap_b32 v63, v7
  v_add_f32 v63, v63, v7
  v_lshlrev_b32 v7, 5, v3
  s_lshl_b32 s56, s9, 7
  v_add_u32 v7, s56, v7
  ds_write_b128 v7, v[56:59]
  ds_write_b128 v7, v[60:63] offset:16
  s_waitcnt lgkmcnt(0)
  s_barrier
  v_and_b32 v7, 31, v1
  v_lshlrev_b32 v7, 2, v7
  ds_read_b32 v16, v7 offset:0
  ds_read_b32 v17, v7 offset:128
  ds_read_b32 v18, v7 offset:256
  ds_read_b32 v19, v7 offset:384
  s_waitcnt lgkmcnt(2)
  v_add_f32 v16, v16, v17
  s_waitcnt lgkmcnt(0)
  v_add_f32 v18, v18, v19
  v_add_f32 v16, v16, v18
  v_cvt_pk_bf16_f32 v16, v16, v16
  v_lshlrev_b32 v16, 16, v16
  s_lshl_b32 s56, s8, 7
  s_add_u32 s56, s56, 65536
  buffer_store_dword v16, v7, s[4:7], s56 offen sc1
  s_waitcnt vmcnt(0)
  s_barrier
  s_cmp_lg_u32 s9, 0
  s_cbranch_scc1 L_ca8d
  v_mov_b32 v125, 20
  s_mov_b32 s43, 0
L_ca8:
    buffer_load_dword v124, v125, s[52:55], 0 offen sc1
    s_waitcnt vmcnt(0)
  v_readfirstlane_b32 s63, v124
  s_nop 0
  s_cmp_ge_u32 s63, 16
  s_nop 1
  s_cbranch_scc1 L_ca8d
  s_sleep 6
  s_add_u32 s43, s43, 1
  s_cmp_lt_u32 s43, 400000
  s_cbranch_scc1 L_ca8
  s_branch L_bail
L_ca8d:
  s_barrier
  s_mov_b32 s17, 45184
  s_cmp_lt_u32 s8, 32
  s_cselect_b32 s17, 45056, s17
  s_cmp_lg_u32 s9, 0
  s_cbranch_scc1 L_camod9
  v_mov_b32 v124, 1
  v_mov_b32 v125, s17
  s_mov_b64 exec, 1
    buffer_atomic_add v124, v125, s[4:7], 0 offen sc1
  s_mov_b64 exec, -1
L_camod9:
L_a_late:
  s_mov_b32 s8, s14
  s_cmp_lg_u32 s9, 0
  s_cbranch_scc1 L_nacr10d
  v_mov_b32 v125, 45312
  s_mov_b32 s43, 0
L_nacr10:
    buffer_load_dword v124, v125, s[4:7], 0 offen sc1
    s_waitcnt vmcnt(0)
  v_readfirstlane_b32 s63, v124
  s_nop 0
  s_cmp_ge_u32 s63, 24
  s_nop 1
  s_cbranch_scc1 L_nacr10d
  s_sleep 8
  s_add_u32 s43, s43, 1
  s_cmp_lt_u32 s43, 400000
  s_cbranch_scc1 L_nacr10
  s_branch L_bail
L_nacr10d:
  s_barrier
  s_lshl_b32 s62, s8, 17
  s_lshl_b32 s63, s9, 8
  s_add_u32 s20, s62, s63
  s_load_dwordx2 s[48:49], s[0:1], 40
  s_waitcnt lgkmcnt(0)
  s_mov_b32 s50, 4194304
  s_mov_b32 s51, 0x20000
  v_and_b32 v16, 15, v1
  v_lshrrev_b32 v17, 4, v1
  s_mov_b32 s56, 8192
  v_mul_lo_u32 v18, v17, s56
  v_lshlrev_b32 v19, 4, v16
  v_add_u32 v18, v18, v19
  v_add_u32 v18, s20, v18
  s_mov_b32 s70, 0x05040100
  s_mov_b32 s71, 0x07060302
  s_mov_b32 s58, 0
  buffer_load_dwordx4 v[24:27], v18, s[48:51], s58 offen
  s_mov_b32 s59, 1024
  buffer_load_dwordx4 v[28:31], v18, s[48:51], s59 offen
  s_mov_b32 s60, 2048
  buffer_load_dwordx4 v[32:35], v18, s[48:51], s60 offen
  s_mov_b32 s61, 3072
  buffer_load_dwordx4 v[36:39], v18, s[48:51], s61 offen
  s_mov_b32 s58, 4096
  buffer_load_dwordx4 v[40:43], v18, s[48:51], s58 offen
  s_mov_b32 s59, 5120
  buffer_load_dwordx4 v[44:47], v18, s[48:51], s59 offen
  s_mov_b32 s60, 6144
  buffer_load_dwordx4 v[48:51], v18, s[48:51], s60 offen
  s_mov_b32 s61, 7168
  buffer_load_dwordx4 v[52:55], v18, s[48:51], s61 offen
  s_mov_b32 s58, 32768
  buffer_load_dwordx4 v[56:59], v18, s[48:51], s58 offen
  s_mov_b32 s59, 33792
  buffer_load_dwordx4 v[60:63], v18, s[48:51], s59 offen
  s_mov_b32 s60, 34816
  buffer_load_dwordx4 v[64:67], v18, s[48:51], s60 offen
  s_mov_b32 s61, 35840
  buffer_load_dwordx4 v[68:71], v18, s[48:51], s61 offen
  s_mov_b32 s58, 36864
  buffer_load_dwordx4 v[72:75], v18, s[48:51], s58 offen
  s_mov_b32 s59, 37888
  buffer_load_dwordx4 v[76:79], v18, s[48:51], s59 offen
  s_mov_b32 s60, 38912
  buffer_load_dwordx4 v[80:83], v18, s[48:51], s60 offen
  s_mov_b32 s61, 39936
  buffer_load_dwordx4 v[84:87], v18, s[48:51], s61 offen
  s_mov_b32 s58, 65536
  buffer_load_dwordx4 v[88:91], v18, s[48:51], s58 offen
  s_mov_b32 s59, 66560
  buffer_load_dwordx4 v[92:95], v18, s[48:51], s59 offen
  s_mov_b32 s60, 67584
  buffer_load_dwordx4 v[96:99], v18, s[48:51], s60 offen
  s_mov_b32 s61, 68608
  buffer_load_dwordx4 v[100:103], v18, s[48:51], s61 offen
  s_mov_b32 s58, 69632
  buffer_load_dwordx4 v[104:107], v18, s[48:51], s58 offen
  s_mov_b32 s59, 70656
  buffer_load_dwordx4 v[108:111], v18, s[48:51], s59 offen
  s_mov_b32 s60, 71680
  buffer_load_dwordx4 v[112:115], v18, s[48:51], s60 offen
  s_mov_b32 s61, 72704
  buffer_load_dwordx4 v[116:119], v18, s[48:51], s61 offen
  s_waitcnt vmcnt(22)
  v_perm_b32 v120, v28, v24, s70
  v_accvgpr_write_b32 a0, v120
  s_waitcnt vmcnt(20)
  v_perm_b32 v121, v36, v32, s70
  v_accvgpr_write_b32 a1, v121
  s_waitcnt vmcnt(18)
  v_perm_b32 v122, v44, v40, s70
  v_accvgpr_write_b32 a2, v122
  s_waitcnt vmcnt(16)
  v_perm_b32 v123, v52, v48, s70
  v_accvgpr_write_b32 a3, v123
  v_perm_b32 v120, v28, v24, s71
  v_accvgpr_write_b32 a16, v120
  v_perm_b32 v121, v36, v32, s71
  v_accvgpr_write_b32 a17, v121
  v_perm_b32 v122, v44, v40, s71
  v_accvgpr_write_b32 a18, v122
  v_perm_b32 v123, v52, v48, s71
  v_accvgpr_write_b32 a19, v123
  v_perm_b32 v120, v29, v25, s70
  v_accvgpr_write_b32 a32, v120
  v_perm_b32 v121, v37, v33, s70
  v_accvgpr_write_b32 a33, v121
  v_perm_b32 v122, v45, v41, s70
  v_accvgpr_write_b32 a34, v122
  v_perm_b32 v123, v53, v49, s70
  v_accvgpr_write_b32 a35, v123
  v_perm_b32 v120, v29, v25, s71
  v_accvgpr_write_b32 a48, v120
  v_perm_b32 v121, v37, v33, s71
  v_accvgpr_write_b32 a49, v121
  v_perm_b32 v122, v45, v41, s71
  v_accvgpr_write_b32 a50, v122
  v_perm_b32 v123, v53, v49, s71
  v_accvgpr_write_b32 a51, v123
  v_perm_b32 v120, v30, v26, s70
  v_accvgpr_write_b32 a64, v120
  v_perm_b32 v121, v38, v34, s70
  v_accvgpr_write_b32 a65, v121
  v_perm_b32 v122, v46, v42, s70
  v_accvgpr_write_b32 a66, v122
  v_perm_b32 v123, v54, v50, s70
  v_accvgpr_write_b32 a67, v123
  v_perm_b32 v120, v30, v26, s71
  v_accvgpr_write_b32 a80, v120
  v_perm_b32 v121, v38, v34, s71
  v_accvgpr_write_b32 a81, v121
  v_perm_b32 v122, v46, v42, s71
  v_accvgpr_write_b32 a82, v122
  v_perm_b32 v123, v54, v50, s71
  v_accvgpr_write_b32 a83, v123
  v_perm_b32 v120, v31, v27, s70
  v_accvgpr_write_b32 a96, v120
  v_perm_b32 v121, v39, v35, s70
  v_accvgpr_write_b32 a97, v121
  v_perm_b32 v122, v47, v43, s70
  v_accvgpr_write_b32 a98, v122
  v_perm_b32 v123, v55, v51, s70
  v_accvgpr_write_b32 a99, v123
  v_perm_b32 v120, v31, v27, s71
  v_accvgpr_write_b32 a112, v120
  v_perm_b32 v121, v39, v35, s71
  v_accvgpr_write_b32 a113, v121
  v_perm_b32 v122, v47, v43, s71
  v_accvgpr_write_b32 a114, v122
  v_perm_b32 v123, v55, v51, s71
  v_accvgpr_write_b32 a115, v123
  s_mov_b32 s58, 98304
  buffer_load_dwordx4 v[24:27], v18, s[48:51], s58 offen
  s_mov_b32 s59, 99328
  buffer_load_dwordx4 v[28:31], v18, s[48:51], s59 offen
  s_mov_b32 s60, 100352
  buffer_load_dwordx4 v[32:35], v18, s[48:51], s60 offen
  s_mov_b32 s61, 101376
  buffer_load_dwordx4 v[36:39], v18, s[48:51], s61 offen
  s_mov_b32 s58, 102400
  buffer_load_dwordx4 v[40:43], v18, s[48:51], s58 offen
  s_mov_b32 s59, 103424
  buffer_load_dwordx4 v[44:47], v18, s[48:51], s59 offen
  s_mov_b32 s60, 104448
  buffer_load_dwordx4 v[48:51], v18, s[48:51], s60 offen
  s_mov_b32 s61, 105472
  buffer_load_dwordx4 v[52:55], v18, s[48:51], s61 offen
  s_waitcnt vmcnt(22)
  v_perm_b32 v120, v60, v56, s70
  v_accvgpr_write_b32 a4, v120
  s_waitcnt vmcnt(20)
  v_perm_b32 v121, v68, v64, s70
  v_accvgpr_write_b32 a5, v121
  s_waitcnt vmcnt(18)
  v_perm_b32 v122, v76, v72, s70
  v_accvgpr_write_b32 a6, v122
  s_waitcnt vmcnt(16)
  v_perm_b32 v123, v84, v80, s70
  v_accvgpr_write_b32 a7, v123
  v_perm_b32 v120, v60, v56, s71
  v_accvgpr_write_b32 a20, v120
  v_perm_b32 v121, v68, v64, s71
  v_accvgpr_write_b32 a21, v121
  v_perm_b32 v122, v76, v72, s71
  v_accvgpr_write_b32 a22, v122
  v_perm_b32 v123, v84, v80, s71
  v_accvgpr_write_b32 a23, v123
  v_perm_b32 v120, v61, v57, s70
  v_accvgpr_write_b32 a36, v120
  v_perm_b32 v121, v69, v65, s70
  v_accvgpr_write_b32 a37, v121
  v_perm_b32 v122, v77, v73, s70
  v_accvgpr_write_b32 a38, v122
  v_perm_b32 v123, v85, v81, s70
  v_accvgpr_write_b32 a39, v123
  v_perm_b32 v120, v61, v57, s71
  v_accvgpr_write_b32 a52, v120
  v_perm_b32 v121, v69, v65, s71
  v_accvgpr_write_b32 a53, v121
  v_perm_b32 v122, v77, v73, s71
  v_accvgpr_write_b32 a54, v122
  v_perm_b32 v123, v85, v81, s71
  v_accvgpr_write_b32 a55, v123
  v_perm_b32 v120, v62, v58, s70
  v_accvgpr_write_b32 a68, v120
  v_perm_b32 v121, v70, v66, s70
  v_accvgpr_write_b32 a69, v121
  v_perm_b32 v122, v78, v74, s70
  v_accvgpr_write_b32 a70, v122
  v_perm_b32 v123, v86, v82, s70
  v_accvgpr_write_b32 a71, v123
  v_perm_b32 v120, v62, v58, s71
  v_accvgpr_write_b32 a84, v120
  v_perm_b32 v121, v70, v66, s71
  v_accvgpr_write_b32 a85, v121
  v_perm_b32 v122, v78, v74, s71
  v_accvgpr_write_b32 a86, v122
  v_perm_b32 v123, v86, v82, s71
  v_accvgpr_write_b32 a87, v123
  v_perm_b32 v120, v63, v59, s70
  v_accvgpr_write_b32 a100, v120
  v_perm_b32 v121, v71, v67, s70
  v_accvgpr_write_b32 a101, v121
  v_perm_b32 v122, v79, v75, s70
  v_accvgpr_write_b32 a102, v122
  v_perm_b32 v123, v87, v83, s70
  v_accvgpr_write_b32 a103, v123
  v_perm_b32 v120, v63, v59, s71
  v_accvgpr_write_b32 a116, v120
  v_perm_b32 v121, v71, v67, s71
  v_accvgpr_write_b32 a117, v121
  v_perm_b32 v122, v79, v75, s71
  v_accvgpr_write_b32 a118, v122
  v_perm_b32 v123, v87, v83, s71
  v_accvgpr_write_b32 a119, v123
  s_waitcnt vmcnt(14)
  v_perm_b32 v120, v92, v88, s70
  v_accvgpr_write_b32 a8, v120
  s_waitcnt vmcnt(12)
  v_perm_b32 v121, v100, v96, s70
  v_accvgpr_write_b32 a9, v121
  s_waitcnt vmcnt(10)
  v_perm_b32 v122, v108, v104, s70
  v_accvgpr_write_b32 a10, v122
  s_waitcnt vmcnt(8)
  v_perm_b32 v123, v116, v112, s70
  v_accvgpr_write_b32 a11, v123
  v_perm_b32 v120, v92, v88, s71
  v_accvgpr_write_b32 a24, v120
  v_perm_b32 v121, v100, v96, s71
  v_accvgpr_write_b32 a25, v121
  v_perm_b32 v122, v108, v104, s71
  v_accvgpr_write_b32 a26, v122
  v_perm_b32 v123, v116, v112, s71
  v_accvgpr_write_b32 a27, v123
  v_perm_b32 v120, v93, v89, s70
  v_accvgpr_write_b32 a40, v120
  v_perm_b32 v121, v101, v97, s70
  v_accvgpr_write_b32 a41, v121
  v_perm_b32 v122, v109, v105, s70
  v_accvgpr_write_b32 a42, v122
  v_perm_b32 v123, v117, v113, s70
  v_accvgpr_write_b32 a43, v123
  v_perm_b32 v120, v93, v89, s71
  v_accvgpr_write_b32 a56, v120
  v_perm_b32 v121, v101, v97, s71
  v_accvgpr_write_b32 a57, v121
  v_perm_b32 v122, v109, v105, s71
  v_accvgpr_write_b32 a58, v122
  v_perm_b32 v123, v117, v113, s71
  v_accvgpr_write_b32 a59, v123
  v_perm_b32 v120, v94, v90, s70
  v_accvgpr_write_b32 a72, v120
  v_perm_b32 v121, v102, v98, s70
  v_accvgpr_write_b32 a73, v121
  v_perm_b32 v122, v110, v106, s70
  v_accvgpr_write_b32 a74, v122
  v_perm_b32 v123, v118, v114, s70
  v_accvgpr_write_b32 a75, v123
  v_perm_b32 v120, v94, v90, s71
  v_accvgpr_write_b32 a88, v120
  v_perm_b32 v121, v102, v98, s71
  v_accvgpr_write_b32 a89, v121
  v_perm_b32 v122, v110, v106, s71
  v_accvgpr_write_b32 a90, v122
  v_perm_b32 v123, v118, v114, s71
  v_accvgpr_write_b32 a91, v123
  v_perm_b32 v120, v95, v91, s70
  v_accvgpr_write_b32 a104, v120
  v_perm_b32 v121, v103, v99, s70
  v_accvgpr_write_b32 a105, v121
  v_perm_b32 v122, v111, v107, s70
  v_accvgpr_write_b32 a106, v122
  v_perm_b32 v123, v119, v115, s70
  v_accvgpr_write_b32 a107, v123
  v_perm_b32 v120, v95, v91, s71
  v_accvgpr_write_b32 a120, v120
  v_perm_b32 v121, v103, v99, s71
  v_accvgpr_write_b32 a121, v121
  v_perm_b32 v122, v111, v107, s71
  v_accvgpr_write_b32 a122, v122
  v_perm_b32 v123, v119, v115, s71
  v_accvgpr_write_b32 a123, v123
  s_waitcnt vmcnt(6)
  v_perm_b32 v120, v28, v24, s70
  v_accvgpr_write_b32 a12, v120
  s_waitcnt vmcnt(4)
  v_perm_b32 v121, v36, v32, s70
  v_accvgpr_write_b32 a13, v121
  s_waitcnt vmcnt(2)
  v_perm_b32 v122, v44, v40, s70
  v_accvgpr_write_b32 a14, v122
  s_waitcnt vmcnt(0)
  v_perm_b32 v123, v52, v48, s70
  v_accvgpr_write_b32 a15, v123
  v_perm_b32 v120, v28, v24, s71
  v_accvgpr_write_b32 a28, v120
  v_perm_b32 v121, v36, v32, s71
  v_accvgpr_write_b32 a29, v121
  v_perm_b32 v122, v44, v40, s71
  v_accvgpr_write_b32 a30, v122
  v_perm_b32 v123, v52, v48, s71
  v_accvgpr_write_b32 a31, v123
  v_perm_b32 v120, v29, v25, s70
  v_accvgpr_write_b32 a44, v120
  v_perm_b32 v121, v37, v33, s70
  v_accvgpr_write_b32 a45, v121
  v_perm_b32 v122, v45, v41, s70
  v_accvgpr_write_b32 a46, v122
  v_perm_b32 v123, v53, v49, s70
  v_accvgpr_write_b32 a47, v123
  v_perm_b32 v120, v29, v25, s71
  v_accvgpr_write_b32 a60, v120
  v_perm_b32 v121, v37, v33, s71
  v_accvgpr_write_b32 a61, v121
  v_perm_b32 v122, v45, v41, s71
  v_accvgpr_write_b32 a62, v122
  v_perm_b32 v123, v53, v49, s71
  v_accvgpr_write_b32 a63, v123
  v_perm_b32 v120, v30, v26, s70
  v_accvgpr_write_b32 a76, v120
  v_perm_b32 v121, v38, v34, s70
  v_accvgpr_write_b32 a77, v121
  v_perm_b32 v122, v46, v42, s70
  v_accvgpr_write_b32 a78, v122
  v_perm_b32 v123, v54, v50, s70
  v_accvgpr_write_b32 a79, v123
  v_perm_b32 v120, v30, v26, s71
  v_accvgpr_write_b32 a92, v120
  v_perm_b32 v121, v38, v34, s71
  v_accvgpr_write_b32 a93, v121
  v_perm_b32 v122, v46, v42, s71
  v_accvgpr_write_b32 a94, v122
  v_perm_b32 v123, v54, v50, s71
  v_accvgpr_write_b32 a95, v123
  v_perm_b32 v120, v31, v27, s70
  v_accvgpr_write_b32 a108, v120
  v_perm_b32 v121, v39, v35, s70
  v_accvgpr_write_b32 a109, v121
  v_perm_b32 v122, v47, v43, s70
  v_accvgpr_write_b32 a110, v122
  v_perm_b32 v123, v55, v51, s70
  v_accvgpr_write_b32 a111, v123
  v_perm_b32 v120, v31, v27, s71
  v_accvgpr_write_b32 a124, v120
  v_perm_b32 v121, v39, v35, s71
  v_accvgpr_write_b32 a125, v121
  v_perm_b32 v122, v47, v43, s71
  v_accvgpr_write_b32 a126, v122
  v_perm_b32 v123, v55, v51, s71
  v_accvgpr_write_b32 a127, v123
  v_and_b32 v100, 15, v1
  v_lshrrev_b32 v101, 4, v1
  v_lshlrev_b32 v2, 4, v1
  v_lshlrev_b32 v3, 6, v100
  v_lshlrev_b32 v102, 4, v101
  v_add_u32 v3, v3, v102
  v_lshrrev_b32 v102, 2, v100
  v_lshlrev_b32 v102, 1, v102
  v_and_b32 v103, 1, v100
  v_add_u32 v102, v102, v103
  v_lshlrev_b32 v102, 6, v102
  v_lshlrev_b32 v103, 4, v101
  v_add_u32 v4, v102, v103
  v_lshlrev_b32 v102, 9, v101
  v_lshlrev_b32 v103, 3, v100
  v_add_u32 v102, v102, v103
  s_lshr_b32 s56, s9, 1
  s_lshl_b32 s56, s56, 8
  v_add_u32 v5, s56, v102
  v_lshlrev_b32 v102, 17, v101
  v_lshlrev_b32 v103, 4, v100
  v_add_u32 v102, v102, v103
  s_lshl_b32 s56, s9, 8
  s_lshl_b32 s57, s8, 10
  s_add_u32 s56, s56, s57
  v_add_u32 v6, s56, v102
  v_lshlrev_b32 v102, 10, v101
  v_lshlrev_b32 v103, 4, v100
  v_add_u32 v102, v102, v103
  s_lshl_b32 s56, s9, 8
  v_add_u32 v7, s56, v102
  v_and_b32 v102, 1, v101
  v_lshlrev_b32 v102, 3, v102
  v_add_u32 v102, v102, v103
  s_lshl_b32 s56, s9, 8
  v_add_u32 v8, s56, v102
  v_and_b32 v102, 7, v100
  v_mov_b32 v103, 0x3f80
  v_cmp_eq_u32 vcc, 0, v102
  s_nop 1
  v_cndmask_b32 v10, 0, v103, vcc
  v_mov_b32 v103, 0x3f800000
  v_cmp_eq_u32 vcc, 1, v102
  s_nop 1
  v_cndmask_b32 v10, v10, v103, vcc
  v_mov_b32 v103, 0x3f80
  v_cmp_eq_u32 vcc, 2, v102
  s_nop 1
  v_cndmask_b32 v11, 0, v103, vcc
  v_mov_b32 v103, 0x3f800000
  v_cmp_eq_u32 vcc, 3, v102
  s_nop 1
  v_cndmask_b32 v11, v11, v103, vcc
  v_mov_b32 v103, 0x3f80
  v_cmp_eq_u32 vcc, 4, v102
  s_nop 1
  v_cndmask_b32 v12, 0, v103, vcc
  v_mov_b32 v103, 0x3f800000
  v_cmp_eq_u32 vcc, 5, v102
  s_nop 1
  v_cndmask_b32 v12, v12, v103, vcc
  v_mov_b32 v103, 0x3f80
  v_cmp_eq_u32 vcc, 6, v102
  s_nop 1
  v_cndmask_b32 v13, 0, v103, vcc
  v_mov_b32 v103, 0x3f800000
  v_cmp_eq_u32 vcc, 7, v102
  s_nop 1
  v_cndmask_b32 v13, v13, v103, vcc
  v_mov_b32 v14, 0x3f803f80
  v_mov_b32 v15, 0x3f803f80
  v_mov_b32 v16, 0x3f803f80
  v_mov_b32 v17, 0x3f803f80
  s_and_b32 s56, s9, 1
  s_lshl_b32 s56, s56, 4
  v_lshlrev_b32 v102, 2, v101
  v_sub_u32 v102, v100, v102
  v_add_u32 v102, s56, v102
  v_cmp_le_i32 s[72:73], 0, v102
  v_cmp_le_i32 s[74:75], 1, v102
  v_cmp_le_i32 s[76:77], 2, v102
  v_cmp_le_i32 s[78:79], 3, v102
  v_subrev_u32 v102, 16, v102
  v_cmp_le_i32 s[80:81], 0, v102
  v_cmp_le_i32 s[82:83], 1, v102
  v_cmp_le_i32 s[84:85], 2, v102
  v_cmp_le_i32 s[86:87], 3, v102
  s_cmp_lg_u32 s9, 0
  s_nop 2
  s_cbranch_scc1 L_nma11d
  v_mov_b32 v125, 45056
  s_mov_b32 s43, 0
L_nma11:
    buffer_load_dword v124, v125, s[4:7], 0 offen sc1
    s_waitcnt vmcnt(0)
  v_readfirstlane_b32 s63, v124
  s_nop 0
  s_cmp_ge_u32 s63, 32
  s_nop 1
  s_cbranch_scc1 L_nma11d
  s_sleep 4
  s_add_u32 s43, s43, 1
  s_cmp_lt_u32 s43, 400000
  s_cbranch_scc1 L_nma11
  s_branch L_bail
L_nma11d:
  s_barrier
  s_cmp_lg_u32 s9, 0
  s_cbranch_scc1 L_nmb12d
  v_mov_b32 v125, 45184
  s_mov_b32 s43, 0
L_nmb12:
    buffer_load_dword v124, v125, s[4:7], 0 offen sc1
    s_waitcnt vmcnt(0)
  v_readfirstlane_b32 s63, v124
  s_nop 0
  s_cmp_ge_u32 s63, 64
  s_nop 1
  s_cbranch_scc1 L_nmb12d
  s_sleep 4
  s_add_u32 s43, s43, 1
  s_cmp_lt_u32 s43, 400000
  s_cbranch_scc1 L_nmb12
  s_branch L_bail
L_nmb12d:
  s_barrier
  v_lshlrev_b32 v102, 1, v8
  s_mov_b32 s56, 69632
  buffer_load_dwordx4 v[18:21], v102, s[4:7], s56 offen sc1
  s_mov_b32 s56, 73728
  buffer_load_dwordx4 v[22:25], v102, s[4:7], s56 offen sc1
  s_mov_b32 s56, 71680
  buffer_load_dwordx4 v[26:29], v102, s[4:7], s56 offen sc1
  s_waitcnt vmcnt(1)
  v_add_f32 v22, 1.0, v22
  v_cvt_pk_bf16_f32 v22, v22, v22
  v_lshlrev_b32 v22, 16, v22
  v_add_f32 v23, 1.0, v23
  v_cvt_pk_bf16_f32 v23, v23, v23
  v_lshlrev_b32 v23, 16, v23
  v_add_f32 v24, 1.0, v24
  v_cvt_pk_bf16_f32 v24, v24, v24
  v_lshlrev_b32 v24, 16, v24
  v_add_f32 v25, 1.0, v25
  v_cvt_pk_bf16_f32 v25, v25, v25
  v_lshlrev_b32 v25, 16, v25
  s_mov_b32 s38, 0x3e0293ee
  s_load_dwordx2 s[44:45], s[0:1], 0
  s_waitcnt lgkmcnt(0)
  s_mov_b32 s46, 2097152
  s_mov_b32 s47, 0x20000
  s_lshl_b32 s15, s11, 7
  s_add_u32 s15, s15, 45440
  s_cmp_lg_u32 s9, 0
  s_cbranch_scc1 L_caa13
  v_mov_b32 v124, 1
  v_mov_b32 v125, s15
  s_mov_b64 exec, 1
    buffer_atomic_add v124, v125, s[4:7], 0 offen sc1
  s_mov_b64 exec, -1
L_caa13:
  s_cmp_lg_u32 s9, 0
  s_cbranch_scc1 L_na14d
  v_mov_b32 v125, s15
  s_mov_b32 s43, 0
L_na14:
    buffer_load_dword v124, v125, s[4:7], 0 offen sc1
    s_waitcnt vmcnt(0)
  v_readfirstlane_b32 s63, v124
  s_nop 0
  s_cmp_ge_u32 s63, 32
  s_nop 1
  s_cbranch_scc1 L_na14d
  s_sleep 4
  s_add_u32 s43, s43, 1
  s_cmp_lt_u32 s43, 400000
  s_cbranch_scc1 L_na14
  s_branch L_bail
L_na14d:
  s_barrier
  s_lshl_b32 s15, s11, 2
  s_add_u32 s15, s15, 96
  v_mov_b32 v125, s15
  buffer_load_dword v124, v125, s[52:55], 0 offen sc1
  s_waitcnt vmcnt(0)
  v_readfirstlane_b32 s15, v124
  s_nop 0
  s_cmp_lg_u32 s15, 0
  s_nop 1
  s_cbranch_scc1 L_as_start
L_af_start:
  s_mov_b32 s10, s16
  s_add_u32 s56, s16, 48
  s_cmp_ge_u32 s16, 3
  s_cselect_b32 s10, s56, s10
  s_mov_b32 s12, 0
  s_add_u32 s18, s10, 1
  s_lshl_b32 s19, s8, 7
  s_mov_b32 s30, 0
  s_mov_b32 s31, 0
  s_add_u32 s21, s19, 8192
  s_cmp_ge_u32 s30, s18
  s_cbranch_scc1 L_pgkv015d
  v_and_b32 v121, 3, v1
  v_lshlrev_b32 v121, 2, v121
  s_mov_b32 s43, 0
L_pgkv015:
    buffer_load_dword v120, v121, s[4:7], s21 offen sc1
    s_waitcnt vmcnt(0)
  v_readlane_b32 s30, v120, 0
  v_readlane_b32 s63, v120, 1
  s_nop 0
  s_min_u32 s30, s30, s63
  v_readlane_b32 s63, v120, 2
  s_nop 0
  s_min_u32 s30, s30, s63
  v_readlane_b32 s63, v120, 3
  s_nop 0
  s_min_u32 s30, s30, s63
  s_cmp_ge_u32 s30, s18
  s_nop 0
  s_cbranch_scc1 L_pgkv015d
  s_sleep 8
  s_add_u32 s43, s43, 1
  s_cmp_lt_u32 s43, 400000
  s_cbranch_scc1 L_pgkv015
  s_branch L_bail
L_pgkv015d:
  s_add_u32 s21, s19, 12288
  s_cmp_ge_u32 s31, s18
  s_cbranch_scc1 L_pgq016d
  v_and_b32 v121, 3, v1
  v_lshlrev_b32 v121, 2, v121
  s_mov_b32 s43, 0
L_pgq016:
    buffer_load_dword v120, v121, s[4:7], s21 offen sc1
    s_waitcnt vmcnt(0)
  v_readlane_b32 s31, v120, 0
  v_readlane_b32 s63, v120, 1
  s_nop 0
  s_min_u32 s31, s31, s63
  v_readlane_b32 s63, v120, 2
  s_nop 0
  s_min_u32 s31, s31, s63
  v_readlane_b32 s63, v120, 3
  s_nop 0
  s_min_u32 s31, s31, s63
  s_cmp_ge_u32 s31, s18
  s_nop 0
  s_cbranch_scc1 L_pgq016d
  s_sleep 8
  s_add_u32 s43, s43, 1
  s_cmp_lt_u32 s43, 400000
  s_cbranch_scc1 L_pgq016
  s_branch L_bail
L_pgq016d:
  s_lshl_b32 s56, s8, 19
  s_lshl_b32 s57, s10, 13
  s_add_u32 s56, s56, s57
  s_and_b32 s58, s9, 1
  s_lshl_b32 s58, s58, 10
  s_add_u32 s24, s56, 41943040
  s_add_u32 s24, s24, s58
  s_add_u32 s25, s56, 8388608
  s_lshr_b32 s58, s9, 1
  s_lshl_b32 s58, s58, 12
  s_add_u32 s26, s56, 25165824
  s_add_u32 s26, s26, s58
  s_add_u32 s59, s24, 0
  buffer_load_dwordx4 v[128:131], v3, s[4:7], s59 offen sc1
  s_add_u32 s60, s25, 0
  buffer_load_dwordx4 v[144:147], v3, s[4:7], s60 offen offset:0 sc1
  buffer_load_dwordx4 v[160:163], v3, s[4:7], s60 offen offset:1024 sc1
  s_add_u32 s59, s24, 2048
  buffer_load_dwordx4 v[132:135], v3, s[4:7], s59 offen sc1
  s_add_u32 s60, s25, 2048
  buffer_load_dwordx4 v[148:151], v3, s[4:7], s60 offen offset:0 sc1
  buffer_load_dwordx4 v[164:167], v3, s[4:7], s60 offen offset:1024 sc1
  s_add_u32 s59, s24, 4096
  buffer_load_dwordx4 v[136:139], v3, s[4:7], s59 offen sc1
  s_add_u32 s60, s25, 4096
  buffer_load_dwordx4 v[152:155], v3, s[4:7], s60 offen offset:0 sc1
  buffer_load_dwordx4 v[168:171], v3, s[4:7], s60 offen offset:1024 sc1
  s_add_u32 s59, s24, 6144
  buffer_load_dwordx4 v[140:143], v3, s[4:7], s59 offen sc1
  s_add_u32 s60, s25, 6144
  buffer_load_dwordx4 v[156:159], v3, s[4:7], s60 offen offset:0 sc1
  buffer_load_dwordx4 v[172:175], v3, s[4:7], s60 offen offset:1024 sc1
  buffer_load_dwordx4 v[176:179], v3, s[4:7], s26 offen offset:0 sc1
  buffer_load_dwordx4 v[180:183], v3, s[4:7], s26 offen offset:1024 sc1
  buffer_load_dwordx4 v[184:187], v3, s[4:7], s26 offen offset:2048 sc1
  buffer_load_dwordx4 v[188:191], v3, s[4:7], s26 offen offset:3072 sc1
  s_waitcnt vmcnt(0)
L_af_loop:
  s_lshl_b32 s56, s16, 1
  s_add_u32 s56, s56, s12
  s_lshl_b32 s56, s56, 20
  s_add_u32 s13, s56, 67108864
  s_lshl_b32 s56, s10, 16
  s_lshl_b32 s57, s8, 11
  s_add_u32 s56, s56, s57
  s_add_u32 s27, s56, 58720256
  s_add_u32 s28, s56, 62914560
  s_add_u32 s18, s10, 1
  s_lshl_b32 s19, s8, 7
  s_add_u32 s21, s19, 16384
  s_cmp_lg_u32 s9, 0
  s_cbranch_scc1 L_wc17d
  v_and_b32 v121, 63, v1
  v_cmp_gt_u32 vcc, 4, v121
  v_lshlrev_b32 v121, 2, v121
  s_nop 0
  v_cndmask_b32 v121, 0, v121, vcc
  s_mov_b32 s43, 0
L_wc17:
    buffer_load_dword v120, v121, s[4:7], s21 offen sc1
    s_waitcnt vmcnt(0)
  v_cmp_gt_u32 vcc, s18, v120
  s_cbranch_vccz L_wc17d
  s_sleep 1
  s_add_u32 s43, s43, 1
  s_cmp_lt_u32 s43, 400000
  s_cbranch_scc1 L_wc17
  s_branch L_bail
L_wc17d:
  s_barrier
  buffer_load_dwordx4 v[80:83], v4, s[4:7], s27 offen offset:0 sc1
  buffer_load_dwordx4 v[84:87], v4, s[4:7], s27 offen offset:512 sc1
  buffer_load_dwordx4 v[88:91], v4, s[4:7], s27 offen offset:1024 sc1
  buffer_load_dwordx4 v[92:95], v4, s[4:7], s27 offen offset:1536 sc1
  buffer_load_dwordx2 v[112:113], v5, s[4:7], s28 offen offset:0 sc1
  buffer_load_dwordx2 v[114:115], v5, s[4:7], s28 offen offset:128 sc1
  v_mfma_f32_16x16x32_bf16 v[116:119], v[144:147], v[128:131], 0
  v_mov_b32 v32, 0xff7fffff
  v_mov_b32 v41, 0
  v_mfma_f32_16x16x32_bf16 v[120:123], v[160:163], v[128:131], 0
  v_mov_b32 v42, 0
  v_mfma_f32_16x16x32_bf16 v[116:119], v[148:151], v[132:135], v[116:119]
  s_waitcnt vmcnt(5)
  v_mfma_f32_16x16x32_bf16 v[124:127], v[80:83], v[128:131], 0
  v_mfma_f32_16x16x32_bf16 v[120:123], v[164:167], v[132:135], v[120:123]
  v_mfma_f32_16x16x32_bf16 v[116:119], v[152:155], v[136:139], v[116:119]
  s_waitcnt vmcnt(4)
  v_mfma_f32_16x16x32_bf16 v[124:127], v[84:87], v[132:135], v[124:127]
  v_mfma_f32_16x16x32_bf16 v[120:123], v[168:171], v[136:139], v[120:123]
  v_mfma_f32_16x16x32_bf16 v[116:119], v[156:159], v[140:143], v[116:119]
  s_waitcnt vmcnt(3)
  v_mfma_f32_16x16x32_bf16 v[124:127], v[88:91], v[136:139], v[124:127]
  v_mfma_f32_16x16x32_bf16 v[120:123], v[172:175], v[140:143], v[120:123]
  v_cndmask_b32 v116, v32, v116, s[72:73]
  v_cndmask_b32 v117, v32, v117, s[74:75]
  s_waitcnt vmcnt(2)
  v_mfma_f32_16x16x32_bf16 v[124:127], v[92:95], v[140:143], v[124:127]
  v_cndmask_b32 v118, v32, v118, s[76:77]
  v_cndmask_b32 v119, v32, v119, s[78:79]
  v_max3_f32 v33, v116, v117, v118
  s_nop 0
  v_cndmask_b32 v120, v32, v120, s[80:81]
  v_cndmask_b32 v121, v32, v121, s[82:83]
  v_cndmask_b32 v122, v32, v122, s[84:85]
  v_max3_f32 v33, v33, v119, v120
  v_cndmask_b32 v123, v32, v123, s[86:87]
  v_max3_f32 v33, v33, v121, v122
  v_max3_f32 v33, v33, v123, v124
  v_max_f32 v33, v33, v125
  v_mov_b32 v34, v33
  s_nop 1
  v_permlane16_swap_b32 v33, v34
  v_max_f32 v33, v33, v34
  v_mov_b32 v34, v33
  s_nop 1
  v_permlane32_swap_b32 v33, v34
  v_max_f32 v33, v33, v34
  v_mul_f32 v33, s38, v33
  v_fma_f32 v116, v116, s38, -v33
  v_fma_f32 v117, v117, s38, -v33
  v_fma_f32 v118, v118, s38, -v33
  v_fma_f32 v119, v119, s38, -v33
  v_fma_f32 v120, v120, s38, -v33
  v_fma_f32 v121, v121, s38, -v33
  v_fma_f32 v122, v122, s38, -v33
  v_fma_f32 v123, v123, s38, -v33
  v_exp_f32 v116, v116
  v_exp_f32 v117, v117
  v_exp_f32 v118, v118
  v_exp_f32 v119, v119
  v_exp_f32 v120, v120
  v_exp_f32 v121, v121
  v_exp_f32 v122, v122
  v_exp_f32 v123, v123
  v_fma_f32 v124, v124, s38, -v33
  v_fma_f32 v125, v125, s38, -v33
  v_cvt_pk_bf16_f32 v36, v116, v117
  v_cvt_pk_bf16_f32 v37, v118, v119
  v_cvt_pk_bf16_f32 v38, v120, v121
  v_cvt_pk_bf16_f32 v39, v122, v123
  v_exp_f32 v124, v124
  v_exp_f32 v125, v125
  v_mfma_f32_16x16x32_bf16 v[116:119], v[14:17], v[36:39], 0
  v_cvt_pk_bf16_f32 v40, v124, v125
  v_mov_b32 v43, v40
  v_mfma_f32_16x16x32_bf16 v[48:51], v[176:179], v[36:39], 0
  v_mfma_f32_16x16x32_bf16 v[52:55], v[180:183], v[36:39], 0
  v_mfma_f32_16x16x32_bf16 v[56:59], v[184:187], v[36:39], 0
  v_mfma_f32_16x16x32_bf16 v[60:63], v[188:191], v[36:39], 0
  v_mfma_f32_16x16x16_bf16 v[116:119], v[14:15], v[40:41], v[116:119]
  s_waitcnt vmcnt(1)
  v_mfma_f32_16x16x16_bf16 v[48:51], v[112:113], v[40:41], v[48:51]
  v_mfma_f32_16x16x16_bf16 v[52:55], v[112:113], v[42:43], v[52:55]
  v_rcp_f32 v120, v116
  s_waitcnt vmcnt(0)
  v_mfma_f32_16x16x16_bf16 v[56:59], v[114:115], v[40:41], v[56:59]
  v_mul_f32 v48, v48, v120
  v_mul_f32 v49, v49, v120
  v_mfma_f32_16x16x16_bf16 v[60:63], v[114:115], v[42:43], v[60:63]
  v_mul_f32 v52, v52, v120
  v_mul_f32 v53, v53, v120
  v_mul_f32 v50, v50, v120
  v_mul_f32 v54, v54, v120
  v_mul_f32 v51, v51, v120
  v_mul_f32 v55, v55, v120
  v_mul_f32 v56, v56, v120
  v_mul_f32 v57, v57, v120
  v_mul_f32 v60, v60, v120
  v_mul_f32 v61, v61, v120
  v_mul_f32 v58, v58, v120
  v_mul_f32 v62, v62, v120
  v_mul_f32 v59, v59, v120
  v_mul_f32 v63, v63, v120
  v_cvt_pk_bf16_f32 v64, v48, v52
  v_cvt_pk_bf16_f32 v65, v49, v53
  v_cvt_pk_bf16_f32 v66, v50, v54
  v_cvt_pk_bf16_f32 v67, v51, v55
  v_cvt_pk_bf16_f32 v68, v56, v60
  v_cvt_pk_bf16_f32 v69, v57, v61
  v_cvt_pk_bf16_f32 v70, v58, v62
  v_cvt_pk_bf16_f32 v71, v59, v63
  s_add_u32 s29, s10, 4
  s_cmp_ge_u32 s10, 48
  s_cbranch_scc1 L_nsafa
  s_add_u32 s29, s10, 3
  s_cmp_lt_u32 s29, 48
  s_cbranch_scc1 L_nsafa
  s_add_u32 s29, s16, 48
L_nsafa:
  s_cmp_ge_u32 s29, 64
  s_cbranch_scc1 L_af_nopf
  s_add_u32 s18, s29, 1
  s_lshl_b32 s19, s8, 7
  s_add_u32 s21, s19, 8192
  s_cmp_ge_u32 s30, s18
  s_cbranch_scc1 L_pgkv18d
  v_and_b32 v121, 3, v1
  v_lshlrev_b32 v121, 2, v121
  s_mov_b32 s43, 0
L_pgkv18:
    buffer_load_dword v120, v121, s[4:7], s21 offen sc1
    s_waitcnt vmcnt(0)
  v_readlane_b32 s30, v120, 0
  v_readlane_b32 s63, v120, 1
  s_nop 0
  s_min_u32 s30, s30, s63
  v_readlane_b32 s63, v120, 2
  s_nop 0
  s_min_u32 s30, s30, s63
  v_readlane_b32 s63, v120, 3
  s_nop 0
  s_min_u32 s30, s30, s63
  s_cmp_ge_u32 s30, s18
  s_nop 0
  s_cbranch_scc1 L_pgkv18d
  s_sleep 8
  s_add_u32 s43, s43, 1
  s_cmp_lt_u32 s43, 400000
  s_cbranch_scc1 L_pgkv18
  s_branch L_bail
L_pgkv18d:
  s_add_u32 s21, s19, 12288
  s_cmp_ge_u32 s31, s18
  s_cbranch_scc1 L_pgq19d
  v_and_b32 v121, 3, v1
  v_lshlrev_b32 v121, 2, v121
  s_mov_b32 s43, 0
L_pgq19:
    buffer_load_dword v120, v121, s[4:7], s21 offen sc1
    s_waitcnt vmcnt(0)
  v_readlane_b32 s31, v120, 0
  v_readlane_b32 s63, v120, 1
  s_nop 0
  s_min_u32 s31, s31, s63
  v_readlane_b32 s63, v120, 2
  s_nop 0
  s_min_u32 s31, s31, s63
  v_readlane_b32 s63, v120, 3
  s_nop 0
  s_min_u32 s31, s31, s63
  s_cmp_ge_u32 s31, s18
  s_nop 0
  s_cbranch_scc1 L_pgq19d
  s_sleep 8
  s_add_u32 s43, s43, 1
  s_cmp_lt_u32 s43, 400000
  s_cbranch_scc1 L_pgq19
  s_branch L_bail
L_pgq19d:
  s_lshl_b32 s56, s8, 19
  s_lshl_b32 s57, s29, 13
  s_add_u32 s56, s56, s57
  s_and_b32 s58, s9, 1
  s_lshl_b32 s58, s58, 10
  s_add_u32 s24, s56, 41943040
  s_add_u32 s24, s24, s58
  s_add_u32 s25, s56, 8388608
  s_lshr_b32 s58, s9, 1
  s_lshl_b32 s58, s58, 12
  s_add_u32 s26, s56, 25165824
  s_add_u32 s26, s26, s58
  s_add_u32 s59, s24, 0
  buffer_load_dwordx4 v[128:131], v3, s[4:7], s59 offen sc1
  s_add_u32 s60, s25, 0
  buffer_load_dwordx4 v[144:147], v3, s[4:7], s60 offen offset:0 sc1
  buffer_load_dwordx4 v[160:163], v3, s[4:7], s60 offen offset:1024 sc1
  s_add_u32 s59, s24, 2048
  buffer_load_dwordx4 v[132:135], v3, s[4:7], s59 offen sc1
  s_add_u32 s60, s25, 2048
  buffer_load_dwordx4 v[148:151], v3, s[4:7], s60 offen offset:0 sc1
  buffer_load_dwordx4 v[164:167], v3, s[4:7], s60 offen offset:1024 sc1
  s_add_u32 s59, s24, 4096
  buffer_load_dwordx4 v[136:139], v3, s[4:7], s59 offen sc1
  s_add_u32 s60, s25, 4096
  buffer_load_dwordx4 v[152:155], v3, s[4:7], s60 offen offset:0 sc1
  buffer_load_dwordx4 v[168:171], v3, s[4:7], s60 offen offset:1024 sc1
  s_add_u32 s59, s24, 6144
  buffer_load_dwordx4 v[140:143], v3, s[4:7], s59 offen sc1
  s_add_u32 s60, s25, 6144
  buffer_load_dwordx4 v[156:159], v3, s[4:7], s60 offen offset:0 sc1
  buffer_load_dwordx4 v[172:175], v3, s[4:7], s60 offen offset:1024 sc1
  buffer_load_dwordx4 v[176:179], v3, s[4:7], s26 offen offset:0 sc1
  buffer_load_dwordx4 v[180:183], v3, s[4:7], s26 offen offset:1024 sc1
  buffer_load_dwordx4 v[184:187], v3, s[4:7], s26 offen offset:2048 sc1
  buffer_load_dwordx4 v[188:191], v3, s[4:7], s26 offen offset:3072 sc1
L_af_nopf:
  s_and_b32 s56, s9, 1
  s_lshl_b32 s56, s56, 12
  s_lshr_b32 s57, s9, 1
  s_lshl_b32 s57, s57, 11
  s_add_u32 s56, s56, s57
  v_add_u32 v121, s56, v2
  ds_write_b128 v121, v[64:67] offset:0
  ds_write_b128 v121, v[68:71] offset:1024
  s_waitcnt lgkmcnt(0)
  s_barrier
  ds_read_b128 v[32:35], v2 offset:0
  s_add_u32 s56, s13, 0
  s_add_u32 s57, s13, 32768
  s_add_u32 s58, s13, 65536
  ds_read_b128 v[36:39], v2 offset:1024
  s_add_u32 s59, s13, 98304
  s_add_u32 s60, s13, 524288
  s_add_u32 s61, s13, 557056
  ds_read_b128 v[40:43], v2 offset:2048
  s_nop 2
  ds_read_b128 v[44:47], v2 offset:3072
  s_nop 2
  ds_read_b128 v[48:51], v2 offset:4096
  s_waitcnt lgkmcnt(4)
  v_mfma_f32_16x16x32_bf16 v[64:67], v[32:35], a[0:3], 0
  s_nop 0
  ds_read_b128 v[52:55], v2 offset:5120
  s_waitcnt lgkmcnt(4)
  v_mfma_f32_16x16x32_bf16 v[64:67], v[36:39], a[4:7], v[64:67]
  s_nop 0
  ds_read_b128 v[56:59], v2 offset:6144
  s_waitcnt lgkmcnt(4)
  v_mfma_f32_16x16x32_bf16 v[64:67], v[40:43], a[8:11], v[64:67]
  s_nop 0
  ds_read_b128 v[60:63], v2 offset:7168
  s_waitcnt lgkmcnt(4)
  v_mfma_f32_16x16x32_bf16 v[64:67], v[44:47], a[12:15], v[64:67]
  v_mfma_f32_16x16x32_bf16 v[68:71], v[32:35], a[16:19], 0
  v_mfma_f32_16x16x32_bf16 v[68:71], v[36:39], a[20:23], v[68:71]
  v_mfma_f32_16x16x32_bf16 v[68:71], v[40:43], a[24:27], v[68:71]
  v_mfma_f32_16x16x32_bf16 v[68:71], v[44:47], a[28:31], v[68:71]
  v_mfma_f32_16x16x32_bf16 v[72:75], v[32:35], a[32:35], 0
  v_mfma_f32_16x16x32_bf16 v[72:75], v[36:39], a[36:39], v[72:75]
  v_cvt_pk_bf16_f32 v192, v64, v68
  v_cvt_pk_bf16_f32 v196, v65, v69
  v_mfma_f32_16x16x32_bf16 v[72:75], v[40:43], a[40:43], v[72:75]
  v_cvt_pk_bf16_f32 v200, v66, v70
  v_cvt_pk_bf16_f32 v204, v67, v71
  v_mfma_f32_16x16x32_bf16 v[72:75], v[44:47], a[44:47], v[72:75]
  v_mfma_f32_16x16x32_bf16 v[76:79], v[32:35], a[48:51], 0
  v_mfma_f32_16x16x32_bf16 v[76:79], v[36:39], a[52:55], v[76:79]
  v_mfma_f32_16x16x32_bf16 v[76:79], v[40:43], a[56:59], v[76:79]
  v_mfma_f32_16x16x32_bf16 v[76:79], v[44:47], a[60:63], v[76:79]
  v_mfma_f32_16x16x32_bf16 v[80:83], v[32:35], a[64:67], 0
  v_mfma_f32_16x16x32_bf16 v[80:83], v[36:39], a[68:71], v[80:83]
  v_cvt_pk_bf16_f32 v193, v72, v76
  v_cvt_pk_bf16_f32 v197, v73, v77
  v_mfma_f32_16x16x32_bf16 v[80:83], v[40:43], a[72:75], v[80:83]
  v_cvt_pk_bf16_f32 v201, v74, v78
  v_cvt_pk_bf16_f32 v205, v75, v79
  v_mfma_f32_16x16x32_bf16 v[80:83], v[44:47], a[76:79], v[80:83]
  v_mfma_f32_16x16x32_bf16 v[84:87], v[32:35], a[80:83], 0
  v_mfma_f32_16x16x32_bf16 v[84:87], v[36:39], a[84:87], v[84:87]
  v_mfma_f32_16x16x32_bf16 v[84:87], v[40:43], a[88:91], v[84:87]
  v_mfma_f32_16x16x32_bf16 v[84:87], v[44:47], a[92:95], v[84:87]
  v_mfma_f32_16x16x32_bf16 v[88:91], v[32:35], a[96:99], 0
  v_mfma_f32_16x16x32_bf16 v[88:91], v[36:39], a[100:103], v[88:91]
  v_cvt_pk_bf16_f32 v194, v80, v84
  v_cvt_pk_bf16_f32 v198, v81, v85
  v_mfma_f32_16x16x32_bf16 v[88:91], v[40:43], a[104:107], v[88:91]
  v_cvt_pk_bf16_f32 v202, v82, v86
  v_cvt_pk_bf16_f32 v206, v83, v87
  v_mfma_f32_16x16x32_bf16 v[88:91], v[44:47], a[108:111], v[88:91]
  v_mfma_f32_16x16x32_bf16 v[92:95], v[32:35], a[112:115], 0
  v_mfma_f32_16x16x32_bf16 v[92:95], v[36:39], a[116:119], v[92:95]
  v_mfma_f32_16x16x32_bf16 v[92:95], v[40:43], a[120:123], v[92:95]
  v_mfma_f32_16x16x32_bf16 v[92:95], v[44:47], a[124:127], v[92:95]
  s_waitcnt lgkmcnt(3)
  v_mfma_f32_16x16x32_bf16 v[96:99], v[48:51], a[0:3], 0
  s_waitcnt lgkmcnt(2)
  v_mfma_f32_16x16x32_bf16 v[96:99], v[52:55], a[4:7], v[96:99]
  v_cvt_pk_bf16_f32 v195, v88, v92
  buffer_store_dwordx4 v[192:195], v6, s[4:7], s56 offen
  s_waitcnt lgkmcnt(1)
  v_mfma_f32_16x16x32_bf16 v[96:99], v[56:59], a[8:11], v[96:99]
  s_add_u32 s56, s13, 589824
  v_cvt_pk_bf16_f32 v199, v89, v93
  buffer_store_dwordx4 v[196:199], v6, s[4:7], s57 offen
  s_waitcnt lgkmcnt(0)
  v_mfma_f32_16x16x32_bf16 v[96:99], v[60:63], a[12:15], v[96:99]
  s_add_u32 s57, s13, 622592
  v_cvt_pk_bf16_f32 v203, v90, v94
  buffer_store_dwordx4 v[200:203], v6, s[4:7], s58 offen
  v_mfma_f32_16x16x32_bf16 v[100:103], v[48:51], a[16:19], 0
  v_cvt_pk_bf16_f32 v207, v91, v95
  v_mfma_f32_16x16x32_bf16 v[100:103], v[52:55], a[20:23], v[100:103]
  v_mfma_f32_16x16x32_bf16 v[100:103], v[56:59], a[24:27], v[100:103]
  v_mfma_f32_16x16x32_bf16 v[100:103], v[60:63], a[28:31], v[100:103]
  v_mfma_f32_16x16x32_bf16 v[104:107], v[48:51], a[32:35], 0
  v_mfma_f32_16x16x32_bf16 v[104:107], v[52:55], a[36:39], v[104:107]
  v_cvt_pk_bf16_f32 v208, v96, v100
  v_cvt_pk_bf16_f32 v212, v97, v101
  buffer_store_dwordx4 v[204:207], v6, s[4:7], s59 offen
  v_mfma_f32_16x16x32_bf16 v[104:107], v[56:59], a[40:43], v[104:107]
  v_cvt_pk_bf16_f32 v216, v98, v102
  v_cvt_pk_bf16_f32 v220, v99, v103
  v_mfma_f32_16x16x32_bf16 v[104:107], v[60:63], a[44:47], v[104:107]
  v_mfma_f32_16x16x32_bf16 v[108:111], v[48:51], a[48:51], 0
  v_mfma_f32_16x16x32_bf16 v[108:111], v[52:55], a[52:55], v[108:111]
  v_mfma_f32_16x16x32_bf16 v[108:111], v[56:59], a[56:59], v[108:111]
  v_mfma_f32_16x16x32_bf16 v[108:111], v[60:63], a[60:63], v[108:111]
  v_mfma_f32_16x16x32_bf16 v[112:115], v[48:51], a[64:67], 0
  v_mfma_f32_16x16x32_bf16 v[112:115], v[52:55], a[68:71], v[112:115]
  v_cvt_pk_bf16_f32 v209, v104, v108
  v_cvt_pk_bf16_f32 v213, v105, v109
  v_mfma_f32_16x16x32_bf16 v[112:115], v[56:59], a[72:75], v[112:115]
  v_cvt_pk_bf16_f32 v217, v106, v110
  v_cvt_pk_bf16_f32 v221, v107, v111
  v_mfma_f32_16x16x32_bf16 v[112:115], v[60:63], a[76:79], v[112:115]
  v_mfma_f32_16x16x32_bf16 v[116:119], v[48:51], a[80:83], 0
  v_mfma_f32_16x16x32_bf16 v[116:119], v[52:55], a[84:87], v[116:119]
  v_mfma_f32_16x16x32_bf16 v[116:119], v[56:59], a[88:91], v[116:119]
  v_mfma_f32_16x16x32_bf16 v[116:119], v[60:63], a[92:95], v[116:119]
  v_mfma_f32_16x16x32_bf16 v[120:123], v[48:51], a[96:99], 0
  v_mfma_f32_16x16x32_bf16 v[120:123], v[52:55], a[100:103], v[120:123]
  v_cvt_pk_bf16_f32 v210, v112, v116
  v_cvt_pk_bf16_f32 v214, v113, v117
  v_mfma_f32_16x16x32_bf16 v[120:123], v[56:59], a[104:107], v[120:123]
  v_cvt_pk_bf16_f32 v218, v114, v118
  v_cvt_pk_bf16_f32 v222, v115, v119
  v_mfma_f32_16x16x32_bf16 v[120:123], v[60:63], a[108:111], v[120:123]
  v_mfma_f32_16x16x32_bf16 v[124:127], v[48:51], a[112:115], 0
  v_mfma_f32_16x16x32_bf16 v[124:127], v[52:55], a[116:119], v[124:127]
  v_mfma_f32_16x16x32_bf16 v[124:127], v[56:59], a[120:123], v[124:127]
  v_mfma_f32_16x16x32_bf16 v[124:127], v[60:63], a[124:127], v[124:127]
  s_nop 7
  v_cvt_pk_bf16_f32 v211, v120, v124
  buffer_store_dwordx4 v[208:211], v6, s[4:7], s60 offen
  v_cvt_pk_bf16_f32 v215, v121, v125
  buffer_store_dwordx4 v[212:215], v6, s[4:7], s61 offen
  v_cvt_pk_bf16_f32 v219, v122, v126
  v_cvt_pk_bf16_f32 v223, v123, v127
  buffer_store_dwordx4 v[216:219], v6, s[4:7], s56 offen
  buffer_store_dwordx4 v[220:223], v6, s[4:7], s57 offen
  s_waitcnt vmcnt(0)
  s_barrier
  s_lshl_b32 s21, s10, 7
  s_add_u32 s21, s21, 20480
  s_lshl_b32 s22, s8, 2
  s_add_u32 s22, s22, s21
  s_cmp_lg_u32 s9, 0
  s_cbranch_scc1 L_sg20
  v_cmp_eq_u32 vcc, 0, v1
  v_mov_b32 v120, 0x7ffffff0
  s_nop 0
  v_cndmask_b32 v121, v120, 0, vcc
  v_mov_b32 v120, 1
    buffer_store_dword v120, v121, s[4:7], s22 offen
L_sg20:
  s_cmp_lg_u32 s9, 0
  s_cbranch_scc1 L_wap21d
  v_and_b32 v121, 63, v1
  v_cmp_gt_u32 vcc, 32, v121
  v_lshlrev_b32 v121, 2, v121
  s_nop 0
  v_cndmask_b32 v121, 0, v121, vcc
  s_mov_b32 s43, 0
L_wap21:
    buffer_load_dword v120, v121, s[4:7], s21 offen sc1
    s_waitcnt vmcnt(0)
  v_cmp_eq_u32 vcc, 0, v120
  s_cbranch_vccz L_wap21d
  s_sleep 1
  s_add_u32 s43, s43, 1
  s_cmp_lt_u32 s43, 400000
  s_cbranch_scc1 L_wap21
  s_branch L_bail
L_wap21d:
  s_barrier
  s_lshl_b32 s56, s8, 15
  s_add_u32 s56, s56, s13
  s_lshl_b32 s57, s10, 15
  s_lshl_b32 s58, s8, 10
  s_add_u32 s24, s57, s58
  buffer_load_dwordx2 v[68:69], v8, s[44:47], s24 offen
  s_add_u32 s59, s56, 0
  buffer_load_dwordx4 v[32:35], v7, s[4:7], s59 offen sc1
  s_add_u32 s59, s56, 4096
  buffer_load_dwordx4 v[36:39], v7, s[4:7], s59 offen sc1
  s_add_u32 s59, s56, 8192
  buffer_load_dwordx4 v[40:43], v7, s[4:7], s59 offen sc1
  s_add_u32 s59, s56, 12288
  buffer_load_dwordx4 v[44:47], v7, s[4:7], s59 offen sc1
  s_add_u32 s59, s56, 16384
  buffer_load_dwordx4 v[48:51], v7, s[4:7], s59 offen sc1
  s_add_u32 s59, s56, 20480
  buffer_load_dwordx4 v[52:55], v7, s[4:7], s59 offen sc1
  s_add_u32 s59, s56, 24576
  buffer_load_dwordx4 v[56:59], v7, s[4:7], s59 offen sc1
  s_add_u32 s59, s56, 28672
  buffer_load_dwordx4 v[60:63], v7, s[4:7], s59 offen sc1
  s_waitcnt vmcnt(7)
  v_mfma_f32_16x16x32_bf16 v[64:67], v[10:13], v[32:35], 0
  s_waitcnt vmcnt(6)
  v_mfma_f32_16x16x32_bf16 v[64:67], v[10:13], v[36:39], v[64:67]
  s_waitcnt vmcnt(5)
  v_mfma_f32_16x16x32_bf16 v[64:67], v[10:13], v[40:43], v[64:67]
  s_waitcnt vmcnt(4)
  v_mfma_f32_16x16x32_bf16 v[64:67], v[10:13], v[44:47], v[64:67]
  s_waitcnt vmcnt(3)
  v_mfma_f32_16x16x32_bf16 v[64:67], v[10:13], v[48:51], v[64:67]
  s_waitcnt vmcnt(2)
  v_mfma_f32_16x16x32_bf16 v[64:67], v[10:13], v[52:55], v[64:67]
  s_waitcnt vmcnt(1)
  v_mfma_f32_16x16x32_bf16 v[64:67], v[10:13], v[56:59], v[64:67]
  s_waitcnt vmcnt(0)
  v_mfma_f32_16x16x32_bf16 v[64:67], v[10:13], v[60:63], v[64:67]
  v_lshlrev_b32 v72, 16, v68
  v_and_b32 v73, 0xffff0000, v68
  v_lshlrev_b32 v74, 16, v69
  v_and_b32 v75, 0xffff0000, v69
  s_nop 3
  v_fma_f32 v72, v64, v18, v72
  v_fma_f32 v73, v65, v19, v73
  v_fma_f32 v74, v66, v20, v74
  v_fma_f32 v75, v67, v21, v75
  v_cvt_pk_bf16_f32 v68, v72, v73
  v_cvt_pk_bf16_f32 v69, v74, v75
  s_add_u32 s25, s24, 4194304
  buffer_store_dwordx2 v[68:69], v8, s[4:7], s25 offen sc1
  v_lshlrev_b32 v72, 16, v68
  v_and_b32 v73, 0xffff0000, v68
  v_lshlrev_b32 v74, 16, v69
  v_and_b32 v75, 0xffff0000, v69
  v_add_f32 v77, v72, v73
  v_add_f32 v76, v74, v75
  v_add_f32 v77, v77, v76
  v_mul_f32 v78, v72, v72
  v_fmac_f32 v78, v73, v73
  v_fmac_f32 v78, v74, v74
  v_fmac_f32 v78, v75, v75
  v_add_f32_dpp v77, v77, v77 row_ror:1 row_mask:0xf bank_mask:0xf
  s_nop 1
  v_add_f32_dpp v77, v77, v77 row_ror:2 row_mask:0xf bank_mask:0xf
  s_nop 1
  v_add_f32_dpp v77, v77, v77 row_ror:4 row_mask:0xf bank_mask:0xf
  s_nop 1
  v_add_f32_dpp v77, v77, v77 row_ror:8 row_mask:0xf bank_mask:0xf
  v_mov_b32 v76, v77
  s_nop 1
  v_permlane16_swap_b32 v77, v76
  v_add_f32 v77, v77, v76
  v_mov_b32 v76, v77
  s_nop 1
  v_permlane32_swap_b32 v77, v76
  v_add_f32 v77, v77, v76
  v_add_f32_dpp v78, v78, v78 row_ror:1 row_mask:0xf bank_mask:0xf
  s_nop 1
  v_add_f32_dpp v78, v78, v78 row_ror:2 row_mask:0xf bank_mask:0xf
  s_nop 1
  v_add_f32_dpp v78, v78, v78 row_ror:4 row_mask:0xf bank_mask:0xf
  s_nop 1
  v_add_f32_dpp v78, v78, v78 row_ror:8 row_mask:0xf bank_mask:0xf
  v_mov_b32 v76, v78
  s_nop 1
  v_permlane16_swap_b32 v78, v76
  v_add_f32 v78, v78, v76
  v_mov_b32 v76, v78
  s_nop 1
  v_permlane32_swap_b32 v78, v76
  v_add_f32 v78, v78, v76
  s_lshl_b32 s56, s9, 3
  s_add_u32 s56, s56, 8192
  v_mov_b32 v76, s56
  v_mov_b32 v82, v77
  v_mov_b32 v83, v78
  ds_write_b64 v76, v[82:83]
  s_waitcnt lgkmcnt(0)
  s_barrier
  v_mov_b32 v76, 8192
  ds_read_b128 v[84:87], v76
  ds_read_b128 v[88:91], v76 offset:16
  s_waitcnt lgkmcnt(1)
  v_add_f32 v77, v84, v86
  s_waitcnt lgkmcnt(0)
  v_add_f32 v76, v88, v90
  v_add_f32 v77, v77, v76
  v_add_f32 v78, v85, v87
  v_add_f32 v76, v89, v91
  v_add_f32 v78, v78, v76
  v_mul_f32 v77, 0x3a800000, v77
  v_mul_f32 v78, 0x3a800000, v78
  v_fma_f32 v78, -v77, v77, v78
  v_max_f32 v78, 0, v78
  v_add_f32 v78, 0x3727c5ac, v78
  v_rsq_f32 v78, v78
  v_sub_f32 v72, v72, v77
  v_mul_f32 v72, v72, v78
  v_fma_f32 v72, v72, v22, v26
  v_sub_f32 v73, v73, v77
  v_mul_f32 v73, v73, v78
  v_fma_f32 v73, v73, v23, v27
  v_sub_f32 v74, v74, v77
  v_mul_f32 v74, v74, v78
  v_fma_f32 v74, v74, v24, v28
  v_sub_f32 v75, v75, v77
  v_mul_f32 v75, v75, v78
  v_fma_f32 v75, v75, v25, v29
  v_cvt_pk_bf16_f32 v80, v72, v73
  v_cvt_pk_bf16_f32 v81, v74, v75
  s_add_u32 s25, s24, 6291456
  buffer_store_dwordx2 v[80:81], v8, s[4:7], s25 offen sc1
  s_waitcnt vmcnt(0)
  s_barrier
  s_lshl_b32 s21, s10, 7
  s_add_u32 s21, s21, 28672
  s_lshl_b32 s22, s8, 2
  s_add_u32 s22, s22, s21
  s_cmp_lg_u32 s9, 0
  s_cbranch_scc1 L_sg22
  v_cmp_eq_u32 vcc, 0, v1
  v_mov_b32 v120, 0x7ffffff0
  s_nop 0
  v_cndmask_b32 v121, v120, 0, vcc
  v_mov_b32 v120, 1
    buffer_store_dword v120, v121, s[4:7], s22 offen sc1
L_sg22:
  s_xor_b32 s12, s12, 1
  s_mov_b32 s10, s29
  s_cmp_lt_u32 s10, 64
  s_cbranch_scc1 L_af_loop
  s_waitcnt vmcnt(0)
  s_endpgm
L_as_start:
  s_mov_b32 s10, s16
  s_add_u32 s56, s16, 48
  s_cmp_ge_u32 s16, 3
  s_cselect_b32 s10, s56, s10
  s_mov_b32 s12, 0
  s_add_u32 s18, s10, 1
  s_lshl_b32 s19, s8, 7
  s_mov_b32 s30, 0
  s_mov_b32 s31, 0
  s_add_u32 s21, s19, 8192
  s_cmp_ge_u32 s30, s18
  s_cbranch_scc1 L_pgkv023d
  v_and_b32 v121, 3, v1
  v_lshlrev_b32 v121, 2, v121
  s_mov_b32 s43, 0
L_pgkv023:
    buffer_load_dword v120, v121, s[4:7], s21 offen sc1
    s_waitcnt vmcnt(0)
  v_readlane_b32 s30, v120, 0
  v_readlane_b32 s63, v120, 1
  s_nop 0
  s_min_u32 s30, s30, s63
  v_readlane_b32 s63, v120, 2
  s_nop 0
  s_min_u32 s30, s30, s63
  v_readlane_b32 s63, v120, 3
  s_nop 0
  s_min_u32 s30, s30, s63
  s_cmp_ge_u32 s30, s18
  s_nop 0
  s_cbranch_scc1 L_pgkv023d
  s_sleep 8
  s_add_u32 s43, s43, 1
  s_cmp_lt_u32 s43, 400000
  s_cbranch_scc1 L_pgkv023
  s_branch L_bail
L_pgkv023d:
  s_add_u32 s21, s19, 12288
  s_cmp_ge_u32 s31, s18
  s_cbranch_scc1 L_pgq024d
  v_and_b32 v121, 3, v1
  v_lshlrev_b32 v121, 2, v121
  s_mov_b32 s43, 0
L_pgq024:
    buffer_load_dword v120, v121, s[4:7], s21 offen sc1
    s_waitcnt vmcnt(0)
  v_readlane_b32 s31, v120, 0
  v_readlane_b32 s63, v120, 1
  s_nop 0
  s_min_u32 s31, s31, s63
  v_readlane_b32 s63, v120, 2
  s_nop 0
  s_min_u32 s31, s31, s63
  v_readlane_b32 s63, v120, 3
  s_nop 0
  s_min_u32 s31, s31, s63
  s_cmp_ge_u32 s31, s18
  s_nop 0
  s_cbranch_scc1 L_pgq024d
  s_sleep 8
  s_add_u32 s43, s43, 1
  s_cmp_lt_u32 s43, 400000
  s_cbranch_scc1 L_pgq024
  s_branch L_bail
L_pgq024d:
  s_lshl_b32 s56, s8, 19
  s_lshl_b32 s57, s10, 13
  s_add_u32 s56, s56, s57
  s_and_b32 s58, s9, 1
  s_lshl_b32 s58, s58, 10
  s_add_u32 s24, s56, 41943040
  s_add_u32 s24, s24, s58
  s_add_u32 s25, s56, 8388608
  s_lshr_b32 s58, s9, 1
  s_lshl_b32 s58, s58, 12
  s_add_u32 s26, s56, 25165824
  s_add_u32 s26, s26, s58
  s_add_u32 s59, s24, 0
  buffer_load_dwordx4 v[128:131], v3, s[4:7], s59 offen sc1
  s_add_u32 s60, s25, 0
  buffer_load_dwordx4 v[144:147], v3, s[4:7], s60 offen offset:0 sc1
  buffer_load_dwordx4 v[160:163], v3, s[4:7], s60 offen offset:1024 sc1
  s_add_u32 s59, s24, 2048
  buffer_load_dwordx4 v[132:135], v3, s[4:7], s59 offen sc1
  s_add_u32 s60, s25, 2048
  buffer_load_dwordx4 v[148:151], v3, s[4:7], s60 offen offset:0 sc1
  buffer_load_dwordx4 v[164:167], v3, s[4:7], s60 offen offset:1024 sc1
  s_add_u32 s59, s24, 4096
  buffer_load_dwordx4 v[136:139], v3, s[4:7], s59 offen sc1
  s_add_u32 s60, s25, 4096
  buffer_load_dwordx4 v[152:155], v3, s[4:7], s60 offen offset:0 sc1
  buffer_load_dwordx4 v[168:171], v3, s[4:7], s60 offen offset:1024 sc1
  s_add_u32 s59, s24, 6144
  buffer_load_dwordx4 v[140:143], v3, s[4:7], s59 offen sc1
  s_add_u32 s60, s25, 6144
  buffer_load_dwordx4 v[156:159], v3, s[4:7], s60 offen offset:0 sc1
  buffer_load_dwordx4 v[172:175], v3, s[4:7], s60 offen offset:1024 sc1
  buffer_load_dwordx4 v[176:179], v3, s[4:7], s26 offen offset:0 sc1
  buffer_load_dwordx4 v[180:183], v3, s[4:7], s26 offen offset:1024 sc1
  buffer_load_dwordx4 v[184:187], v3, s[4:7], s26 offen offset:2048 sc1
  buffer_load_dwordx4 v[188:191], v3, s[4:7], s26 offen offset:3072 sc1
  s_waitcnt vmcnt(0)
L_as_loop:
  s_lshl_b32 s56, s16, 1
  s_add_u32 s56, s56, s12
  s_lshl_b32 s56, s56, 20
  s_add_u32 s13, s56, 67108864
  s_lshl_b32 s56, s10, 16
  s_lshl_b32 s57, s8, 11
  s_add_u32 s56, s56, s57
  s_add_u32 s27, s56, 58720256
  s_add_u32 s28, s56, 62914560
  s_add_u32 s18, s10, 1
  s_lshl_b32 s19, s8, 7
  s_add_u32 s21, s19, 16384
  s_cmp_lg_u32 s9, 0
  s_cbranch_scc1 L_wc25d
  v_and_b32 v121, 63, v1
  v_cmp_gt_u32 vcc, 4, v121
  v_lshlrev_b32 v121, 2, v121
  s_nop 0
  v_cndmask_b32 v121, 0, v121, vcc
  s_mov_b32 s43, 0
L_wc25:
    buffer_load_dword v120, v121, s[4:7], s21 offen sc1
    s_waitcnt vmcnt(0)
  v_cmp_gt_u32 vcc, s18, v120
  s_cbranch_vccz L_wc25d
  s_sleep 1
  s_add_u32 s43, s43, 1
  s_cmp_lt_u32 s43, 400000
  s_cbranch_scc1 L_wc25
  s_branch L_bail
L_wc25d:
  s_barrier
  buffer_load_dwordx4 v[80:83], v4, s[4:7], s27 offen offset:0 sc1
  buffer_load_dwordx4 v[84:87], v4, s[4:7], s27 offen offset:512 sc1
  buffer_load_dwordx4 v[88:91], v4, s[4:7], s27 offen offset:1024 sc1
  buffer_load_dwordx4 v[92:95], v4, s[4:7], s27 offen offset:1536 sc1
  buffer_load_dwordx2 v[112:113], v5, s[4:7], s28 offen offset:0 sc1
  buffer_load_dwordx2 v[114:115], v5, s[4:7], s28 offen offset:128 sc1
  v_mfma_f32_16x16x32_bf16 v[116:119], v[144:147], v[128:131], 0
  v_mov_b32 v32, 0xff7fffff
  v_mov_b32 v41, 0
  v_mfma_f32_16x16x32_bf16 v[120:123], v[160:163], v[128:131], 0
  v_mov_b32 v42, 0
  v_mfma_f32_16x16x32_bf16 v[116:119], v[148:151], v[132:135], v[116:119]
  s_waitcnt vmcnt(5)
  v_mfma_f32_16x16x32_bf16 v[124:127], v[80:83], v[128:131], 0
  v_mfma_f32_16x16x32_bf16 v[120:123], v[164:167], v[132:135], v[120:123]
  v_mfma_f32_16x16x32_bf16 v[116:119], v[152:155], v[136:139], v[116:119]
  s_waitcnt vmcnt(4)
  v_mfma_f32_16x16x32_bf16 v[124:127], v[84:87], v[132:135], v[124:127]
  v_mfma_f32_16x16x32_bf16 v[120:123], v[168:171], v[136:139], v[120:123]
  v_mfma_f32_16x16x32_bf16 v[116:119], v[156:159], v[140:143], v[116:119]
  s_waitcnt vmcnt(3)
  v_mfma_f32_16x16x32_bf16 v[124:127], v[88:91], v[136:139], v[124:127]
  v_mfma_f32_16x16x32_bf16 v[120:123], v[172:175], v[140:143], v[120:123]
  v_cndmask_b32 v116, v32, v116, s[72:73]
  v_cndmask_b32 v117, v32, v117, s[74:75]
  s_waitcnt vmcnt(2)
  v_mfma_f32_16x16x32_bf16 v[124:127], v[92:95], v[140:143], v[124:127]
  v_cndmask_b32 v118, v32, v118, s[76:77]
  v_cndmask_b32 v119, v32, v119, s[78:79]
  v_max3_f32 v33, v116, v117, v118
  s_nop 0
  v_cndmask_b32 v120, v32, v120, s[80:81]
  v_cndmask_b32 v121, v32, v121, s[82:83]
  v_cndmask_b32 v122, v32, v122, s[84:85]
  v_max3_f32 v33, v33, v119, v120
  v_cndmask_b32 v123, v32, v123, s[86:87]
  v_max3_f32 v33, v33, v121, v122
  v_max3_f32 v33, v33, v123, v124
  v_max_f32 v33, v33, v125
  v_mov_b32 v34, v33
  s_nop 1
  v_permlane16_swap_b32 v33, v34
  v_max_f32 v33, v33, v34
  v_mov_b32 v34, v33
  s_nop 1
  v_permlane32_swap_b32 v33, v34
  v_max_f32 v33, v33, v34
  v_mul_f32 v33, s38, v33
  v_fma_f32 v116, v116, s38, -v33
  v_fma_f32 v117, v117, s38, -v33
  v_fma_f32 v118, v118, s38, -v33
  v_fma_f32 v119, v119, s38, -v33
  v_fma_f32 v120, v120, s38, -v33
  v_fma_f32 v121, v121, s38, -v33
  v_fma_f32 v122, v122, s38, -v33
  v_fma_f32 v123, v123, s38, -v33
  v_exp_f32 v116, v116
  v_exp_f32 v117, v117
  v_exp_f32 v118, v118
  v_exp_f32 v119, v119
  v_exp_f32 v120, v120
  v_exp_f32 v121, v121
  v_exp_f32 v122, v122
  v_exp_f32 v123, v123
  v_fma_f32 v124, v124, s38, -v33
  v_fma_f32 v125, v125, s38, -v33
  v_cvt_pk_bf16_f32 v36, v116, v117
  v_cvt_pk_bf16_f32 v37, v118, v119
  v_cvt_pk_bf16_f32 v38, v120, v121
  v_cvt_pk_bf16_f32 v39, v122, v123
  v_exp_f32 v124, v124
  v_exp_f32 v125, v125
  v_mfma_f32_16x16x32_bf16 v[116:119], v[14:17], v[36:39], 0
  v_cvt_pk_bf16_f32 v40, v124, v125
  v_mov_b32 v43, v40
  v_mfma_f32_16x16x32_bf16 v[48:51], v[176:179], v[36:39], 0
  v_mfma_f32_16x16x32_bf16 v[52:55], v[180:183], v[36:39], 0
  v_mfma_f32_16x16x32_bf16 v[56:59], v[184:187], v[36:39], 0
  v_mfma_f32_16x16x32_bf16 v[60:63], v[188:191], v[36:39], 0
  v_mfma_f32_16x16x16_bf16 v[116:119], v[14:15], v[40:41], v[116:119]
  s_waitcnt vmcnt(1)
  v_mfma_f32_16x16x16_bf16 v[48:51], v[112:113], v[40:41], v[48:51]
  v_mfma_f32_16x16x16_bf16 v[52:55], v[112:113], v[42:43], v[52:55]
  v_rcp_f32 v120, v116
  s_waitcnt vmcnt(0)
  v_mfma_f32_16x16x16_bf16 v[56:59], v[114:115], v[40:41], v[56:59]
  v_mul_f32 v48, v48, v120
  v_mul_f32 v49, v49, v120
  v_mfma_f32_16x16x16_bf16 v[60:63], v[114:115], v[42:43], v[60:63]
  v_mul_f32 v52, v52, v120
  v_mul_f32 v53, v53, v120
  v_mul_f32 v50, v50, v120
  v_mul_f32 v54, v54, v120
  v_mul_f32 v51, v51, v120
  v_mul_f32 v55, v55, v120
  v_mul_f32 v56, v56, v120
  v_mul_f32 v57, v57, v120
  v_mul_f32 v60, v60, v120
  v_mul_f32 v61, v61, v120
  v_mul_f32 v58, v58, v120
  v_mul_f32 v62, v62, v120
  v_mul_f32 v59, v59, v120
  v_mul_f32 v63, v63, v120
  v_cvt_pk_bf16_f32 v64, v48, v52
  v_cvt_pk_bf16_f32 v65, v49, v53
  v_cvt_pk_bf16_f32 v66, v50, v54
  v_cvt_pk_bf16_f32 v67, v51, v55
  v_cvt_pk_bf16_f32 v68, v56, v60
  v_cvt_pk_bf16_f32 v69, v57, v61
  v_cvt_pk_bf16_f32 v70, v58, v62
  v_cvt_pk_bf16_f32 v71, v59, v63
  s_add_u32 s29, s10, 4
  s_cmp_ge_u32 s10, 48
  s_cbranch_scc1 L_nsasa
  s_add_u32 s29, s10, 3
  s_cmp_lt_u32 s29, 48
  s_cbranch_scc1 L_nsasa
  s_add_u32 s29, s16, 48
L_nsasa:
  s_cmp_ge_u32 s29, 64
  s_cbranch_scc1 L_as_nopf
  s_add_u32 s18, s29, 1
  s_lshl_b32 s19, s8, 7
  s_add_u32 s21, s19, 8192
  s_cmp_ge_u32 s30, s18
  s_cbranch_scc1 L_pgkv26d
  v_and_b32 v121, 3, v1
  v_lshlrev_b32 v121, 2, v121
  s_mov_b32 s43, 0
L_pgkv26:
    buffer_load_dword v120, v121, s[4:7], s21 offen sc1
    s_waitcnt vmcnt(0)
  v_readlane_b32 s30, v120, 0
  v_readlane_b32 s63, v120, 1
  s_nop 0
  s_min_u32 s30, s30, s63
  v_readlane_b32 s63, v120, 2
  s_nop 0
  s_min_u32 s30, s30, s63
  v_readlane_b32 s63, v120, 3
  s_nop 0
  s_min_u32 s30, s30, s63
  s_cmp_ge_u32 s30, s18
  s_nop 0
  s_cbranch_scc1 L_pgkv26d
  s_sleep 8
  s_add_u32 s43, s43, 1
  s_cmp_lt_u32 s43, 400000
  s_cbranch_scc1 L_pgkv26
  s_branch L_bail
L_pgkv26d:
  s_add_u32 s21, s19, 12288
  s_cmp_ge_u32 s31, s18
  s_cbranch_scc1 L_pgq27d
  v_and_b32 v121, 3, v1
  v_lshlrev_b32 v121, 2, v121
  s_mov_b32 s43, 0
L_pgq27:
    buffer_load_dword v120, v121, s[4:7], s21 offen sc1
    s_waitcnt vmcnt(0)
  v_readlane_b32 s31, v120, 0
  v_readlane_b32 s63, v120, 1
  s_nop 0
  s_min_u32 s31, s31, s63
  v_readlane_b32 s63, v120, 2
  s_nop 0
  s_min_u32 s31, s31, s63
  v_readlane_b32 s63, v120, 3
  s_nop 0
  s_min_u32 s31, s31, s63
  s_cmp_ge_u32 s31, s18
  s_nop 0
  s_cbranch_scc1 L_pgq27d
  s_sleep 8
  s_add_u32 s43, s43, 1
  s_cmp_lt_u32 s43, 400000
  s_cbranch_scc1 L_pgq27
  s_branch L_bail
L_pgq27d:
  s_lshl_b32 s56, s8, 19
  s_lshl_b32 s57, s29, 13
  s_add_u32 s56, s56, s57
  s_and_b32 s58, s9, 1
  s_lshl_b32 s58, s58, 10
  s_add_u32 s24, s56, 41943040
  s_add_u32 s24, s24, s58
  s_add_u32 s25, s56, 8388608
  s_lshr_b32 s58, s9, 1
  s_lshl_b32 s58, s58, 12
  s_add_u32 s26, s56, 25165824
  s_add_u32 s26, s26, s58
  s_add_u32 s59, s24, 0
  buffer_load_dwordx4 v[128:131], v3, s[4:7], s59 offen sc1
  s_add_u32 s60, s25, 0
  buffer_load_dwordx4 v[144:147], v3, s[4:7], s60 offen offset:0 sc1
  buffer_load_dwordx4 v[160:163], v3, s[4:7], s60 offen offset:1024 sc1
  s_add_u32 s59, s24, 2048
  buffer_load_dwordx4 v[132:135], v3, s[4:7], s59 offen sc1
  s_add_u32 s60, s25, 2048
  buffer_load_dwordx4 v[148:151], v3, s[4:7], s60 offen offset:0 sc1
  buffer_load_dwordx4 v[164:167], v3, s[4:7], s60 offen offset:1024 sc1
  s_add_u32 s59, s24, 4096
  buffer_load_dwordx4 v[136:139], v3, s[4:7], s59 offen sc1
  s_add_u32 s60, s25, 4096
  buffer_load_dwordx4 v[152:155], v3, s[4:7], s60 offen offset:0 sc1
  buffer_load_dwordx4 v[168:171], v3, s[4:7], s60 offen offset:1024 sc1
  s_add_u32 s59, s24, 6144
  buffer_load_dwordx4 v[140:143], v3, s[4:7], s59 offen sc1
  s_add_u32 s60, s25, 6144
  buffer_load_dwordx4 v[156:159], v3, s[4:7], s60 offen offset:0 sc1
  buffer_load_dwordx4 v[172:175], v3, s[4:7], s60 offen offset:1024 sc1
  buffer_load_dwordx4 v[176:179], v3, s[4:7], s26 offen offset:0 sc1
  buffer_load_dwordx4 v[180:183], v3, s[4:7], s26 offen offset:1024 sc1
  buffer_load_dwordx4 v[184:187], v3, s[4:7], s26 offen offset:2048 sc1
  buffer_load_dwordx4 v[188:191], v3, s[4:7], s26 offen offset:3072 sc1
L_as_nopf:
  s_and_b32 s56, s9, 1
  s_lshl_b32 s56, s56, 12
  s_lshr_b32 s57, s9, 1
  s_lshl_b32 s57, s57, 11
  s_add_u32 s56, s56, s57
  v_add_u32 v121, s56, v2
  ds_write_b128 v121, v[64:67] offset:0
  ds_write_b128 v121, v[68:71] offset:1024
  s_waitcnt lgkmcnt(0)
  s_barrier
  ds_read_b128 v[32:35], v2 offset:0
  s_add_u32 s56, s13, 0
  s_add_u32 s57, s13, 32768
  s_add_u32 s58, s13, 65536
  ds_read_b128 v[36:39], v2 offset:1024
  s_add_u32 s59, s13, 98304
  s_add_u32 s60, s13, 524288
  s_add_u32 s61, s13, 557056
  ds_read_b128 v[40:43], v2 offset:2048
  s_nop 2
  ds_read_b128 v[44:47], v2 offset:3072
  s_nop 2
  ds_read_b128 v[48:51], v2 offset:4096
  s_waitcnt lgkmcnt(4)
  v_mfma_f32_16x16x32_bf16 v[64:67], v[32:35], a[0:3], 0
  s_nop 0
  ds_read_b128 v[52:55], v2 offset:5120
  s_waitcnt lgkmcnt(4)
  v_mfma_f32_16x16x32_bf16 v[64:67], v[36:39], a[4:7], v[64:67]
  s_nop 0
  ds_read_b128 v[56:59], v2 offset:6144
  s_waitcnt lgkmcnt(4)
  v_mfma_f32_16x16x32_bf16 v[64:67], v[40:43], a[8:11], v[64:67]
  s_nop 0
  ds_read_b128 v[60:63], v2 offset:7168
  s_waitcnt lgkmcnt(4)
  v_mfma_f32_16x16x32_bf16 v[64:67], v[44:47], a[12:15], v[64:67]
  v_mfma_f32_16x16x32_bf16 v[68:71], v[32:35], a[16:19], 0
  v_mfma_f32_16x16x32_bf16 v[68:71], v[36:39], a[20:23], v[68:71]
  v_mfma_f32_16x16x32_bf16 v[68:71], v[40:43], a[24:27], v[68:71]
  v_mfma_f32_16x16x32_bf16 v[68:71], v[44:47], a[28:31], v[68:71]
  v_mfma_f32_16x16x32_bf16 v[72:75], v[32:35], a[32:35], 0
  v_mfma_f32_16x16x32_bf16 v[72:75], v[36:39], a[36:39], v[72:75]
  v_cvt_pk_bf16_f32 v192, v64, v68
  v_cvt_pk_bf16_f32 v196, v65, v69
  v_mfma_f32_16x16x32_bf16 v[72:75], v[40:43], a[40:43], v[72:75]
  v_cvt_pk_bf16_f32 v200, v66, v70
  v_cvt_pk_bf16_f32 v204, v67, v71
  v_mfma_f32_16x16x32_bf16 v[72:75], v[44:47], a[44:47], v[72:75]
  v_mfma_f32_16x16x32_bf16 v[76:79], v[32:35], a[48:51], 0
  v_mfma_f32_16x16x32_bf16 v[76:79], v[36:39], a[52:55], v[76:79]
  v_mfma_f32_16x16x32_bf16 v[76:79], v[40:43], a[56:59], v[76:79]
  v_mfma_f32_16x16x32_bf16 v[76:79], v[44:47], a[60:63], v[76:79]
  v_mfma_f32_16x16x32_bf16 v[80:83], v[32:35], a[64:67], 0
  v_mfma_f32_16x16x32_bf16 v[80:83], v[36:39], a[68:71], v[80:83]
  v_cvt_pk_bf16_f32 v193, v72, v76
  v_cvt_pk_bf16_f32 v197, v73, v77
  v_mfma_f32_16x16x32_bf16 v[80:83], v[40:43], a[72:75], v[80:83]
  v_cvt_pk_bf16_f32 v201, v74, v78
  v_cvt_pk_bf16_f32 v205, v75, v79
  v_mfma_f32_16x16x32_bf16 v[80:83], v[44:47], a[76:79], v[80:83]
  v_mfma_f32_16x16x32_bf16 v[84:87], v[32:35], a[80:83], 0
  v_mfma_f32_16x16x32_bf16 v[84:87], v[36:39], a[84:87], v[84:87]
  v_mfma_f32_16x16x32_bf16 v[84:87], v[40:43], a[88:91], v[84:87]
  v_mfma_f32_16x16x32_bf16 v[84:87], v[44:47], a[92:95], v[84:87]
  v_mfma_f32_16x16x32_bf16 v[88:91], v[32:35], a[96:99], 0
  v_mfma_f32_16x16x32_bf16 v[88:91], v[36:39], a[100:103], v[88:91]
  v_cvt_pk_bf16_f32 v194, v80, v84
  v_cvt_pk_bf16_f32 v198, v81, v85
  v_mfma_f32_16x16x32_bf16 v[88:91], v[40:43], a[104:107], v[88:91]
  v_cvt_pk_bf16_f32 v202, v82, v86
  v_cvt_pk_bf16_f32 v206, v83, v87
  v_mfma_f32_16x16x32_bf16 v[88:91], v[44:47], a[108:111], v[88:91]
  v_mfma_f32_16x16x32_bf16 v[92:95], v[32:35], a[112:115], 0
  v_mfma_f32_16x16x32_bf16 v[92:95], v[36:39], a[116:119], v[92:95]
  v_mfma_f32_16x16x32_bf16 v[92:95], v[40:43], a[120:123], v[92:95]
  v_mfma_f32_16x16x32_bf16 v[92:95], v[44:47], a[124:127], v[92:95]
  s_waitcnt lgkmcnt(3)
  v_mfma_f32_16x16x32_bf16 v[96:99], v[48:51], a[0:3], 0
  s_waitcnt lgkmcnt(2)
  v_mfma_f32_16x16x32_bf16 v[96:99], v[52:55], a[4:7], v[96:99]
  v_cvt_pk_bf16_f32 v195, v88, v92
  buffer_store_dwordx4 v[192:195], v6, s[4:7], s56 offen sc1
  s_waitcnt lgkmcnt(1)
  v_mfma_f32_16x16x32_bf16 v[96:99], v[56:59], a[8:11], v[96:99]
  s_add_u32 s56, s13, 589824
  v_cvt_pk_bf16_f32 v199, v89, v93
  buffer_store_dwordx4 v[196:199], v6, s[4:7], s57 offen sc1
  s_waitcnt lgkmcnt(0)
  v_mfma_f32_16x16x32_bf16 v[96:99], v[60:63], a[12:15], v[96:99]
  s_add_u32 s57, s13, 622592
  v_cvt_pk_bf16_f32 v203, v90, v94
  buffer_store_dwordx4 v[200:203], v6, s[4:7], s58 offen sc1
  v_mfma_f32_16x16x32_bf16 v[100:103], v[48:51], a[16:19], 0
  v_cvt_pk_bf16_f32 v207, v91, v95
  v_mfma_f32_16x16x32_bf16 v[100:103], v[52:55], a[20:23], v[100:103]
  v_mfma_f32_16x16x32_bf16 v[100:103], v[56:59], a[24:27], v[100:103]
  v_mfma_f32_16x16x32_bf16 v[100:103], v[60:63], a[28:31], v[100:103]
  v_mfma_f32_16x16x32_bf16 v[104:107], v[48:51], a[32:35], 0
  v_mfma_f32_16x16x32_bf16 v[104:107], v[52:55], a[36:39], v[104:107]
  v_cvt_pk_bf16_f32 v208, v96, v100
  v_cvt_pk_bf16_f32 v212, v97, v101
  buffer_store_dwordx4 v[204:207], v6, s[4:7], s59 offen sc1
  v_mfma_f32_16x16x32_bf16 v[104:107], v[56:59], a[40:43], v[104:107]
  v_cvt_pk_bf16_f32 v216, v98, v102
  v_cvt_pk_bf16_f32 v220, v99, v103
  v_mfma_f32_16x16x32_bf16 v[104:107], v[60:63], a[44:47], v[104:107]
  v_mfma_f32_16x16x32_bf16 v[108:111], v[48:51], a[48:51], 0
  v_mfma_f32_16x16x32_bf16 v[108:111], v[52:55], a[52:55], v[108:111]
  v_mfma_f32_16x16x32_bf16 v[108:111], v[56:59], a[56:59], v[108:111]
  v_mfma_f32_16x16x32_bf16 v[108:111], v[60:63], a[60:63], v[108:111]
  v_mfma_f32_16x16x32_bf16 v[112:115], v[48:51], a[64:67], 0
  v_mfma_f32_16x16x32_bf16 v[112:115], v[52:55], a[68:71], v[112:115]
  v_cvt_pk_bf16_f32 v209, v104, v108
  v_cvt_pk_bf16_f32 v213, v105, v109
  v_mfma_f32_16x16x32_bf16 v[112:115], v[56:59], a[72:75], v[112:115]
  v_cvt_pk_bf16_f32 v217, v106, v110
  v_cvt_pk_bf16_f32 v221, v107, v111
  v_mfma_f32_16x16x32_bf16 v[112:115], v[60:63], a[76:79], v[112:115]
  v_mfma_f32_16x16x32_bf16 v[116:119], v[48:51], a[80:83], 0
  v_mfma_f32_16x16x32_bf16 v[116:119], v[52:55], a[84:87], v[116:119]
  v_mfma_f32_16x16x32_bf16 v[116:119], v[56:59], a[88:91], v[116:119]
  v_mfma_f32_16x16x32_bf16 v[116:119], v[60:63], a[92:95], v[116:119]
  v_mfma_f32_16x16x32_bf16 v[120:123], v[48:51], a[96:99], 0
  v_mfma_f32_16x16x32_bf16 v[120:123], v[52:55], a[100:103], v[120:123]
  v_cvt_pk_bf16_f32 v210, v112, v116
  v_cvt_pk_bf16_f32 v214, v113, v117
  v_mfma_f32_16x16x32_bf16 v[120:123], v[56:59], a[104:107], v[120:123]
  v_cvt_pk_bf16_f32 v218, v114, v118
  v_cvt_pk_bf16_f32 v222, v115, v119
  v_mfma_f32_16x16x32_bf16 v[120:123], v[60:63], a[108:111], v[120:123]
  v_mfma_f32_16x16x32_bf16 v[124:127], v[48:51], a[112:115], 0
  v_mfma_f32_16x16x32_bf16 v[124:127], v[52:55], a[116:119], v[124:127]
  v_mfma_f32_16x16x32_bf16 v[124:127], v[56:59], a[120:123], v[124:127]
  v_mfma_f32_16x16x32_bf16 v[124:127], v[60:63], a[124:127], v[124:127]
  s_nop 7
  v_cvt_pk_bf16_f32 v211, v120, v124
  buffer_store_dwordx4 v[208:211], v6, s[4:7], s60 offen sc1
  v_cvt_pk_bf16_f32 v215, v121, v125
  buffer_store_dwordx4 v[212:215], v6, s[4:7], s61 offen sc1
  v_cvt_pk_bf16_f32 v219, v122, v126
  v_cvt_pk_bf16_f32 v223, v123, v127
  buffer_store_dwordx4 v[216:219], v6, s[4:7], s56 offen sc1
  buffer_store_dwordx4 v[220:223], v6, s[4:7], s57 offen sc1
  s_waitcnt vmcnt(0)
  s_barrier
  s_lshl_b32 s21, s10, 7
  s_add_u32 s21, s21, 20480
  s_lshl_b32 s22, s8, 2
  s_add_u32 s22, s22, s21
  s_cmp_lg_u32 s9, 0
  s_cbranch_scc1 L_sg28
  v_cmp_eq_u32 vcc, 0, v1
  v_mov_b32 v120, 0x7ffffff0
  s_nop 0
  v_cndmask_b32 v121, v120, 0, vcc
  v_mov_b32 v120, 1
    buffer_store_dword v120, v121, s[4:7], s22 offen sc1
L_sg28:
  s_cmp_lg_u32 s9, 0
  s_cbranch_scc1 L_wap29d
  v_and_b32 v121, 63, v1
  v_cmp_gt_u32 vcc, 32, v121
  v_lshlrev_b32 v121, 2, v121
  s_nop 0
  v_cndmask_b32 v121, 0, v121, vcc
  s_mov_b32 s43, 0
L_wap29:
    buffer_load_dword v120, v121, s[4:7], s21 offen sc1
    s_waitcnt vmcnt(0)
  v_cmp_eq_u32 vcc, 0, v120
  s_cbranch_vccz L_wap29d
  s_sleep 1
  s_add_u32 s43, s43, 1
  s_cmp_lt_u32 s43, 400000
  s_cbranch_scc1 L_wap29
  s_branch L_bail
L_wap29d:
  s_barrier
  s_lshl_b32 s56, s8, 15
  s_add_u32 s56, s56, s13
  s_lshl_b32 s57, s10, 15
  s_lshl_b32 s58, s8, 10
  s_add_u32 s24, s57, s58
  buffer_load_dwordx2 v[68:69], v8, s[44:47], s24 offen
  s_add_u32 s59, s56, 0
  buffer_load_dwordx4 v[32:35], v7, s[4:7], s59 offen sc1
  s_add_u32 s59, s56, 4096
  buffer_load_dwordx4 v[36:39], v7, s[4:7], s59 offen sc1
  s_add_u32 s59, s56, 8192
  buffer_load_dwordx4 v[40:43], v7, s[4:7], s59 offen sc1
  s_add_u32 s59, s56, 12288
  buffer_load_dwordx4 v[44:47], v7, s[4:7], s59 offen sc1
  s_add_u32 s59, s56, 16384
  buffer_load_dwordx4 v[48:51], v7, s[4:7], s59 offen sc1
  s_add_u32 s59, s56, 20480
  buffer_load_dwordx4 v[52:55], v7, s[4:7], s59 offen sc1
  s_add_u32 s59, s56, 24576
  buffer_load_dwordx4 v[56:59], v7, s[4:7], s59 offen sc1
  s_add_u32 s59, s56, 28672
  buffer_load_dwordx4 v[60:63], v7, s[4:7], s59 offen sc1
  s_waitcnt vmcnt(7)
  v_mfma_f32_16x16x32_bf16 v[64:67], v[10:13], v[32:35], 0
  s_waitcnt vmcnt(6)
  v_mfma_f32_16x16x32_bf16 v[64:67], v[10:13], v[36:39], v[64:67]
  s_waitcnt vmcnt(5)
  v_mfma_f32_16x16x32_bf16 v[64:67], v[10:13], v[40:43], v[64:67]
  s_waitcnt vmcnt(4)
  v_mfma_f32_16x16x32_bf16 v[64:67], v[10:13], v[44:47], v[64:67]
  s_waitcnt vmcnt(3)
  v_mfma_f32_16x16x32_bf16 v[64:67], v[10:13], v[48:51], v[64:67]
  s_waitcnt vmcnt(2)
  v_mfma_f32_16x16x32_bf16 v[64:67], v[10:13], v[52:55], v[64:67]
  s_waitcnt vmcnt(1)
  v_mfma_f32_16x16x32_bf16 v[64:67], v[10:13], v[56:59], v[64:67]
  s_waitcnt vmcnt(0)
  v_mfma_f32_16x16x32_bf16 v[64:67], v[10:13], v[60:63], v[64:67]
  v_lshlrev_b32 v72, 16, v68
  v_and_b32 v73, 0xffff0000, v68
  v_lshlrev_b32 v74, 16, v69
  v_and_b32 v75, 0xffff0000, v69
  s_nop 3
  v_fma_f32 v72, v64, v18, v72
  v_fma_f32 v73, v65, v19, v73
  v_fma_f32 v74, v66, v20, v74
  v_fma_f32 v75, v67, v21, v75
  v_cvt_pk_bf16_f32 v68, v72, v73
  v_cvt_pk_bf16_f32 v69, v74, v75
  s_add_u32 s25, s24, 4194304
  buffer_store_dwordx2 v[68:69], v8, s[4:7], s25 offen sc1
  v_lshlrev_b32 v72, 16, v68
  v_and_b32 v73, 0xffff0000, v68
  v_lshlrev_b32 v74, 16, v69
  v_and_b32 v75, 0xffff0000, v69
  v_add_f32 v77, v72, v73
  v_add_f32 v76, v74, v75
  v_add_f32 v77, v77, v76
  v_mul_f32 v78, v72, v72
  v_fmac_f32 v78, v73, v73
  v_fmac_f32 v78, v74, v74
  v_fmac_f32 v78, v75, v75
  v_add_f32_dpp v77, v77, v77 row_ror:1 row_mask:0xf bank_mask:0xf
  s_nop 1
  v_add_f32_dpp v77, v77, v77 row_ror:2 row_mask:0xf bank_mask:0xf
  s_nop 1
  v_add_f32_dpp v77, v77, v77 row_ror:4 row_mask:0xf bank_mask:0xf
  s_nop 1
  v_add_f32_dpp v77, v77, v77 row_ror:8 row_mask:0xf bank_mask:0xf
  v_mov_b32 v76, v77
  s_nop 1
  v_permlane16_swap_b32 v77, v76
  v_add_f32 v77, v77, v76
  v_mov_b32 v76, v77
  s_nop 1
  v_permlane32_swap_b32 v77, v76
  v_add_f32 v77, v77, v76
  v_add_f32_dpp v78, v78, v78 row_ror:1 row_mask:0xf bank_mask:0xf
  s_nop 1
  v_add_f32_dpp v78, v78, v78 row_ror:2 row_mask:0xf bank_mask:0xf
  s_nop 1
  v_add_f32_dpp v78, v78, v78 row_ror:4 row_mask:0xf bank_mask:0xf
  s_nop 1
  v_add_f32_dpp v78, v78, v78 row_ror:8 row_mask:0xf bank_mask:0xf
  v_mov_b32 v76, v78
  s_nop 1
  v_permlane16_swap_b32 v78, v76
  v_add_f32 v78, v78, v76
  v_mov_b32 v76, v78
  s_nop 1
  v_permlane32_swap_b32 v78, v76
  v_add_f32 v78, v78, v76
  s_lshl_b32 s56, s9, 3
  s_add_u32 s56, s56, 8192
  v_mov_b32 v76, s56
  v_mov_b32 v82, v77
  v_mov_b32 v83, v78
  ds_write_b64 v76, v[82:83]
  s_waitcnt lgkmcnt(0)
  s_barrier
  v_mov_b32 v76, 8192
  ds_read_b128 v[84:87], v76
  ds_read_b128 v[88:91], v76 offset:16
  s_waitcnt lgkmcnt(1)
  v_add_f32 v77, v84, v86
  s_waitcnt lgkmcnt(0)
  v_add_f32 v76, v88, v90
  v_add_f32 v77, v77, v76
  v_add_f32 v78, v85, v87
  v_add_f32 v76, v89, v91
  v_add_f32 v78, v78, v76
  v_mul_f32 v77, 0x3a800000, v77
  v_mul_f32 v78, 0x3a800000, v78
  v_fma_f32 v78, -v77, v77, v78
  v_max_f32 v78, 0, v78
  v_add_f32 v78, 0x3727c5ac, v78
  v_rsq_f32 v78, v78
  v_sub_f32 v72, v72, v77
  v_mul_f32 v72, v72, v78
  v_fma_f32 v72, v72, v22, v26
  v_sub_f32 v73, v73, v77
  v_mul_f32 v73, v73, v78
  v_fma_f32 v73, v73, v23, v27
  v_sub_f32 v74, v74, v77
  v_mul_f32 v74, v74, v78
  v_fma_f32 v74, v74, v24, v28
  v_sub_f32 v75, v75, v77
  v_mul_f32 v75, v75, v78
  v_fma_f32 v75, v75, v25, v29
  v_cvt_pk_bf16_f32 v80, v72, v73
  v_cvt_pk_bf16_f32 v81, v74, v75
  s_add_u32 s25, s24, 6291456
  buffer_store_dwordx2 v[80:81], v8, s[4:7], s25 offen sc1
  s_waitcnt vmcnt(0)
  s_barrier
  s_lshl_b32 s21, s10, 7
  s_add_u32 s21, s21, 28672
  s_lshl_b32 s22, s8, 2
  s_add_u32 s22, s22, s21
  s_cmp_lg_u32 s9, 0
  s_cbranch_scc1 L_sg30
  v_cmp_eq_u32 vcc, 0, v1
  v_mov_b32 v120, 0x7ffffff0
  s_nop 0
  v_cndmask_b32 v121, v120, 0, vcc
  v_mov_b32 v120, 1
    buffer_store_dword v120, v121, s[4:7], s22 offen sc1
L_sg30:
  s_xor_b32 s12, s12, 1
  s_mov_b32 s10, s29
  s_cmp_lt_u32 s10, 64
  s_cbranch_scc1 L_as_loop
  s_waitcnt vmcnt(0)
  s_endpgm
L_role_f:
  s_sub_u32 s16, s11, 4
  s_load_dwordx2 s[48:49], s[0:1], 0
  s_waitcnt lgkmcnt(0)
  s_mov_b32 s50, 2097152
  s_mov_b32 s51, 0x20000
  s_lshl_b32 s17, s16, 5
  s_add_u32 s17, s17, s14
  s_lshl_b32 s20, s17, 15
  s_add_u32 s21, s20, 1048576
  v_and_b32 v3, 15, v1
  v_lshrrev_b32 v4, 4, v1
  v_lshlrev_b32 v5, 10, v3
  v_lshlrev_b32 v7, 4, v4
  v_add_u32 v5, v5, v7
  s_and_b32 s56, s9, 1
  s_lshl_b32 s56, s56, 14
  s_lshr_b32 s57, s9, 1
  s_lshl_b32 s58, s57, 9
  s_add_u32 s59, s20, s56
  s_add_u32 s59, s59, s58
  buffer_load_dwordx4 v[16:19], v5, s[48:51], s59 offen offset:0
  buffer_load_dwordx4 v[20:23], v5, s[48:51], s59 offen offset:64
  buffer_load_dwordx4 v[24:27], v5, s[48:51], s59 offen offset:128
  buffer_load_dwordx4 v[28:31], v5, s[48:51], s59 offen offset:192
  buffer_load_dwordx4 v[32:35], v5, s[48:51], s59 offen offset:256
  buffer_load_dwordx4 v[36:39], v5, s[48:51], s59 offen offset:320
  buffer_load_dwordx4 v[40:43], v5, s[48:51], s59 offen offset:384
  buffer_load_dwordx4 v[44:47], v5, s[48:51], s59 offen offset:448
  v_lshlrev_b32 v6, 4, v1
  v_lshlrev_b32 v12, 5, v4
  s_lshl_b32 s60, s57, 10
  v_add_u32 v12, s60, v12
  v_mov_b32 v13, 0x3f803f80
  v_mov_b32 v10, 0
  v_mov_b32 v11, 0
  v_mov_b32 v65, 0
  v_mov_b32 v67, 0
  s_waitcnt vmcnt(7)
  v_lshlrev_b32 v14, 16, v16
  v_and_b32 v15, 0xffff0000, v16
  v_add_f32 v10, v10, v14
  v_add_f32 v65, v65, v15
  v_fmac_f32 v11, v14, v14
  v_fmac_f32 v67, v15, v15
  v_lshlrev_b32 v14, 16, v17
  v_and_b32 v15, 0xffff0000, v17
  v_add_f32 v10, v10, v14
  v_add_f32 v65, v65, v15
  v_fmac_f32 v11, v14, v14
  v_fmac_f32 v67, v15, v15
  v_lshlrev_b32 v14, 16, v18
  v_and_b32 v15, 0xffff0000, v18
  v_add_f32 v10, v10, v14
  v_add_f32 v65, v65, v15
  v_fmac_f32 v11, v14, v14
  v_fmac_f32 v67, v15, v15
  v_lshlrev_b32 v14, 16, v19
  v_and_b32 v15, 0xffff0000, v19
  v_add_f32 v10, v10, v14
  v_add_f32 v65, v65, v15
  v_fmac_f32 v11, v14, v14
  v_fmac_f32 v67, v15, v15
  s_waitcnt vmcnt(6)
  v_lshlrev_b32 v14, 16, v20
  v_and_b32 v15, 0xffff0000, v20
  v_add_f32 v10, v10, v14
  v_add_f32 v65, v65, v15
  v_fmac_f32 v11, v14, v14
  v_fmac_f32 v67, v15, v15
  v_lshlrev_b32 v14, 16, v21
  v_and_b32 v15, 0xffff0000, v21
  v_add_f32 v10, v10, v14
  v_add_f32 v65, v65, v15
  v_fmac_f32 v11, v14, v14
  v_fmac_f32 v67, v15, v15
  v_lshlrev_b32 v14, 16, v22
  v_and_b32 v15, 0xffff0000, v22
  v_add_f32 v10, v10, v14
  v_add_f32 v65, v65, v15
  v_fmac_f32 v11, v14, v14
  v_fmac_f32 v67, v15, v15
  v_lshlrev_b32 v14, 16, v23
  v_and_b32 v15, 0xffff0000, v23
  v_add_f32 v10, v10, v14
  v_add_f32 v65, v65, v15
  v_fmac_f32 v11, v14, v14
  v_fmac_f32 v67, v15, v15
  s_waitcnt vmcnt(5)
  v_lshlrev_b32 v14, 16, v24
  v_and_b32 v15, 0xffff0000, v24
  v_add_f32 v10, v10, v14
  v_add_f32 v65, v65, v15
  v_fmac_f32 v11, v14, v14
  v_fmac_f32 v67, v15, v15
  v_lshlrev_b32 v14, 16, v25
  v_and_b32 v15, 0xffff0000, v25
  v_add_f32 v10, v10, v14
  v_add_f32 v65, v65, v15
  v_fmac_f32 v11, v14, v14
  v_fmac_f32 v67, v15, v15
  v_lshlrev_b32 v14, 16, v26
  v_and_b32 v15, 0xffff0000, v26
  v_add_f32 v10, v10, v14
  v_add_f32 v65, v65, v15
  v_fmac_f32 v11, v14, v14
  v_fmac_f32 v67, v15, v15
  v_lshlrev_b32 v14, 16, v27
  v_and_b32 v15, 0xffff0000, v27
  v_add_f32 v10, v10, v14
  v_add_f32 v65, v65, v15
  v_fmac_f32 v11, v14, v14
  v_fmac_f32 v67, v15, v15
  s_waitcnt vmcnt(4)
  v_lshlrev_b32 v14, 16, v28
  v_and_b32 v15, 0xffff0000, v28
  v_add_f32 v10, v10, v14
  v_add_f32 v65, v65, v15
  v_fmac_f32 v11, v14, v14
  v_fmac_f32 v67, v15, v15
  v_lshlrev_b32 v14, 16, v29
  v_and_b32 v15, 0xffff0000, v29
  v_add_f32 v10, v10, v14
  v_add_f32 v65, v65, v15
  v_fmac_f32 v11, v14, v14
  v_fmac_f32 v67, v15, v15
  v_lshlrev_b32 v14, 16, v30
  v_and_b32 v15, 0xffff0000, v30
  v_add_f32 v10, v10, v14
  v_add_f32 v65, v65, v15
  v_fmac_f32 v11, v14, v14
  v_fmac_f32 v67, v15, v15
  v_lshlrev_b32 v14, 16, v31
  v_and_b32 v15, 0xffff0000, v31
  v_add_f32 v10, v10, v14
  v_add_f32 v65, v65, v15
  v_fmac_f32 v11, v14, v14
  v_fmac_f32 v67, v15, v15
  s_waitcnt vmcnt(3)
  v_lshlrev_b32 v14, 16, v32
  v_and_b32 v15, 0xffff0000, v32
  v_add_f32 v10, v10, v14
  v_add_f32 v65, v65, v15
  v_fmac_f32 v11, v14, v14
  v_fmac_f32 v67, v15, v15
  v_lshlrev_b32 v14, 16, v33
  v_and_b32 v15, 0xffff0000, v33
  v_add_f32 v10, v10, v14
  v_add_f32 v65, v65, v15
  v_fmac_f32 v11, v14, v14
  v_fmac_f32 v67, v15, v15
  v_lshlrev_b32 v14, 16, v34
  v_and_b32 v15, 0xffff0000, v34
  v_add_f32 v10, v10, v14
  v_add_f32 v65, v65, v15
  v_fmac_f32 v11, v14, v14
  v_fmac_f32 v67, v15, v15
  v_lshlrev_b32 v14, 16, v35
  v_and_b32 v15, 0xffff0000, v35
  v_add_f32 v10, v10, v14
  v_add_f32 v65, v65, v15
  v_fmac_f32 v11, v14, v14
  v_fmac_f32 v67, v15, v15
  s_waitcnt vmcnt(2)
  v_lshlrev_b32 v14, 16, v36
  v_and_b32 v15, 0xffff0000, v36
  v_add_f32 v10, v10, v14
  v_add_f32 v65, v65, v15
  v_fmac_f32 v11, v14, v14
  v_fmac_f32 v67, v15, v15
  v_lshlrev_b32 v14, 16, v37
  v_and_b32 v15, 0xffff0000, v37
  v_add_f32 v10, v10, v14
  v_add_f32 v65, v65, v15
  v_fmac_f32 v11, v14, v14
  v_fmac_f32 v67, v15, v15
  v_lshlrev_b32 v14, 16, v38
  v_and_b32 v15, 0xffff0000, v38
  v_add_f32 v10, v10, v14
  v_add_f32 v65, v65, v15
  v_fmac_f32 v11, v14, v14
  v_fmac_f32 v67, v15, v15
  v_lshlrev_b32 v14, 16, v39
  v_and_b32 v15, 0xffff0000, v39
  v_add_f32 v10, v10, v14
  v_add_f32 v65, v65, v15
  v_fmac_f32 v11, v14, v14
  v_fmac_f32 v67, v15, v15
  s_waitcnt vmcnt(1)
  v_lshlrev_b32 v14, 16, v40
  v_and_b32 v15, 0xffff0000, v40
  v_add_f32 v10, v10, v14
  v_add_f32 v65, v65, v15
  v_fmac_f32 v11, v14, v14
  v_fmac_f32 v67, v15, v15
  v_lshlrev_b32 v14, 16, v41
  v_and_b32 v15, 0xffff0000, v41
  v_add_f32 v10, v10, v14
  v_add_f32 v65, v65, v15
  v_fmac_f32 v11, v14, v14
  v_fmac_f32 v67, v15, v15
  v_lshlrev_b32 v14, 16, v42
  v_and_b32 v15, 0xffff0000, v42
  v_add_f32 v10, v10, v14
  v_add_f32 v65, v65, v15
  v_fmac_f32 v11, v14, v14
  v_fmac_f32 v67, v15, v15
  v_lshlrev_b32 v14, 16, v43
  v_and_b32 v15, 0xffff0000, v43
  v_add_f32 v10, v10, v14
  v_add_f32 v65, v65, v15
  v_fmac_f32 v11, v14, v14
  v_fmac_f32 v67, v15, v15
  s_waitcnt vmcnt(0)
  v_lshlrev_b32 v14, 16, v44
  v_and_b32 v15, 0xffff0000, v44
  v_add_f32 v10, v10, v14
  v_add_f32 v65, v65, v15
  v_fmac_f32 v11, v14, v14
  v_fmac_f32 v67, v15, v15
  v_lshlrev_b32 v14, 16, v45
  v_and_b32 v15, 0xffff0000, v45
  v_add_f32 v10, v10, v14
  v_add_f32 v65, v65, v15
  v_fmac_f32 v11, v14, v14
  v_fmac_f32 v67, v15, v15
  v_lshlrev_b32 v14, 16, v46
  v_and_b32 v15, 0xffff0000, v46
  v_add_f32 v10, v10, v14
  v_add_f32 v65, v65, v15
  v_fmac_f32 v11, v14, v14
  v_fmac_f32 v67, v15, v15
  v_lshlrev_b32 v14, 16, v47
  v_and_b32 v15, 0xffff0000, v47
  v_add_f32 v10, v10, v14
  v_add_f32 v65, v65, v15
  v_fmac_f32 v11, v14, v14
  v_fmac_f32 v67, v15, v15
  v_add_f32 v10, v10, v65
  v_add_f32 v11, v11, v67
  v_mov_b32 v7, v10
  s_nop 1
  v_permlane16_swap_b32 v10, v7
  v_add_f32 v10, v10, v7
  v_mov_b32 v7, v10
  s_nop 1
  v_permlane32_swap_b32 v10, v7
  v_add_f32 v10, v10, v7
  v_mov_b32 v7, v11
  s_nop 1
  v_permlane16_swap_b32 v11, v7
  v_add_f32 v11, v11, v7
  v_mov_b32 v7, v11
  s_nop 1
  v_permlane32_swap_b32 v11, v7
  v_add_f32 v11, v11, v7
  v_mov_b32 v68, v10
  v_mov_b32 v69, v11
  v_lshlrev_b32 v7, 3, v1
  s_lshl_b32 s60, s9, 9
  v_add_u32 v66, s60, v7
  ds_write_b64 v66, v[68:69] offset:4096
  s_waitcnt lgkmcnt(0)
  s_barrier
  s_xor_b32 s60, s9, 2
  s_lshl_b32 s60, s60, 9
  v_add_u32 v66, s60, v7
  ds_read_b64 v[68:69], v66 offset:4096
  s_waitcnt lgkmcnt(0)
  v_add_f32 v10, v10, v68
  v_add_f32 v11, v11, v69
  v_mul_f32 v8, 0x3b000000, v10
  v_mul_f32 v9, 0x3b000000, v11
  v_fma_f32 v9, -v8, v8, v9
  v_max_f32 v9, 0, v9
  v_add_f32 v9, 0x3727c5ac, v9
  v_rsq_f32 v9, v9
  s_cmp_lg_u32 s9, 0
  s_cbranch_scc1 L_cf31d
  v_mov_b32 v125, 20
  s_mov_b32 s43, 0
L_cf31:
    buffer_load_dword v124, v125, s[52:55], 0 offen sc1
    s_waitcnt vmcnt(0)
  v_readfirstlane_b32 s63, v124
  s_nop 0
  s_cmp_ge_u32 s63, 16
  s_nop 1
  s_cbranch_scc1 L_cf31d
  s_sleep 6
  s_add_u32 s43, s43, 1
  s_cmp_lt_u32 s43, 400000
  s_cbranch_scc1 L_cf31
  s_branch L_bail
L_cf31d:
  s_barrier
  s_cmp_lg_u32 s9, 0
  s_cbranch_scc1 L_nfma32d
  v_mov_b32 v125, 45056
  s_mov_b32 s43, 0
L_nfma32:
    buffer_load_dword v124, v125, s[4:7], 0 offen sc1
    s_waitcnt vmcnt(0)
  v_readfirstlane_b32 s63, v124
  s_nop 0
  s_cmp_ge_u32 s63, 32
  s_nop 1
  s_cbranch_scc1 L_nfma32d
  s_sleep 2
  s_add_u32 s43, s43, 1
  s_cmp_lt_u32 s43, 400000
  s_cbranch_scc1 L_nfma32
  s_branch L_bail
L_nfma32d:
  s_barrier
  v_lshlrev_b32 v70, 3, v0
  s_mov_b32 s61, 67584
  buffer_load_dwordx2 v[72:73], v70, s[4:7], s61 offen sc1
  s_waitcnt vmcnt(0)
  v_add_f32 v72, 1.0, v72
  v_add_f32 v73, 1.0, v73
  v_cvt_pk_bf16_f32 v73, v72, v73
  v_lshlrev_b32 v72, 16, v73
  v_and_b32 v73, 0xffff0000, v73
  ds_write_b64 v70, v[72:73] offset:0
  v_lshlrev_b32 v70, 3, v0
  s_mov_b32 s61, 65536
  buffer_load_dwordx2 v[74:75], v70, s[4:7], s61 offen sc1
  s_waitcnt vmcnt(0)
  ds_write_b64 v70, v[74:75] offset:2048
  s_waitcnt lgkmcnt(0)
  s_barrier
  ds_read_b128 v[48:51], v12 offset:0
  ds_read_b128 v[52:55], v12 offset:16
  ds_read_b128 v[56:59], v12 offset:2048
  ds_read_b128 v[60:63], v12 offset:2064
  v_lshlrev_b32 v14, 16, v16
  v_and_b32 v15, 0xffff0000, v16
  v_sub_f32 v14, v14, v8
  v_sub_f32 v15, v15, v8
  s_waitcnt lgkmcnt(3)
  v_mul_f32 v64, v9, v48
  v_mul_f32 v66, v9, v49
  s_waitcnt lgkmcnt(1)
  v_fma_f32 v14, v14, v64, v56
  v_fma_f32 v15, v15, v66, v57
  v_cvt_pk_bf16_f32 v16, v14, v15
  v_lshlrev_b32 v14, 16, v17
  v_and_b32 v15, 0xffff0000, v17
  v_sub_f32 v14, v14, v8
  v_sub_f32 v15, v15, v8
  v_mul_f32 v64, v9, v50
  v_mul_f32 v66, v9, v51
  v_fma_f32 v14, v14, v64, v58
  v_fma_f32 v15, v15, v66, v59
  v_cvt_pk_bf16_f32 v17, v14, v15
  v_lshlrev_b32 v14, 16, v18
  v_and_b32 v15, 0xffff0000, v18
  v_sub_f32 v14, v14, v8
  v_sub_f32 v15, v15, v8
  v_mul_f32 v64, v9, v52
  v_mul_f32 v66, v9, v53
  s_waitcnt lgkmcnt(0)
  v_fma_f32 v14, v14, v64, v60
  v_fma_f32 v15, v15, v66, v61
  v_cvt_pk_bf16_f32 v18, v14, v15
  v_lshlrev_b32 v14, 16, v19
  v_and_b32 v15, 0xffff0000, v19
  v_sub_f32 v14, v14, v8
  v_sub_f32 v15, v15, v8
  v_mul_f32 v64, v9, v54
  v_mul_f32 v66, v9, v55
  v_fma_f32 v14, v14, v64, v62
  v_fma_f32 v15, v15, v66, v63
  v_cvt_pk_bf16_f32 v19, v14, v15
  s_lshl_b32 s61, s57, 13
  s_add_u32 s61, s61, s56
  s_add_u32 s61, s61, s21
  s_add_u32 s61, s61, 0
  buffer_store_dwordx4 v[16:19], v6, s[4:7], s61 offen sc1
  ds_read_b128 v[48:51], v12 offset:128
  ds_read_b128 v[52:55], v12 offset:144
  ds_read_b128 v[56:59], v12 offset:2176
  ds_read_b128 v[60:63], v12 offset:2192
  v_lshlrev_b32 v14, 16, v20
  v_and_b32 v15, 0xffff0000, v20
  v_sub_f32 v14, v14, v8
  v_sub_f32 v15, v15, v8
  s_waitcnt lgkmcnt(3)
  v_mul_f32 v64, v9, v48
  v_mul_f32 v66, v9, v49
  s_waitcnt lgkmcnt(1)
  v_fma_f32 v14, v14, v64, v56
  v_fma_f32 v15, v15, v66, v57
  v_cvt_pk_bf16_f32 v20, v14, v15
  v_lshlrev_b32 v14, 16, v21
  v_and_b32 v15, 0xffff0000, v21
  v_sub_f32 v14, v14, v8
  v_sub_f32 v15, v15, v8
  v_mul_f32 v64, v9, v50
  v_mul_f32 v66, v9, v51
  v_fma_f32 v14, v14, v64, v58
  v_fma_f32 v15, v15, v66, v59
  v_cvt_pk_bf16_f32 v21, v14, v15
  v_lshlrev_b32 v14, 16, v22
  v_and_b32 v15, 0xffff0000, v22
  v_sub_f32 v14, v14, v8
  v_sub_f32 v15, v15, v8
  v_mul_f32 v64, v9, v52
  v_mul_f32 v66, v9, v53
  s_waitcnt lgkmcnt(0)
  v_fma_f32 v14, v14, v64, v60
  v_fma_f32 v15, v15, v66, v61
  v_cvt_pk_bf16_f32 v22, v14, v15
  v_lshlrev_b32 v14, 16, v23
  v_and_b32 v15, 0xffff0000, v23
  v_sub_f32 v14, v14, v8
  v_sub_f32 v15, v15, v8
  v_mul_f32 v64, v9, v54
  v_mul_f32 v66, v9, v55
  v_fma_f32 v14, v14, v64, v62
  v_fma_f32 v15, v15, v66, v63
  v_cvt_pk_bf16_f32 v23, v14, v15
  s_lshl_b32 s61, s57, 13
  s_add_u32 s61, s61, s56
  s_add_u32 s61, s61, s21
  s_add_u32 s61, s61, 1024
  buffer_store_dwordx4 v[20:23], v6, s[4:7], s61 offen sc1
  ds_read_b128 v[48:51], v12 offset:256
  ds_read_b128 v[52:55], v12 offset:272
  ds_read_b128 v[56:59], v12 offset:2304
  ds_read_b128 v[60:63], v12 offset:2320
  v_lshlrev_b32 v14, 16, v24
  v_and_b32 v15, 0xffff0000, v24
  v_sub_f32 v14, v14, v8
  v_sub_f32 v15, v15, v8
  s_waitcnt lgkmcnt(3)
  v_mul_f32 v64, v9, v48
  v_mul_f32 v66, v9, v49
  s_waitcnt lgkmcnt(1)
  v_fma_f32 v14, v14, v64, v56
  v_fma_f32 v15, v15, v66, v57
  v_cvt_pk_bf16_f32 v24, v14, v15
  v_lshlrev_b32 v14, 16, v25
  v_and_b32 v15, 0xffff0000, v25
  v_sub_f32 v14, v14, v8
  v_sub_f32 v15, v15, v8
  v_mul_f32 v64, v9, v50
  v_mul_f32 v66, v9, v51
  v_fma_f32 v14, v14, v64, v58
  v_fma_f32 v15, v15, v66, v59
  v_cvt_pk_bf16_f32 v25, v14, v15
  v_lshlrev_b32 v14, 16, v26
  v_and_b32 v15, 0xffff0000, v26
  v_sub_f32 v14, v14, v8
  v_sub_f32 v15, v15, v8
  v_mul_f32 v64, v9, v52
  v_mul_f32 v66, v9, v53
  s_waitcnt lgkmcnt(0)
  v_fma_f32 v14, v14, v64, v60
  v_fma_f32 v15, v15, v66, v61
  v_cvt_pk_bf16_f32 v26, v14, v15
  v_lshlrev_b32 v14, 16, v27
  v_and_b32 v15, 0xffff0000, v27
  v_sub_f32 v14, v14, v8
  v_sub_f32 v15, v15, v8
  v_mul_f32 v64, v9, v54
  v_mul_f32 v66, v9, v55
  v_fma_f32 v14, v14, v64, v62
  v_fma_f32 v15, v15, v66, v63
  v_cvt_pk_bf16_f32 v27, v14, v15
  s_lshl_b32 s61, s57, 13
  s_add_u32 s61, s61, s56
  s_add_u32 s61, s61, s21
  s_add_u32 s61, s61, 2048
  buffer_store_dwordx4 v[24:27], v6, s[4:7], s61 offen sc1
  ds_read_b128 v[48:51], v12 offset:384
  ds_read_b128 v[52:55], v12 offset:400
  ds_read_b128 v[56:59], v12 offset:2432
  ds_read_b128 v[60:63], v12 offset:2448
  v_lshlrev_b32 v14, 16, v28
  v_and_b32 v15, 0xffff0000, v28
  v_sub_f32 v14, v14, v8
  v_sub_f32 v15, v15, v8
  s_waitcnt lgkmcnt(3)
  v_mul_f32 v64, v9, v48
  v_mul_f32 v66, v9, v49
  s_waitcnt lgkmcnt(1)
  v_fma_f32 v14, v14, v64, v56
  v_fma_f32 v15, v15, v66, v57
  v_cvt_pk_bf16_f32 v28, v14, v15
  v_lshlrev_b32 v14, 16, v29
  v_and_b32 v15, 0xffff0000, v29
  v_sub_f32 v14, v14, v8
  v_sub_f32 v15, v15, v8
  v_mul_f32 v64, v9, v50
  v_mul_f32 v66, v9, v51
  v_fma_f32 v14, v14, v64, v58
  v_fma_f32 v15, v15, v66, v59
  v_cvt_pk_bf16_f32 v29, v14, v15
  v_lshlrev_b32 v14, 16, v30
  v_and_b32 v15, 0xffff0000, v30
  v_sub_f32 v14, v14, v8
  v_sub_f32 v15, v15, v8
  v_mul_f32 v64, v9, v52
  v_mul_f32 v66, v9, v53
  s_waitcnt lgkmcnt(0)
  v_fma_f32 v14, v14, v64, v60
  v_fma_f32 v15, v15, v66, v61
  v_cvt_pk_bf16_f32 v30, v14, v15
  v_lshlrev_b32 v14, 16, v31
  v_and_b32 v15, 0xffff0000, v31
  v_sub_f32 v14, v14, v8
  v_sub_f32 v15, v15, v8
  v_mul_f32 v64, v9, v54
  v_mul_f32 v66, v9, v55
  v_fma_f32 v14, v14, v64, v62
  v_fma_f32 v15, v15, v66, v63
  v_cvt_pk_bf16_f32 v31, v14, v15
  s_lshl_b32 s61, s57, 13
  s_add_u32 s61, s61, s56
  s_add_u32 s61, s61, s21
  s_add_u32 s61, s61, 3072
  buffer_store_dwordx4 v[28:31], v6, s[4:7], s61 offen sc1
  ds_read_b128 v[48:51], v12 offset:512
  ds_read_b128 v[52:55], v12 offset:528
  ds_read_b128 v[56:59], v12 offset:2560
  ds_read_b128 v[60:63], v12 offset:2576
  v_lshlrev_b32 v14, 16, v32
  v_and_b32 v15, 0xffff0000, v32
  v_sub_f32 v14, v14, v8
  v_sub_f32 v15, v15, v8
  s_waitcnt lgkmcnt(3)
  v_mul_f32 v64, v9, v48
  v_mul_f32 v66, v9, v49
  s_waitcnt lgkmcnt(1)
  v_fma_f32 v14, v14, v64, v56
  v_fma_f32 v15, v15, v66, v57
  v_cvt_pk_bf16_f32 v32, v14, v15
  v_lshlrev_b32 v14, 16, v33
  v_and_b32 v15, 0xffff0000, v33
  v_sub_f32 v14, v14, v8
  v_sub_f32 v15, v15, v8
  v_mul_f32 v64, v9, v50
  v_mul_f32 v66, v9, v51
  v_fma_f32 v14, v14, v64, v58
  v_fma_f32 v15, v15, v66, v59
  v_cvt_pk_bf16_f32 v33, v14, v15
  v_lshlrev_b32 v14, 16, v34
  v_and_b32 v15, 0xffff0000, v34
  v_sub_f32 v14, v14, v8
  v_sub_f32 v15, v15, v8
  v_mul_f32 v64, v9, v52
  v_mul_f32 v66, v9, v53
  s_waitcnt lgkmcnt(0)
  v_fma_f32 v14, v14, v64, v60
  v_fma_f32 v15, v15, v66, v61
  v_cvt_pk_bf16_f32 v34, v14, v15
  v_lshlrev_b32 v14, 16, v35
  v_and_b32 v15, 0xffff0000, v35
  v_sub_f32 v14, v14, v8
  v_sub_f32 v15, v15, v8
  v_mul_f32 v64, v9, v54
  v_mul_f32 v66, v9, v55
  v_fma_f32 v14, v14, v64, v62
  v_fma_f32 v15, v15, v66, v63
  v_cvt_pk_bf16_f32 v35, v14, v15
  s_lshl_b32 s61, s57, 13
  s_add_u32 s61, s61, s56
  s_add_u32 s61, s61, s21
  s_add_u32 s61, s61, 4096
  buffer_store_dwordx4 v[32:35], v6, s[4:7], s61 offen sc1
  ds_read_b128 v[48:51], v12 offset:640
  ds_read_b128 v[52:55], v12 offset:656
  ds_read_b128 v[56:59], v12 offset:2688
  ds_read_b128 v[60:63], v12 offset:2704
  v_lshlrev_b32 v14, 16, v36
  v_and_b32 v15, 0xffff0000, v36
  v_sub_f32 v14, v14, v8
  v_sub_f32 v15, v15, v8
  s_waitcnt lgkmcnt(3)
  v_mul_f32 v64, v9, v48
  v_mul_f32 v66, v9, v49
  s_waitcnt lgkmcnt(1)
  v_fma_f32 v14, v14, v64, v56
  v_fma_f32 v15, v15, v66, v57
  v_cvt_pk_bf16_f32 v36, v14, v15
  v_lshlrev_b32 v14, 16, v37
  v_and_b32 v15, 0xffff0000, v37
  v_sub_f32 v14, v14, v8
  v_sub_f32 v15, v15, v8
  v_mul_f32 v64, v9, v50
  v_mul_f32 v66, v9, v51
  v_fma_f32 v14, v14, v64, v58
  v_fma_f32 v15, v15, v66, v59
  v_cvt_pk_bf16_f32 v37, v14, v15
  v_lshlrev_b32 v14, 16, v38
  v_and_b32 v15, 0xffff0000, v38
  v_sub_f32 v14, v14, v8
  v_sub_f32 v15, v15, v8
  v_mul_f32 v64, v9, v52
  v_mul_f32 v66, v9, v53
  s_waitcnt lgkmcnt(0)
  v_fma_f32 v14, v14, v64, v60
  v_fma_f32 v15, v15, v66, v61
  v_cvt_pk_bf16_f32 v38, v14, v15
  v_lshlrev_b32 v14, 16, v39
  v_and_b32 v15, 0xffff0000, v39
  v_sub_f32 v14, v14, v8
  v_sub_f32 v15, v15, v8
  v_mul_f32 v64, v9, v54
  v_mul_f32 v66, v9, v55
  v_fma_f32 v14, v14, v64, v62
  v_fma_f32 v15, v15, v66, v63
  v_cvt_pk_bf16_f32 v39, v14, v15
  s_lshl_b32 s61, s57, 13
  s_add_u32 s61, s61, s56
  s_add_u32 s61, s61, s21
  s_add_u32 s61, s61, 5120
  buffer_store_dwordx4 v[36:39], v6, s[4:7], s61 offen sc1
  ds_read_b128 v[48:51], v12 offset:768
  ds_read_b128 v[52:55], v12 offset:784
  ds_read_b128 v[56:59], v12 offset:2816
  ds_read_b128 v[60:63], v12 offset:2832
  v_lshlrev_b32 v14, 16, v40
  v_and_b32 v15, 0xffff0000, v40
  v_sub_f32 v14, v14, v8
  v_sub_f32 v15, v15, v8
  s_waitcnt lgkmcnt(3)
  v_mul_f32 v64, v9, v48
  v_mul_f32 v66, v9, v49
  s_waitcnt lgkmcnt(1)
  v_fma_f32 v14, v14, v64, v56
  v_fma_f32 v15, v15, v66, v57
  v_cvt_pk_bf16_f32 v40, v14, v15
  v_lshlrev_b32 v14, 16, v41
  v_and_b32 v15, 0xffff0000, v41
  v_sub_f32 v14, v14, v8
  v_sub_f32 v15, v15, v8
  v_mul_f32 v64, v9, v50
  v_mul_f32 v66, v9, v51
  v_fma_f32 v14, v14, v64, v58
  v_fma_f32 v15, v15, v66, v59
  v_cvt_pk_bf16_f32 v41, v14, v15
  v_lshlrev_b32 v14, 16, v42
  v_and_b32 v15, 0xffff0000, v42
  v_sub_f32 v14, v14, v8
  v_sub_f32 v15, v15, v8
  v_mul_f32 v64, v9, v52
  v_mul_f32 v66, v9, v53
  s_waitcnt lgkmcnt(0)
  v_fma_f32 v14, v14, v64, v60
  v_fma_f32 v15, v15, v66, v61
  v_cvt_pk_bf16_f32 v42, v14, v15
  v_lshlrev_b32 v14, 16, v43
  v_and_b32 v15, 0xffff0000, v43
  v_sub_f32 v14, v14, v8
  v_sub_f32 v15, v15, v8
  v_mul_f32 v64, v9, v54
  v_mul_f32 v66, v9, v55
  v_fma_f32 v14, v14, v64, v62
  v_fma_f32 v15, v15, v66, v63
  v_cvt_pk_bf16_f32 v43, v14, v15
  s_lshl_b32 s61, s57, 13
  s_add_u32 s61, s61, s56
  s_add_u32 s61, s61, s21
  s_add_u32 s61, s61, 6144
  buffer_store_dwordx4 v[40:43], v6, s[4:7], s61 offen sc1
  ds_read_b128 v[48:51], v12 offset:896
  ds_read_b128 v[52:55], v12 offset:912
  ds_read_b128 v[56:59], v12 offset:2944
  ds_read_b128 v[60:63], v12 offset:2960
  v_lshlrev_b32 v14, 16, v44
  v_and_b32 v15, 0xffff0000, v44
  v_sub_f32 v14, v14, v8
  v_sub_f32 v15, v15, v8
  s_waitcnt lgkmcnt(3)
  v_mul_f32 v64, v9, v48
  v_mul_f32 v66, v9, v49
  s_waitcnt lgkmcnt(1)
  v_fma_f32 v14, v14, v64, v56
  v_fma_f32 v15, v15, v66, v57
  v_cvt_pk_bf16_f32 v44, v14, v15
  v_lshlrev_b32 v14, 16, v45
  v_and_b32 v15, 0xffff0000, v45
  v_sub_f32 v14, v14, v8
  v_sub_f32 v15, v15, v8
  v_mul_f32 v64, v9, v50
  v_mul_f32 v66, v9, v51
  v_fma_f32 v14, v14, v64, v58
  v_fma_f32 v15, v15, v66, v59
  v_cvt_pk_bf16_f32 v45, v14, v15
  v_lshlrev_b32 v14, 16, v46
  v_and_b32 v15, 0xffff0000, v46
  v_sub_f32 v14, v14, v8
  v_sub_f32 v15, v15, v8
  v_mul_f32 v64, v9, v52
  v_mul_f32 v66, v9, v53
  s_waitcnt lgkmcnt(0)
  v_fma_f32 v14, v14, v64, v60
  v_fma_f32 v15, v15, v66, v61
  v_cvt_pk_bf16_f32 v46, v14, v15
  v_lshlrev_b32 v14, 16, v47
  v_and_b32 v15, 0xffff0000, v47
  v_sub_f32 v14, v14, v8
  v_sub_f32 v15, v15, v8
  v_mul_f32 v64, v9, v54
  v_mul_f32 v66, v9, v55
  v_fma_f32 v14, v14, v64, v62
  v_fma_f32 v15, v15, v66, v63
  v_cvt_pk_bf16_f32 v47, v14, v15
  s_lshl_b32 s61, s57, 13
  s_add_u32 s61, s61, s56
  s_add_u32 s61, s61, s21
  s_add_u32 s61, s61, 7168
  buffer_store_dwordx4 v[44:47], v6, s[4:7], s61 offen sc1
  s_waitcnt vmcnt(0)
  s_barrier
  s_cmp_ge_u32 s9, 2
  s_cbranch_scc1 L_f_noln
  s_lshl_b32 s22, s17, 7
  s_lshl_b32 s56, s9, 2
  s_add_u32 s22, s22, s56
  s_add_u32 s22, s22, 0
  v_cmp_eq_u32 vcc, 0, v1
  v_mov_b32 v120, 0x7ffffff0
  s_nop 0
  v_cndmask_b32 v121, v120, 0, vcc
  v_mov_b32 v120, 1
    buffer_store_dword v120, v121, s[4:7], s22 offen sc1
L_f_noln:
L_f_late:
  s_mov_b32 s8, s14
  s_cmp_lg_u32 s9, 0
  s_cbranch_scc1 L_nfcr33d
  v_mov_b32 v125, 45312
  s_mov_b32 s43, 0
L_nfcr33:
    buffer_load_dword v124, v125, s[4:7], 0 offen sc1
    s_waitcnt vmcnt(0)
  v_readfirstlane_b32 s63, v124
  s_nop 0
  s_cmp_ge_u32 s63, 24
  s_nop 1
  s_cbranch_scc1 L_nfcr33d
  s_sleep 8
  s_add_u32 s43, s43, 1
  s_cmp_lt_u32 s43, 400000
  s_cbranch_scc1 L_nfcr33
  s_branch L_bail
L_nfcr33d:
  s_barrier
  s_load_dwordx2 s[48:49], s[0:1], 64
  s_waitcnt lgkmcnt(0)
  s_mov_b32 s50, 1409024
  s_mov_b32 s51, 0x20000
  v_and_b32 v16, 15, v1
  v_lshrrev_b32 v17, 4, v1
  s_mov_b32 s56, 22016
  v_mul_lo_u32 v18, v17, s56
  v_lshlrev_b32 v19, 2, v16
  v_add_u32 v18, v18, v19
  s_lshl_b32 s56, s8, 7
  s_lshr_b32 s57, s9, 1
  s_lshl_b32 s57, s57, 6
  s_add_u32 s56, s56, s57
  s_cmp_ge_u32 s56, 2752
  s_cselect_b32 s56, 0x40000000, s56
  v_add_u32 v18, s56, v18
  s_and_b32 s57, s9, 1
  s_cmp_eq_u32 s57, 0
  s_mov_b32 s71, 0x07060302
  s_cselect_b32 s70, 0x05040100, s71
  s_mov_b32 s58, 0
  buffer_load_dword v24, v18, s[48:51], s58 offen
  s_mov_b32 s59, 2752
  buffer_load_dword v25, v18, s[48:51], s59 offen
  s_mov_b32 s60, 5504
  buffer_load_dword v26, v18, s[48:51], s60 offen
  s_mov_b32 s61, 8256
  buffer_load_dword v27, v18, s[48:51], s61 offen
  s_mov_b32 s58, 11008
  buffer_load_dword v28, v18, s[48:51], s58 offen
  s_mov_b32 s59, 13760
  buffer_load_dword v29, v18, s[48:51], s59 offen
  s_mov_b32 s60, 16512
  buffer_load_dword v30, v18, s[48:51], s60 offen
  s_mov_b32 s61, 19264
  buffer_load_dword v31, v18, s[48:51], s61 offen
  s_mov_b32 s58, 88064
  buffer_load_dword v32, v18, s[48:51], s58 offen
  s_mov_b32 s59, 90816
  buffer_load_dword v33, v18, s[48:51], s59 offen
  s_mov_b32 s60, 93568
  buffer_load_dword v34, v18, s[48:51], s60 offen
  s_mov_b32 s61, 96320
  buffer_load_dword v35, v18, s[48:51], s61 offen
  s_mov_b32 s58, 99072
  buffer_load_dword v36, v18, s[48:51], s58 offen
  s_mov_b32 s59, 101824
  buffer_load_dword v37, v18, s[48:51], s59 offen
  s_mov_b32 s60, 104576
  buffer_load_dword v38, v18, s[48:51], s60 offen
  s_mov_b32 s61, 107328
  buffer_load_dword v39, v18, s[48:51], s61 offen
  s_mov_b32 s58, 176128
  buffer_load_dword v40, v18, s[48:51], s58 offen
  s_mov_b32 s59, 178880
  buffer_load_dword v41, v18, s[48:51], s59 offen
  s_mov_b32 s60, 181632
  buffer_load_dword v42, v18, s[48:51], s60 offen
  s_mov_b32 s61, 184384
  buffer_load_dword v43, v18, s[48:51], s61 offen
  s_mov_b32 s58, 187136
  buffer_load_dword v44, v18, s[48:51], s58 offen
  s_mov_b32 s59, 189888
  buffer_load_dword v45, v18, s[48:51], s59 offen
  s_mov_b32 s60, 192640
  buffer_load_dword v46, v18, s[48:51], s60 offen
  s_mov_b32 s61, 195392
  buffer_load_dword v47, v18, s[48:51], s61 offen
  s_mov_b32 s58, 264192
  buffer_load_dword v48, v18, s[48:51], s58 offen
  s_mov_b32 s59, 266944
  buffer_load_dword v49, v18, s[48:51], s59 offen
  s_mov_b32 s60, 269696
  buffer_load_dword v50, v18, s[48:51], s60 offen
  s_mov_b32 s61, 272448
  buffer_load_dword v51, v18, s[48:51], s61 offen
  s_mov_b32 s58, 275200
  buffer_load_dword v52, v18, s[48:51], s58 offen
  s_mov_b32 s59, 277952
  buffer_load_dword v53, v18, s[48:51], s59 offen
  s_mov_b32 s60, 280704
  buffer_load_dword v54, v18, s[48:51], s60 offen
  s_mov_b32 s61, 283456
  buffer_load_dword v55, v18, s[48:51], s61 offen
  s_mov_b32 s58, 352256
  buffer_load_dword v56, v18, s[48:51], s58 offen
  s_mov_b32 s59, 355008
  buffer_load_dword v57, v18, s[48:51], s59 offen
  s_mov_b32 s60, 357760
  buffer_load_dword v58, v18, s[48:51], s60 offen
  s_mov_b32 s61, 360512
  buffer_load_dword v59, v18, s[48:51], s61 offen
  s_mov_b32 s58, 363264
  buffer_load_dword v60, v18, s[48:51], s58 offen
  s_mov_b32 s59, 366016
  buffer_load_dword v61, v18, s[48:51], s59 offen
  s_mov_b32 s60, 368768
  buffer_load_dword v62, v18, s[48:51], s60 offen
  s_mov_b32 s61, 371520
  buffer_load_dword v63, v18, s[48:51], s61 offen
  s_mov_b32 s58, 440320
  buffer_load_dword v64, v18, s[48:51], s58 offen
  s_mov_b32 s59, 443072
  buffer_load_dword v65, v18, s[48:51], s59 offen
  s_mov_b32 s60, 445824
  buffer_load_dword v66, v18, s[48:51], s60 offen
  s_mov_b32 s61, 448576
  buffer_load_dword v67, v18, s[48:51], s61 offen
  s_mov_b32 s58, 451328
  buffer_load_dword v68, v18, s[48:51], s58 offen
  s_mov_b32 s59, 454080
  buffer_load_dword v69, v18, s[48:51], s59 offen
  s_mov_b32 s60, 456832
  buffer_load_dword v70, v18, s[48:51], s60 offen
  s_mov_b32 s61, 459584
  buffer_load_dword v71, v18, s[48:51], s61 offen
  s_mov_b32 s58, 528384
  buffer_load_dword v72, v18, s[48:51], s58 offen
  s_mov_b32 s59, 531136
  buffer_load_dword v73, v18, s[48:51], s59 offen
  s_mov_b32 s60, 533888
  buffer_load_dword v74, v18, s[48:51], s60 offen
  s_mov_b32 s61, 536640
  buffer_load_dword v75, v18, s[48:51], s61 offen
  s_mov_b32 s58, 539392
  buffer_load_dword v76, v18, s[48:51], s58 offen
  s_mov_b32 s59, 542144
  buffer_load_dword v77, v18, s[48:51], s59 offen
  s_mov_b32 s60, 544896
  buffer_load_dword v78, v18, s[48:51], s60 offen
  s_mov_b32 s61, 547648
  buffer_load_dword v79, v18, s[48:51], s61 offen
  s_mov_b32 s58, 616448
  buffer_load_dword v80, v18, s[48:51], s58 offen
  s_mov_b32 s59, 619200
  buffer_load_dword v81, v18, s[48:51], s59 offen
  s_mov_b32 s60, 621952
  buffer_load_dword v82, v18, s[48:51], s60 offen
  s_mov_b32 s61, 624704
  buffer_load_dword v83, v18, s[48:51], s61 offen
  s_mov_b32 s58, 627456
  buffer_load_dword v84, v18, s[48:51], s58 offen
  s_mov_b32 s59, 630208
  buffer_load_dword v85, v18, s[48:51], s59 offen
  s_mov_b32 s60, 632960
  buffer_load_dword v86, v18, s[48:51], s60 offen
  s_mov_b32 s61, 635712
  buffer_load_dword v87, v18, s[48:51], s61 offen
  s_mov_b32 s58, 704512
  buffer_load_dword v88, v18, s[48:51], s58 offen
  s_mov_b32 s59, 707264
  buffer_load_dword v89, v18, s[48:51], s59 offen
  s_mov_b32 s60, 710016
  buffer_load_dword v90, v18, s[48:51], s60 offen
  s_mov_b32 s61, 712768
  buffer_load_dword v91, v18, s[48:51], s61 offen
  s_mov_b32 s58, 715520
  buffer_load_dword v92, v18, s[48:51], s58 offen
  s_mov_b32 s59, 718272
  buffer_load_dword v93, v18, s[48:51], s59 offen
  s_mov_b32 s60, 721024
  buffer_load_dword v94, v18, s[48:51], s60 offen
  s_mov_b32 s61, 723776
  buffer_load_dword v95, v18, s[48:51], s61 offen
  s_mov_b32 s58, 792576
  buffer_load_dword v96, v18, s[48:51], s58 offen
  s_mov_b32 s59, 795328
  buffer_load_dword v97, v18, s[48:51], s59 offen
  s_mov_b32 s60, 798080
  buffer_load_dword v98, v18, s[48:51], s60 offen
  s_mov_b32 s61, 800832
  buffer_load_dword v99, v18, s[48:51], s61 offen
  s_mov_b32 s58, 803584
  buffer_load_dword v100, v18, s[48:51], s58 offen
  s_mov_b32 s59, 806336
  buffer_load_dword v101, v18, s[48:51], s59 offen
  s_mov_b32 s60, 809088
  buffer_load_dword v102, v18, s[48:51], s60 offen
  s_mov_b32 s61, 811840
  buffer_load_dword v103, v18, s[48:51], s61 offen
  s_mov_b32 s58, 880640
  buffer_load_dword v104, v18, s[48:51], s58 offen
  s_mov_b32 s59, 883392
  buffer_load_dword v105, v18, s[48:51], s59 offen
  s_mov_b32 s60, 886144
  buffer_load_dword v106, v18, s[48:51], s60 offen
  s_mov_b32 s61, 888896
  buffer_load_dword v107, v18, s[48:51], s61 offen
  s_mov_b32 s58, 891648
  buffer_load_dword v108, v18, s[48:51], s58 offen
  s_mov_b32 s59, 894400
  buffer_load_dword v109, v18, s[48:51], s59 offen
  s_mov_b32 s60, 897152
  buffer_load_dword v110, v18, s[48:51], s60 offen
  s_mov_b32 s61, 899904
  buffer_load_dword v111, v18, s[48:51], s61 offen
  s_mov_b32 s58, 968704
  buffer_load_dword v112, v18, s[48:51], s58 offen
  s_mov_b32 s59, 971456
  buffer_load_dword v113, v18, s[48:51], s59 offen
  s_mov_b32 s60, 974208
  buffer_load_dword v114, v18, s[48:51], s60 offen
  s_mov_b32 s61, 976960
  buffer_load_dword v115, v18, s[48:51], s61 offen
  s_mov_b32 s58, 979712
  buffer_load_dword v116, v18, s[48:51], s58 offen
  s_mov_b32 s59, 982464
  buffer_load_dword v117, v18, s[48:51], s59 offen
  s_mov_b32 s60, 985216
  buffer_load_dword v118, v18, s[48:51], s60 offen
  s_mov_b32 s61, 987968
  buffer_load_dword v119, v18, s[48:51], s61 offen
  s_waitcnt vmcnt(63)
  v_perm_b32 v120, v25, v24, s70
  v_accvgpr_write_b32 a0, v120
  s_waitcnt vmcnt(63)
  v_perm_b32 v121, v27, v26, s70
  v_accvgpr_write_b32 a1, v121
  s_waitcnt vmcnt(63)
  v_perm_b32 v122, v29, v28, s70
  v_accvgpr_write_b32 a2, v122
  s_waitcnt vmcnt(63)
  v_perm_b32 v123, v31, v30, s70
  v_accvgpr_write_b32 a3, v123
  s_waitcnt vmcnt(63)
  v_perm_b32 v120, v33, v32, s70
  v_accvgpr_write_b32 a4, v120
  s_waitcnt vmcnt(63)
  v_perm_b32 v121, v35, v34, s70
  v_accvgpr_write_b32 a5, v121
  s_waitcnt vmcnt(63)
  v_perm_b32 v122, v37, v36, s70
  v_accvgpr_write_b32 a6, v122
  s_waitcnt vmcnt(63)
  v_perm_b32 v123, v39, v38, s70
  v_accvgpr_write_b32 a7, v123
  s_mov_b32 s58, 1056768
  buffer_load_dword v24, v18, s[48:51], s58 offen
  s_mov_b32 s59, 1059520
  buffer_load_dword v25, v18, s[48:51], s59 offen
  s_mov_b32 s60, 1062272
  buffer_load_dword v26, v18, s[48:51], s60 offen
  s_mov_b32 s61, 1065024
  buffer_load_dword v27, v18, s[48:51], s61 offen
  s_mov_b32 s58, 1067776
  buffer_load_dword v28, v18, s[48:51], s58 offen
  s_mov_b32 s59, 1070528
  buffer_load_dword v29, v18, s[48:51], s59 offen
  s_mov_b32 s60, 1073280
  buffer_load_dword v30, v18, s[48:51], s60 offen
  s_mov_b32 s61, 1076032
  buffer_load_dword v31, v18, s[48:51], s61 offen
  s_mov_b32 s58, 1144832
  buffer_load_dword v32, v18, s[48:51], s58 offen
  s_mov_b32 s59, 1147584
  buffer_load_dword v33, v18, s[48:51], s59 offen
  s_mov_b32 s60, 1150336
  buffer_load_dword v34, v18, s[48:51], s60 offen
  s_mov_b32 s61, 1153088
  buffer_load_dword v35, v18, s[48:51], s61 offen
  s_mov_b32 s58, 1155840
  buffer_load_dword v36, v18, s[48:51], s58 offen
  s_mov_b32 s59, 1158592
  buffer_load_dword v37, v18, s[48:51], s59 offen
  s_mov_b32 s60, 1161344
  buffer_load_dword v38, v18, s[48:51], s60 offen
  s_mov_b32 s61, 1164096
  buffer_load_dword v39, v18, s[48:51], s61 offen
  s_waitcnt vmcnt(63)
  v_perm_b32 v120, v41, v40, s70
  v_accvgpr_write_b32 a8, v120
  s_waitcnt vmcnt(63)
  v_perm_b32 v121, v43, v42, s70
  v_accvgpr_write_b32 a9, v121
  s_waitcnt vmcnt(63)
  v_perm_b32 v122, v45, v44, s70
  v_accvgpr_write_b32 a10, v122
  s_waitcnt vmcnt(63)
  v_perm_b32 v123, v47, v46, s70
  v_accvgpr_write_b32 a11, v123
  s_waitcnt vmcnt(63)
  v_perm_b32 v120, v49, v48, s70
  v_accvgpr_write_b32 a12, v120
  s_waitcnt vmcnt(63)
  v_perm_b32 v121, v51, v50, s70
  v_accvgpr_write_b32 a13, v121
  s_waitcnt vmcnt(63)
  v_perm_b32 v122, v53, v52, s70
  v_accvgpr_write_b32 a14, v122
  s_waitcnt vmcnt(63)
  v_perm_b32 v123, v55, v54, s70
  v_accvgpr_write_b32 a15, v123
  s_mov_b32 s58, 1232896
  buffer_load_dword v40, v18, s[48:51], s58 offen
  s_mov_b32 s59, 1235648
  buffer_load_dword v41, v18, s[48:51], s59 offen
  s_mov_b32 s60, 1238400
  buffer_load_dword v42, v18, s[48:51], s60 offen
  s_mov_b32 s61, 1241152
  buffer_load_dword v43, v18, s[48:51], s61 offen
  s_mov_b32 s58, 1243904
  buffer_load_dword v44, v18, s[48:51], s58 offen
  s_mov_b32 s59, 1246656
  buffer_load_dword v45, v18, s[48:51], s59 offen
  s_mov_b32 s60, 1249408
  buffer_load_dword v46, v18, s[48:51], s60 offen
  s_mov_b32 s61, 1252160
  buffer_load_dword v47, v18, s[48:51], s61 offen
  s_mov_b32 s58, 1320960
  buffer_load_dword v48, v18, s[48:51], s58 offen
  s_mov_b32 s59, 1323712
  buffer_load_dword v49, v18, s[48:51], s59 offen
  s_mov_b32 s60, 1326464
  buffer_load_dword v50, v18, s[48:51], s60 offen
  s_mov_b32 s61, 1329216
  buffer_load_dword v51, v18, s[48:51], s61 offen
  s_mov_b32 s58, 1331968
  buffer_load_dword v52, v18, s[48:51], s58 offen
  s_mov_b32 s59, 1334720
  buffer_load_dword v53, v18, s[48:51], s59 offen
  s_mov_b32 s60, 1337472
  buffer_load_dword v54, v18, s[48:51], s60 offen
  s_mov_b32 s61, 1340224
  buffer_load_dword v55, v18, s[48:51], s61 offen
  s_waitcnt vmcnt(63)
  v_perm_b32 v120, v57, v56, s70
  v_accvgpr_write_b32 a16, v120
  s_waitcnt vmcnt(63)
  v_perm_b32 v121, v59, v58, s70
  v_accvgpr_write_b32 a17, v121
  s_waitcnt vmcnt(63)
  v_perm_b32 v122, v61, v60, s70
  v_accvgpr_write_b32 a18, v122
  s_waitcnt vmcnt(63)
  v_perm_b32 v123, v63, v62, s70
  v_accvgpr_write_b32 a19, v123
  s_waitcnt vmcnt(63)
  v_perm_b32 v120, v65, v64, s70
  v_accvgpr_write_b32 a20, v120
  s_waitcnt vmcnt(63)
  v_perm_b32 v121, v67, v66, s70
  v_accvgpr_write_b32 a21, v121
  s_waitcnt vmcnt(63)
  v_perm_b32 v122, v69, v68, s70
  v_accvgpr_write_b32 a22, v122
  s_waitcnt vmcnt(63)
  v_perm_b32 v123, v71, v70, s70
  v_accvgpr_write_b32 a23, v123
  s_waitcnt vmcnt(63)
  v_perm_b32 v120, v73, v72, s70
  v_accvgpr_write_b32 a24, v120
  s_waitcnt vmcnt(63)
  v_perm_b32 v121, v75, v74, s70
  v_accvgpr_write_b32 a25, v121
  s_waitcnt vmcnt(63)
  v_perm_b32 v122, v77, v76, s70
  v_accvgpr_write_b32 a26, v122
  s_waitcnt vmcnt(63)
  v_perm_b32 v123, v79, v78, s70
  v_accvgpr_write_b32 a27, v123
  s_waitcnt vmcnt(63)
  v_perm_b32 v120, v81, v80, s70
  v_accvgpr_write_b32 a28, v120
  s_waitcnt vmcnt(63)
  v_perm_b32 v121, v83, v82, s70
  v_accvgpr_write_b32 a29, v121
  s_waitcnt vmcnt(63)
  v_perm_b32 v122, v85, v84, s70
  v_accvgpr_write_b32 a30, v122
  s_waitcnt vmcnt(63)
  v_perm_b32 v123, v87, v86, s70
  v_accvgpr_write_b32 a31, v123
  s_waitcnt vmcnt(62)
  v_perm_b32 v120, v89, v88, s70
  v_accvgpr_write_b32 a32, v120
  s_waitcnt vmcnt(60)
  v_perm_b32 v121, v91, v90, s70
  v_accvgpr_write_b32 a33, v121
  s_waitcnt vmcnt(58)
  v_perm_b32 v122, v93, v92, s70
  v_accvgpr_write_b32 a34, v122
  s_waitcnt vmcnt(56)
  v_perm_b32 v123, v95, v94, s70
  v_accvgpr_write_b32 a35, v123
  s_waitcnt vmcnt(54)
  v_perm_b32 v120, v97, v96, s70
  v_accvgpr_write_b32 a36, v120
  s_waitcnt vmcnt(52)
  v_perm_b32 v121, v99, v98, s70
  v_accvgpr_write_b32 a37, v121
  s_waitcnt vmcnt(50)
  v_perm_b32 v122, v101, v100, s70
  v_accvgpr_write_b32 a38, v122
  s_waitcnt vmcnt(48)
  v_perm_b32 v123, v103, v102, s70
  v_accvgpr_write_b32 a39, v123
  s_waitcnt vmcnt(46)
  v_perm_b32 v120, v105, v104, s70
  v_accvgpr_write_b32 a40, v120
  s_waitcnt vmcnt(44)
  v_perm_b32 v121, v107, v106, s70
  v_accvgpr_write_b32 a41, v121
  s_waitcnt vmcnt(42)
  v_perm_b32 v122, v109, v108, s70
  v_accvgpr_write_b32 a42, v122
  s_waitcnt vmcnt(40)
  v_perm_b32 v123, v111, v110, s70
  v_accvgpr_write_b32 a43, v123
  s_waitcnt vmcnt(38)
  v_perm_b32 v120, v113, v112, s70
  v_accvgpr_write_b32 a44, v120
  s_waitcnt vmcnt(36)
  v_perm_b32 v121, v115, v114, s70
  v_accvgpr_write_b32 a45, v121
  s_waitcnt vmcnt(34)
  v_perm_b32 v122, v117, v116, s70
  v_accvgpr_write_b32 a46, v122
  s_waitcnt vmcnt(32)
  v_perm_b32 v123, v119, v118, s70
  v_accvgpr_write_b32 a47, v123
  s_waitcnt vmcnt(30)
  v_perm_b32 v120, v25, v24, s70
  v_accvgpr_write_b32 a48, v120
  s_waitcnt vmcnt(28)
  v_perm_b32 v121, v27, v26, s70
  v_accvgpr_write_b32 a49, v121
  s_waitcnt vmcnt(26)
  v_perm_b32 v122, v29, v28, s70
  v_accvgpr_write_b32 a50, v122
  s_waitcnt vmcnt(24)
  v_perm_b32 v123, v31, v30, s70
  v_accvgpr_write_b32 a51, v123
  s_waitcnt vmcnt(22)
  v_perm_b32 v120, v33, v32, s70
  v_accvgpr_write_b32 a52, v120
  s_waitcnt vmcnt(20)
  v_perm_b32 v121, v35, v34, s70
  v_accvgpr_write_b32 a53, v121
  s_waitcnt vmcnt(18)
  v_perm_b32 v122, v37, v36, s70
  v_accvgpr_write_b32 a54, v122
  s_waitcnt vmcnt(16)
  v_perm_b32 v123, v39, v38, s70
  v_accvgpr_write_b32 a55, v123
  s_waitcnt vmcnt(14)
  v_perm_b32 v120, v41, v40, s70
  v_accvgpr_write_b32 a56, v120
  s_waitcnt vmcnt(12)
  v_perm_b32 v121, v43, v42, s70
  v_accvgpr_write_b32 a57, v121
  s_waitcnt vmcnt(10)
  v_perm_b32 v122, v45, v44, s70
  v_accvgpr_write_b32 a58, v122
  s_waitcnt vmcnt(8)
  v_perm_b32 v123, v47, v46, s70
  v_accvgpr_write_b32 a59, v123
  s_waitcnt vmcnt(6)
  v_perm_b32 v120, v49, v48, s70
  v_accvgpr_write_b32 a60, v120
  s_waitcnt vmcnt(4)
  v_perm_b32 v121, v51, v50, s70
  v_accvgpr_write_b32 a61, v121
  s_waitcnt vmcnt(2)
  v_perm_b32 v122, v53, v52, s70
  v_accvgpr_write_b32 a62, v122
  s_waitcnt vmcnt(0)
  v_perm_b32 v123, v55, v54, s70
  v_accvgpr_write_b32 a63, v123
  s_lshl_b32 s62, s8, 16
  s_lshl_b32 s63, s9, 8
  s_add_u32 s20, s62, s63
  s_load_dwordx2 s[48:49], s[0:1], 72
  s_waitcnt lgkmcnt(0)
  s_mov_b32 s50, 1409024
  s_mov_b32 s51, 0x20000
  v_and_b32 v16, 15, v1
  v_lshrrev_b32 v17, 4, v1
  s_mov_b32 s56, 8192
  v_mul_lo_u32 v18, v17, s56
  v_lshlrev_b32 v19, 4, v16
  v_add_u32 v18, v18, v19
  v_add_u32 v18, s20, v18
  s_mov_b32 s70, 0x05040100
  s_mov_b32 s71, 0x07060302
  s_mov_b32 s58, 0
  buffer_load_dwordx4 v[24:27], v18, s[48:51], s58 offen
  s_mov_b32 s59, 2048
  buffer_load_dwordx4 v[28:31], v18, s[48:51], s59 offen
  s_mov_b32 s60, 4096
  buffer_load_dwordx4 v[32:35], v18, s[48:51], s60 offen
  s_mov_b32 s61, 6144
  buffer_load_dwordx4 v[36:39], v18, s[48:51], s61 offen
  s_mov_b32 s58, 1024
  buffer_load_dwordx4 v[40:43], v18, s[48:51], s58 offen
  s_mov_b32 s59, 3072
  buffer_load_dwordx4 v[44:47], v18, s[48:51], s59 offen
  s_mov_b32 s60, 5120
  buffer_load_dwordx4 v[48:51], v18, s[48:51], s60 offen
  s_mov_b32 s61, 7168
  buffer_load_dwordx4 v[52:55], v18, s[48:51], s61 offen
  s_mov_b32 s58, 32768
  buffer_load_dwordx4 v[56:59], v18, s[48:51], s58 offen
  s_mov_b32 s59, 34816
  buffer_load_dwordx4 v[60:63], v18, s[48:51], s59 offen
  s_mov_b32 s60, 36864
  buffer_load_dwordx4 v[64:67], v18, s[48:51], s60 offen
  s_mov_b32 s61, 38912
  buffer_load_dwordx4 v[68:71], v18, s[48:51], s61 offen
  s_mov_b32 s58, 33792
  buffer_load_dwordx4 v[72:75], v18, s[48:51], s58 offen
  s_mov_b32 s59, 35840
  buffer_load_dwordx4 v[76:79], v18, s[48:51], s59 offen
  s_mov_b32 s60, 37888
  buffer_load_dwordx4 v[80:83], v18, s[48:51], s60 offen
  s_mov_b32 s61, 39936
  buffer_load_dwordx4 v[84:87], v18, s[48:51], s61 offen
  s_waitcnt vmcnt(14)
  v_perm_b32 v120, v28, v24, s70
  v_accvgpr_write_b32 a64, v120
  s_waitcnt vmcnt(12)
  v_perm_b32 v121, v36, v32, s70
  v_accvgpr_write_b32 a65, v121
  s_waitcnt vmcnt(10)
  v_perm_b32 v122, v44, v40, s70
  v_accvgpr_write_b32 a66, v122
  s_waitcnt vmcnt(8)
  v_perm_b32 v123, v52, v48, s70
  v_accvgpr_write_b32 a67, v123
  v_perm_b32 v120, v28, v24, s71
  v_accvgpr_write_b32 a72, v120
  v_perm_b32 v121, v36, v32, s71
  v_accvgpr_write_b32 a73, v121
  v_perm_b32 v122, v44, v40, s71
  v_accvgpr_write_b32 a74, v122
  v_perm_b32 v123, v52, v48, s71
  v_accvgpr_write_b32 a75, v123
  v_perm_b32 v120, v29, v25, s70
  v_accvgpr_write_b32 a80, v120
  v_perm_b32 v121, v37, v33, s70
  v_accvgpr_write_b32 a81, v121
  v_perm_b32 v122, v45, v41, s70
  v_accvgpr_write_b32 a82, v122
  v_perm_b32 v123, v53, v49, s70
  v_accvgpr_write_b32 a83, v123
  v_perm_b32 v120, v29, v25, s71
  v_accvgpr_write_b32 a88, v120
  v_perm_b32 v121, v37, v33, s71
  v_accvgpr_write_b32 a89, v121
  v_perm_b32 v122, v45, v41, s71
  v_accvgpr_write_b32 a90, v122
  v_perm_b32 v123, v53, v49, s71
  v_accvgpr_write_b32 a91, v123
  v_perm_b32 v120, v30, v26, s70
  v_accvgpr_write_b32 a96, v120
  v_perm_b32 v121, v38, v34, s70
  v_accvgpr_write_b32 a97, v121
  v_perm_b32 v122, v46, v42, s70
  v_accvgpr_write_b32 a98, v122
  v_perm_b32 v123, v54, v50, s70
  v_accvgpr_write_b32 a99, v123
  v_perm_b32 v120, v30, v26, s71
  v_accvgpr_write_b32 a104, v120
  v_perm_b32 v121, v38, v34, s71
  v_accvgpr_write_b32 a105, v121
  v_perm_b32 v122, v46, v42, s71
  v_accvgpr_write_b32 a106, v122
  v_perm_b32 v123, v54, v50, s71
  v_accvgpr_write_b32 a107, v123
  v_perm_b32 v120, v31, v27, s70
  v_accvgpr_write_b32 a112, v120
  v_perm_b32 v121, v39, v35, s70
  v_accvgpr_write_b32 a113, v121
  v_perm_b32 v122, v47, v43, s70
  v_accvgpr_write_b32 a114, v122
  v_perm_b32 v123, v55, v51, s70
  v_accvgpr_write_b32 a115, v123
  v_perm_b32 v120, v31, v27, s71
  v_accvgpr_write_b32 a120, v120
  v_perm_b32 v121, v39, v35, s71
  v_accvgpr_write_b32 a121, v121
  v_perm_b32 v122, v47, v43, s71
  v_accvgpr_write_b32 a122, v122
  v_perm_b32 v123, v55, v51, s71
  v_accvgpr_write_b32 a123, v123
  s_waitcnt vmcnt(6)
  v_perm_b32 v120, v60, v56, s70
  v_accvgpr_write_b32 a68, v120
  s_waitcnt vmcnt(4)
  v_perm_b32 v121, v68, v64, s70
  v_accvgpr_write_b32 a69, v121
  s_waitcnt vmcnt(2)
  v_perm_b32 v122, v76, v72, s70
  v_accvgpr_write_b32 a70, v122
  s_waitcnt vmcnt(0)
  v_perm_b32 v123, v84, v80, s70
  v_accvgpr_write_b32 a71, v123
  v_perm_b32 v120, v60, v56, s71
  v_accvgpr_write_b32 a76, v120
  v_perm_b32 v121, v68, v64, s71
  v_accvgpr_write_b32 a77, v121
  v_perm_b32 v122, v76, v72, s71
  v_accvgpr_write_b32 a78, v122
  v_perm_b32 v123, v84, v80, s71
  v_accvgpr_write_b32 a79, v123
  v_perm_b32 v120, v61, v57, s70
  v_accvgpr_write_b32 a84, v120
  v_perm_b32 v121, v69, v65, s70
  v_accvgpr_write_b32 a85, v121
  v_perm_b32 v122, v77, v73, s70
  v_accvgpr_write_b32 a86, v122
  v_perm_b32 v123, v85, v81, s70
  v_accvgpr_write_b32 a87, v123
  v_perm_b32 v120, v61, v57, s71
  v_accvgpr_write_b32 a92, v120
  v_perm_b32 v121, v69, v65, s71
  v_accvgpr_write_b32 a93, v121
  v_perm_b32 v122, v77, v73, s71
  v_accvgpr_write_b32 a94, v122
  v_perm_b32 v123, v85, v81, s71
  v_accvgpr_write_b32 a95, v123
  v_perm_b32 v120, v62, v58, s70
  v_accvgpr_write_b32 a100, v120
  v_perm_b32 v121, v70, v66, s70
  v_accvgpr_write_b32 a101, v121
  v_perm_b32 v122, v78, v74, s70
  v_accvgpr_write_b32 a102, v122
  v_perm_b32 v123, v86, v82, s70
  v_accvgpr_write_b32 a103, v123
  v_perm_b32 v120, v62, v58, s71
  v_accvgpr_write_b32 a108, v120
  v_perm_b32 v121, v70, v66, s71
  v_accvgpr_write_b32 a109, v121
  v_perm_b32 v122, v78, v74, s71
  v_accvgpr_write_b32 a110, v122
  v_perm_b32 v123, v86, v82, s71
  v_accvgpr_write_b32 a111, v123
  v_perm_b32 v120, v63, v59, s70
  v_accvgpr_write_b32 a116, v120
  v_perm_b32 v121, v71, v67, s70
  v_accvgpr_write_b32 a117, v121
  v_perm_b32 v122, v79, v75, s70
  v_accvgpr_write_b32 a118, v122
  v_perm_b32 v123, v87, v83, s70
  v_accvgpr_write_b32 a119, v123
  v_perm_b32 v120, v63, v59, s71
  v_accvgpr_write_b32 a124, v120
  v_perm_b32 v121, v71, v67, s71
  v_accvgpr_write_b32 a125, v121
  v_perm_b32 v122, v79, v75, s71
  v_accvgpr_write_b32 a126, v122
  v_perm_b32 v123, v87, v83, s71
  v_accvgpr_write_b32 a127, v123
  v_and_b32 v100, 15, v1
  v_lshrrev_b32 v101, 4, v1
  v_lshlrev_b32 v2, 4, v1
  v_lshlrev_b32 v3, 10, v100
  v_lshlrev_b32 v102, 4, v101
  v_add_u32 v3, v3, v102
  v_lshlrev_b32 v102, 17, v101
  v_lshlrev_b32 v103, 4, v100
  v_add_u32 v102, v102, v103
  s_lshl_b32 s56, s9, 8
  s_lshl_b32 s57, s8, 10
  s_add_u32 s56, s56, s57
  v_add_u32 v6, s56, v102
  v_lshlrev_b32 v102, 10, v101
  v_add_u32 v102, v102, v103
  s_lshl_b32 s56, s9, 8
  v_add_u32 v7, s56, v102
  v_and_b32 v102, 1, v101
  v_lshlrev_b32 v102, 3, v102
  v_add_u32 v102, v102, v103
  s_lshl_b32 s56, s9, 8
  v_add_u32 v8, s56, v102
  s_lshr_b32 s56, s9, 1
  s_lshl_b32 s56, s56, 10
  s_and_b32 s57, s9, 1
  s_lshl_b32 s57, s57, 3
  s_add_u32 s56, s56, s57
  s_add_u32 s56, s56, 32768
  v_add_u32 v4, s56, v2
  v_and_b32 v102, 7, v100
  v_mov_b32 v103, 0x3f80
  v_cmp_eq_u32 vcc, 0, v102
  s_nop 1
  v_cndmask_b32 v10, 0, v103, vcc
  v_mov_b32 v103, 0x3f800000
  v_cmp_eq_u32 vcc, 1, v102
  s_nop 1
  v_cndmask_b32 v10, v10, v103, vcc
  v_mov_b32 v103, 0x3f80
  v_cmp_eq_u32 vcc, 2, v102
  s_nop 1
  v_cndmask_b32 v11, 0, v103, vcc
  v_mov_b32 v103, 0x3f800000
  v_cmp_eq_u32 vcc, 3, v102
  s_nop 1
  v_cndmask_b32 v11, v11, v103, vcc
  v_mov_b32 v103, 0x3f80
  v_cmp_eq_u32 vcc, 4, v102
  s_nop 1
  v_cndmask_b32 v12, 0, v103, vcc
  v_mov_b32 v103, 0x3f800000
  v_cmp_eq_u32 vcc, 5, v102
  s_nop 1
  v_cndmask_b32 v12, v12, v103, vcc
  v_mov_b32 v103, 0x3f80
  v_cmp_eq_u32 vcc, 6, v102
  s_nop 1
  v_cndmask_b32 v13, 0, v103, vcc
  v_mov_b32 v103, 0x3f800000
  v_cmp_eq_u32 vcc, 7, v102
  s_nop 1
  v_cndmask_b32 v13, v13, v103, vcc
  s_cmp_lg_u32 s9, 0
  s_cbranch_scc1 L_nfmb34d
  v_mov_b32 v125, 45184
  s_mov_b32 s43, 0
L_nfmb34:
    buffer_load_dword v124, v125, s[4:7], 0 offen sc1
    s_waitcnt vmcnt(0)
  v_readfirstlane_b32 s63, v124
  s_nop 0
  s_cmp_ge_u32 s63, 64
  s_nop 1
  s_cbranch_scc1 L_nfmb34d
  s_sleep 4
  s_add_u32 s43, s43, 1
  s_cmp_lt_u32 s43, 400000
  s_cbranch_scc1 L_nfmb34
  s_branch L_bail
L_nfmb34d:
  s_barrier
  v_lshlrev_b32 v102, 1, v8
  s_mov_b32 s56, 75776
  buffer_load_dwordx4 v[18:21], v102, s[4:7], s56 offen sc1
  s_load_dwordx2 s[44:45], s[0:1], 96
  s_waitcnt lgkmcnt(0)
  s_mov_b32 s46, 2097152
  s_mov_b32 s47, 0x20000
  s_lshl_b32 s15, s11, 7
  s_add_u32 s15, s15, 45440
  s_cmp_lg_u32 s9, 0
  s_cbranch_scc1 L_caf35
  v_mov_b32 v124, 1
  v_mov_b32 v125, s15
  s_mov_b64 exec, 1
    buffer_atomic_add v124, v125, s[4:7], 0 offen sc1
  s_mov_b64 exec, -1
L_caf35:
  s_cmp_lg_u32 s9, 0
  s_cbranch_scc1 L_nf36d
  v_mov_b32 v125, s15
  s_mov_b32 s43, 0
L_nf36:
    buffer_load_dword v124, v125, s[4:7], 0 offen sc1
    s_waitcnt vmcnt(0)
  v_readfirstlane_b32 s63, v124
  s_nop 0
  s_cmp_ge_u32 s63, 32
  s_nop 1
  s_cbranch_scc1 L_nf36d
  s_sleep 4
  s_add_u32 s43, s43, 1
  s_cmp_lt_u32 s43, 400000
  s_cbranch_scc1 L_nf36
  s_branch L_bail
L_nf36d:
  s_barrier
  s_lshl_b32 s15, s11, 2
  s_add_u32 s15, s15, 96
  v_mov_b32 v125, s15
  buffer_load_dword v124, v125, s[52:55], 0 offen sc1
  s_waitcnt vmcnt(0)
  v_readfirstlane_b32 s15, v124
  s_nop 0
  s_cmp_lg_u32 s15, 0
  s_nop 1
  s_cbranch_scc1 L_fs_start
L_ff_start:
  s_mov_b32 s10, s16
  s_add_u32 s56, s16, 48
  s_cmp_ge_u32 s16, 2
  s_cselect_b32 s10, s56, s10
  s_mov_b32 s12, 0
L_ff_loop:
  s_lshl_b32 s56, s16, 1
  s_add_u32 s56, s56, s12
  s_lshl_b32 s56, s56, 20
  s_add_u32 s13, s56, 100663296
  s_lshl_b32 s21, s10, 7
  s_add_u32 s21, s21, 28672
  s_cmp_lg_u32 s9, 0
  s_cbranch_scc1 L_war37d
  v_and_b32 v121, 63, v1
  v_cmp_gt_u32 vcc, 32, v121
  v_lshlrev_b32 v121, 2, v121
  s_nop 0
  v_cndmask_b32 v121, 0, v121, vcc
  s_mov_b32 s43, 0
L_war37:
    buffer_load_dword v120, v121, s[4:7], s21 offen sc1
    s_waitcnt vmcnt(0)
  v_cmp_eq_u32 vcc, 0, v120
  s_cbranch_vccz L_war37d
  s_sleep 1
  s_add_u32 s43, s43, 1
  s_cmp_lt_u32 s43, 400000
  s_cbranch_scc1 L_war37
  s_branch L_bail
L_war37d:
  s_barrier
  s_lshl_b32 s23, s10, 7
  s_add_u32 s23, s23, 36864
  s_cmp_ge_u32 s8, 22
  s_cbranch_scc1 L_ff_noprod
  s_lshl_b32 s57, s10, 15
  s_add_u32 s57, s57, 6291456
  s_lshr_b32 s58, s9, 1
  s_lshl_b32 s58, s58, 14
  s_add_u32 s57, s57, s58
  s_and_b32 s59, s9, 1
  s_lshl_b32 s60, s59, 9
  s_add_u32 s57, s57, s60
  s_lshl_b32 s59, s59, 13
  s_add_u32 s59, s59, s58
  s_add_u32 m0, s59, 0
  s_add_u32 s60, s57, 0
  buffer_load_dwordx4 v3, s[4:7], s60 offen sc1 lds
  s_add_u32 m0, s59, 1024
  s_add_u32 s60, s57, 64
  buffer_load_dwordx4 v3, s[4:7], s60 offen sc1 lds
  s_add_u32 m0, s59, 2048
  s_add_u32 s60, s57, 128
  buffer_load_dwordx4 v3, s[4:7], s60 offen sc1 lds
  s_add_u32 m0, s59, 3072
  s_add_u32 s60, s57, 192
  buffer_load_dwordx4 v3, s[4:7], s60 offen sc1 lds
  s_add_u32 m0, s59, 4096
  s_add_u32 s60, s57, 256
  buffer_load_dwordx4 v3, s[4:7], s60 offen sc1 lds
  s_add_u32 m0, s59, 5120
  s_add_u32 s60, s57, 320
  buffer_load_dwordx4 v3, s[4:7], s60 offen sc1 lds
  s_add_u32 m0, s59, 6144
  s_add_u32 s60, s57, 384
  buffer_load_dwordx4 v3, s[4:7], s60 offen sc1 lds
  s_add_u32 m0, s59, 7168
  s_add_u32 s60, s57, 448
  buffer_load_dwordx4 v3, s[4:7], s60 offen sc1 lds
  s_waitcnt vmcnt(0)
  s_barrier
  ds_read_b128 v[32:35], v2 offset:0
  s_nop 2
  ds_read_b128 v[36:39], v2 offset:1024
  s_nop 2
  ds_read_b128 v[40:43], v2 offset:2048
  s_nop 2
  ds_read_b128 v[44:47], v2 offset:3072
  s_nop 2
  ds_read_b128 v[48:51], v2 offset:4096
  s_waitcnt lgkmcnt(4)
  v_mfma_f32_16x16x32_bf16 v[64:67], a[0:3], v[32:35], 0
  s_nop 0
  ds_read_b128 v[52:55], v2 offset:5120
  s_waitcnt lgkmcnt(4)
  v_mfma_f32_16x16x32_bf16 v[64:67], a[4:7], v[36:39], v[64:67]
  s_nop 0
  ds_read_b128 v[56:59], v2 offset:6144
  s_waitcnt lgkmcnt(4)
  v_mfma_f32_16x16x32_bf16 v[64:67], a[8:11], v[40:43], v[64:67]
  s_nop 0
  ds_read_b128 v[60:63], v2 offset:7168
  s_waitcnt lgkmcnt(4)
  v_mfma_f32_16x16x32_bf16 v[64:67], a[12:15], v[44:47], v[64:67]
  s_nop 0
  ds_read_b128 v[32:35], v2 offset:8192
  s_waitcnt lgkmcnt(4)
  v_mfma_f32_16x16x32_bf16 v[64:67], a[16:19], v[48:51], v[64:67]
  s_nop 0
  ds_read_b128 v[36:39], v2 offset:9216
  s_waitcnt lgkmcnt(4)
  v_mfma_f32_16x16x32_bf16 v[64:67], a[20:23], v[52:55], v[64:67]
  s_nop 0
  ds_read_b128 v[40:43], v2 offset:10240
  s_waitcnt lgkmcnt(4)
  v_mfma_f32_16x16x32_bf16 v[64:67], a[24:27], v[56:59], v[64:67]
  s_nop 0
  ds_read_b128 v[44:47], v2 offset:11264
  s_waitcnt lgkmcnt(4)
  v_mfma_f32_16x16x32_bf16 v[64:67], a[28:31], v[60:63], v[64:67]
  s_nop 0
  ds_read_b128 v[48:51], v2 offset:12288
  s_waitcnt lgkmcnt(4)
  v_mfma_f32_16x16x32_bf16 v[64:67], a[32:35], v[32:35], v[64:67]
  s_nop 0
  ds_read_b128 v[32:35], v2 offset:16384
  s_waitcnt lgkmcnt(4)
  v_mfma_f32_16x16x32_bf16 v[64:67], a[36:39], v[36:39], v[64:67]
  s_nop 0
  ds_read_b128 v[36:39], v2 offset:17408
  s_waitcnt lgkmcnt(4)
  v_mfma_f32_16x16x32_bf16 v[64:67], a[40:43], v[40:43], v[64:67]
  s_nop 0
  ds_read_b128 v[52:55], v2 offset:13312
  s_waitcnt lgkmcnt(4)
  v_mfma_f32_16x16x32_bf16 v[64:67], a[44:47], v[44:47], v[64:67]
  s_nop 0
  ds_read_b128 v[40:43], v2 offset:18432
  s_waitcnt lgkmcnt(4)
  v_mfma_f32_16x16x32_bf16 v[64:67], a[48:51], v[48:51], v[64:67]
  s_nop 0
  ds_read_b128 v[56:59], v2 offset:14336
  s_waitcnt lgkmcnt(4)
  v_mfma_f32_16x16x32_bf16 v[68:71], a[0:3], v[32:35], 0
  s_nop 0
  ds_read_b128 v[44:47], v2 offset:19456
  s_waitcnt lgkmcnt(4)
  v_mfma_f32_16x16x32_bf16 v[68:71], a[4:7], v[36:39], v[68:71]
  s_nop 0
  ds_read_b128 v[60:63], v2 offset:15360
  s_waitcnt lgkmcnt(4)
  v_mfma_f32_16x16x32_bf16 v[64:67], a[52:55], v[52:55], v[64:67]
  s_nop 0
  ds_read_b128 v[48:51], v2 offset:20480
  s_waitcnt lgkmcnt(4)
  v_mfma_f32_16x16x32_bf16 v[68:71], a[8:11], v[40:43], v[68:71]
  s_nop 0
  ds_read_b128 v[52:55], v2 offset:21504
  s_waitcnt lgkmcnt(4)
  v_mfma_f32_16x16x32_bf16 v[64:67], a[56:59], v[56:59], v[64:67]
  s_nop 0
  ds_read_b128 v[56:59], v2 offset:22528
  s_waitcnt lgkmcnt(4)
  v_mfma_f32_16x16x32_bf16 v[68:71], a[12:15], v[44:47], v[68:71]
  s_nop 0
  ds_read_b128 v[32:35], v2 offset:24576
  s_waitcnt lgkmcnt(4)
  v_mfma_f32_16x16x32_bf16 v[64:67], a[60:63], v[60:63], v[64:67]
  s_nop 0
  ds_read_b128 v[60:63], v2 offset:23552
  s_waitcnt lgkmcnt(4)
  v_mfma_f32_16x16x32_bf16 v[68:71], a[16:19], v[48:51], v[68:71]
  s_nop 0
  ds_read_b128 v[36:39], v2 offset:25600
  s_waitcnt lgkmcnt(4)
  v_mfma_f32_16x16x32_bf16 v[68:71], a[20:23], v[52:55], v[68:71]
  s_nop 0
  ds_read_b128 v[40:43], v2 offset:26624
  v_max_f32 v64, 0, v64
  s_waitcnt lgkmcnt(4)
  v_mfma_f32_16x16x32_bf16 v[68:71], a[24:27], v[56:59], v[68:71]
  s_nop 0
  ds_read_b128 v[44:47], v2 offset:27648
  v_max_f32 v65, 0, v65
  v_max_f32 v66, 0, v66
  v_max_f32 v67, 0, v67
  ds_read_b128 v[48:51], v2 offset:28672
  s_waitcnt lgkmcnt(4)
  v_mfma_f32_16x16x32_bf16 v[68:71], a[28:31], v[60:63], v[68:71]
  ds_read_b128 v[52:55], v2 offset:29696
  v_cvt_pk_bf16_f32 v72, v64, v65
  v_cvt_pk_bf16_f32 v73, v66, v67
  v_mfma_f32_16x16x32_bf16 v[68:71], a[32:35], v[32:35], v[68:71]
  ds_read_b128 v[56:59], v2 offset:30720
  s_waitcnt lgkmcnt(5)
  v_mfma_f32_16x16x32_bf16 v[68:71], a[36:39], v[36:39], v[68:71]
  ds_read_b128 v[60:63], v2 offset:31744
  s_waitcnt lgkmcnt(5)
  v_mfma_f32_16x16x32_bf16 v[68:71], a[40:43], v[40:43], v[68:71]
  s_waitcnt lgkmcnt(4)
  v_mfma_f32_16x16x32_bf16 v[68:71], a[44:47], v[44:47], v[68:71]
  s_waitcnt lgkmcnt(3)
  v_mfma_f32_16x16x32_bf16 v[68:71], a[48:51], v[48:51], v[68:71]
  s_waitcnt lgkmcnt(2)
  v_mfma_f32_16x16x32_bf16 v[68:71], a[52:55], v[52:55], v[68:71]
  s_waitcnt lgkmcnt(1)
  v_mfma_f32_16x16x32_bf16 v[68:71], a[56:59], v[56:59], v[68:71]
  s_waitcnt lgkmcnt(0)
  v_mfma_f32_16x16x32_bf16 v[68:71], a[60:63], v[60:63], v[68:71]
  s_nop 7
  v_max_f32 v68, 0, v68
  v_max_f32 v69, 0, v69
  v_max_f32 v70, 0, v70
  v_max_f32 v71, 0, v71
  v_cvt_pk_bf16_f32 v74, v68, v69
  v_cvt_pk_bf16_f32 v75, v70, v71
  ds_write_b64 v4, v[72:73] offset:0
  ds_write_b64 v4, v[74:75] offset:2048
  s_waitcnt lgkmcnt(0)
  s_barrier
  ds_read_b128 v[32:35], v2 offset:32768
  s_add_u32 s56, s13, 0
  s_add_u32 s57, s13, 32768
  s_add_u32 s58, s13, 65536
  ds_read_b128 v[36:39], v2 offset:33792
  s_add_u32 s59, s13, 98304
  s_add_u32 s60, s13, 524288
  s_add_u32 s61, s13, 557056
  ds_read_b128 v[40:43], v2 offset:34816
  s_nop 2
  ds_read_b128 v[44:47], v2 offset:35840
  s_waitcnt lgkmcnt(3)
  v_mfma_f32_16x16x32_bf16 v[64:67], v[32:35], a[64:67], 0
  s_waitcnt lgkmcnt(2)
  v_mfma_f32_16x16x32_bf16 v[64:67], v[36:39], a[68:71], v[64:67]
  v_mfma_f32_16x16x32_bf16 v[68:71], v[32:35], a[72:75], 0
  v_mfma_f32_16x16x32_bf16 v[68:71], v[36:39], a[76:79], v[68:71]
  v_mfma_f32_16x16x32_bf16 v[72:75], v[32:35], a[80:83], 0
  v_mfma_f32_16x16x32_bf16 v[72:75], v[36:39], a[84:87], v[72:75]
  v_cvt_pk_bf16_f32 v192, v64, v68
  v_cvt_pk_bf16_f32 v196, v65, v69
  v_mfma_f32_16x16x32_bf16 v[76:79], v[32:35], a[88:91], 0
  v_cvt_pk_bf16_f32 v200, v66, v70
  v_cvt_pk_bf16_f32 v204, v67, v71
  v_mfma_f32_16x16x32_bf16 v[76:79], v[36:39], a[92:95], v[76:79]
  v_mfma_f32_16x16x32_bf16 v[80:83], v[32:35], a[96:99], 0
  v_mfma_f32_16x16x32_bf16 v[80:83], v[36:39], a[100:103], v[80:83]
  v_cvt_pk_bf16_f32 v193, v72, v76
  v_cvt_pk_bf16_f32 v197, v73, v77
  v_mfma_f32_16x16x32_bf16 v[84:87], v[32:35], a[104:107], 0
  v_cvt_pk_bf16_f32 v201, v74, v78
  v_cvt_pk_bf16_f32 v205, v75, v79
  v_mfma_f32_16x16x32_bf16 v[84:87], v[36:39], a[108:111], v[84:87]
  v_mfma_f32_16x16x32_bf16 v[88:91], v[32:35], a[112:115], 0
  v_mfma_f32_16x16x32_bf16 v[88:91], v[36:39], a[116:119], v[88:91]
  v_cvt_pk_bf16_f32 v194, v80, v84
  v_cvt_pk_bf16_f32 v198, v81, v85
  v_mfma_f32_16x16x32_bf16 v[92:95], v[32:35], a[120:123], 0
  v_cvt_pk_bf16_f32 v202, v82, v86
  v_cvt_pk_bf16_f32 v206, v83, v87
  v_mfma_f32_16x16x32_bf16 v[92:95], v[36:39], a[124:127], v[92:95]
  s_waitcnt lgkmcnt(1)
  v_mfma_f32_16x16x32_bf16 v[96:99], v[40:43], a[64:67], 0
  s_waitcnt lgkmcnt(0)
  v_mfma_f32_16x16x32_bf16 v[96:99], v[44:47], a[68:71], v[96:99]
  v_cvt_pk_bf16_f32 v195, v88, v92
  buffer_store_dwordx4 v[192:195], v6, s[4:7], s56 offen
  v_cvt_pk_bf16_f32 v199, v89, v93
  s_add_u32 s56, s13, 589824
  buffer_store_dwordx4 v[196:199], v6, s[4:7], s57 offen
  v_mfma_f32_16x16x32_bf16 v[100:103], v[40:43], a[72:75], 0
  s_add_u32 s57, s13, 622592
  v_cvt_pk_bf16_f32 v203, v90, v94
  v_cvt_pk_bf16_f32 v207, v91, v95
  buffer_store_dwordx4 v[200:203], v6, s[4:7], s58 offen
  v_mfma_f32_16x16x32_bf16 v[100:103], v[44:47], a[76:79], v[100:103]
  v_mfma_f32_16x16x32_bf16 v[104:107], v[40:43], a[80:83], 0
  v_mfma_f32_16x16x32_bf16 v[104:107], v[44:47], a[84:87], v[104:107]
  v_cvt_pk_bf16_f32 v208, v96, v100
  v_cvt_pk_bf16_f32 v212, v97, v101
  v_mfma_f32_16x16x32_bf16 v[108:111], v[40:43], a[88:91], 0
  v_cvt_pk_bf16_f32 v216, v98, v102
  v_cvt_pk_bf16_f32 v220, v99, v103
  v_mfma_f32_16x16x32_bf16 v[108:111], v[44:47], a[92:95], v[108:111]
  v_mfma_f32_16x16x32_bf16 v[112:115], v[40:43], a[96:99], 0
  v_mfma_f32_16x16x32_bf16 v[112:115], v[44:47], a[100:103], v[112:115]
  buffer_store_dwordx4 v[204:207], v6, s[4:7], s59 offen
  v_mfma_f32_16x16x32_bf16 v[116:119], v[40:43], a[104:107], 0
  v_cvt_pk_bf16_f32 v209, v104, v108
  v_cvt_pk_bf16_f32 v213, v105, v109
  v_mfma_f32_16x16x32_bf16 v[116:119], v[44:47], a[108:111], v[116:119]
  v_cvt_pk_bf16_f32 v217, v106, v110
  v_cvt_pk_bf16_f32 v221, v107, v111
  v_mfma_f32_16x16x32_bf16 v[120:123], v[40:43], a[112:115], 0
  v_mfma_f32_16x16x32_bf16 v[120:123], v[44:47], a[116:119], v[120:123]
  v_cvt_pk_bf16_f32 v210, v112, v116
  v_cvt_pk_bf16_f32 v214, v113, v117
  v_mfma_f32_16x16x32_bf16 v[124:127], v[40:43], a[120:123], 0
  v_cvt_pk_bf16_f32 v218, v114, v118
  v_cvt_pk_bf16_f32 v222, v115, v119
  v_mfma_f32_16x16x32_bf16 v[124:127], v[44:47], a[124:127], v[124:127]
  s_nop 7
  v_cvt_pk_bf16_f32 v211, v120, v124
  buffer_store_dwordx4 v[208:211], v6, s[4:7], s60 offen
  v_cvt_pk_bf16_f32 v215, v121, v125
  v_cvt_pk_bf16_f32 v219, v122, v126
  v_cvt_pk_bf16_f32 v223, v123, v127
  buffer_store_dwordx4 v[212:215], v6, s[4:7], s61 offen
  buffer_store_dwordx4 v[216:219], v6, s[4:7], s56 offen
  buffer_store_dwordx4 v[220:223], v6, s[4:7], s57 offen
  s_waitcnt vmcnt(0)
  s_barrier
  s_lshl_b32 s22, s8, 2
  s_add_u32 s22, s22, s23
  s_cmp_lg_u32 s9, 0
  s_cbranch_scc1 L_sg38
  v_cmp_eq_u32 vcc, 0, v1
  v_mov_b32 v120, 0x7ffffff0
  s_nop 0
  v_cndmask_b32 v121, v120, 0, vcc
  v_mov_b32 v120, 1
    buffer_store_dword v120, v121, s[4:7], s22 offen
L_sg38:
L_ff_noprod:
  s_cmp_lg_u32 s9, 0
  s_cbranch_scc1 L_wfp39d
  v_and_b32 v121, 63, v1
  v_cmp_gt_u32 vcc, 22, v121
  v_lshlrev_b32 v121, 2, v121
  s_nop 0
  v_cndmask_b32 v121, 0, v121, vcc
  s_mov_b32 s43, 0
L_wfp39:
    buffer_load_dword v120, v121, s[4:7], s23 offen sc1
    s_waitcnt vmcnt(0)
  v_cmp_eq_u32 vcc, 0, v120
  s_cbranch_vccz L_wfp39d
  s_sleep 1
  s_add_u32 s43, s43, 1
  s_cmp_lt_u32 s43, 400000
  s_cbranch_scc1 L_wfp39
  s_branch L_bail
L_wfp39d:
  s_barrier
  s_lshl_b32 s56, s8, 15
  s_add_u32 s56, s56, s13
  s_lshl_b32 s57, s10, 15
  s_lshl_b32 s58, s8, 10
  s_add_u32 s24, s57, s58
  s_add_u32 s25, s24, 4194304
  buffer_load_dwordx2 v[68:69], v8, s[4:7], s25 offen sc1
  v_cmp_le_u32 vcc, 32, v1
  v_mov_b32 v77, 0x7ff00000
  s_nop 0
  v_cndmask_b32 v76, v7, v77, vcc
  s_add_u32 s59, s56, 0
  buffer_load_dwordx4 v[32:35], v7, s[4:7], s59 offen sc1
  s_add_u32 s59, s56, 4096
  buffer_load_dwordx4 v[36:39], v7, s[4:7], s59 offen sc1
  s_add_u32 s59, s56, 8192
  buffer_load_dwordx4 v[40:43], v7, s[4:7], s59 offen sc1
  s_add_u32 s59, s56, 12288
  buffer_load_dwordx4 v[44:47], v7, s[4:7], s59 offen sc1
  s_add_u32 s59, s56, 16384
  buffer_load_dwordx4 v[48:51], v7, s[4:7], s59 offen sc1
  s_add_u32 s59, s56, 20480
  buffer_load_dwordx4 v[52:55], v76, s[4:7], s59 offen sc1
  s_waitcnt vmcnt(5)
  v_mfma_f32_16x16x32_bf16 v[64:67], v[10:13], v[32:35], 0
  s_waitcnt vmcnt(4)
  v_mfma_f32_16x16x32_bf16 v[64:67], v[10:13], v[36:39], v[64:67]
  s_waitcnt vmcnt(3)
  v_mfma_f32_16x16x32_bf16 v[64:67], v[10:13], v[40:43], v[64:67]
  s_waitcnt vmcnt(2)
  v_mfma_f32_16x16x32_bf16 v[64:67], v[10:13], v[44:47], v[64:67]
  s_waitcnt vmcnt(1)
  v_mfma_f32_16x16x32_bf16 v[64:67], v[10:13], v[48:51], v[64:67]
  s_waitcnt vmcnt(0)
  v_mfma_f32_16x16x32_bf16 v[64:67], v[10:13], v[52:55], v[64:67]
  v_lshlrev_b32 v72, 16, v68
  v_and_b32 v73, 0xffff0000, v68
  v_lshlrev_b32 v74, 16, v69
  v_and_b32 v75, 0xffff0000, v69
  s_nop 3
  v_fma_f32 v72, v64, v18, v72
  v_fma_f32 v73, v65, v19, v73
  v_fma_f32 v74, v66, v20, v74
  v_fma_f32 v75, v67, v21, v75
  v_cvt_pk_bf16_f32 v68, v72, v73
  v_cvt_pk_bf16_f32 v69, v74, v75
  buffer_store_dwordx2 v[68:69], v8, s[44:47], s24 offen
  s_waitcnt vmcnt(0)
  s_barrier
  s_xor_b32 s12, s12, 1
  s_add_u32 s29, s10, 3
  s_cmp_ge_u32 s10, 48
  s_cbranch_scc1 L_nsfff
  s_add_u32 s29, s10, 2
  s_cmp_lt_u32 s29, 48
  s_cbranch_scc1 L_nsfff
  s_add_u32 s29, s16, 48
L_nsfff:
  s_mov_b32 s10, s29
  s_cmp_lt_u32 s10, 64
  s_cbranch_scc1 L_ff_loop
  s_waitcnt vmcnt(0)
  s_endpgm
L_fs_start:
  s_mov_b32 s10, s16
  s_add_u32 s56, s16, 48
  s_cmp_ge_u32 s16, 2
  s_cselect_b32 s10, s56, s10
  s_mov_b32 s12, 0
L_fs_loop:
  s_lshl_b32 s56, s16, 1
  s_add_u32 s56, s56, s12
  s_lshl_b32 s56, s56, 20
  s_add_u32 s13, s56, 100663296
  s_lshl_b32 s21, s10, 7
  s_add_u32 s21, s21, 28672
  s_cmp_lg_u32 s9, 0
  s_cbranch_scc1 L_war40d
  v_and_b32 v121, 63, v1
  v_cmp_gt_u32 vcc, 32, v121
  v_lshlrev_b32 v121, 2, v121
  s_nop 0
  v_cndmask_b32 v121, 0, v121, vcc
  s_mov_b32 s43, 0
L_war40:
    buffer_load_dword v120, v121, s[4:7], s21 offen sc1
    s_waitcnt vmcnt(0)
  v_cmp_eq_u32 vcc, 0, v120
  s_cbranch_vccz L_war40d
  s_sleep 1
  s_add_u32 s43, s43, 1
  s_cmp_lt_u32 s43, 400000
  s_cbranch_scc1 L_war40
  s_branch L_bail
L_war40d:
  s_barrier
  s_lshl_b32 s23, s10, 7
  s_add_u32 s23, s23, 36864
  s_cmp_ge_u32 s8, 22
  s_cbranch_scc1 L_fs_noprod
  s_lshl_b32 s57, s10, 15
  s_add_u32 s57, s57, 6291456
  s_lshr_b32 s58, s9, 1
  s_lshl_b32 s58, s58, 14
  s_add_u32 s57, s57, s58
  s_and_b32 s59, s9, 1
  s_lshl_b32 s60, s59, 9
  s_add_u32 s57, s57, s60
  s_lshl_b32 s59, s59, 13
  s_add_u32 s59, s59, s58
  s_add_u32 m0, s59, 0
  s_add_u32 s60, s57, 0
  buffer_load_dwordx4 v3, s[4:7], s60 offen sc1 lds
  s_add_u32 m0, s59, 1024
  s_add_u32 s60, s57, 64
  buffer_load_dwordx4 v3, s[4:7], s60 offen sc1 lds
  s_add_u32 m0, s59, 2048
  s_add_u32 s60, s57, 128
  buffer_load_dwordx4 v3, s[4:7], s60 offen sc1 lds
  s_add_u32 m0, s59, 3072
  s_add_u32 s60, s57, 192
  buffer_load_dwordx4 v3, s[4:7], s60 offen sc1 lds
  s_add_u32 m0, s59, 4096
  s_add_u32 s60, s57, 256
  buffer_load_dwordx4 v3, s[4:7], s60 offen sc1 lds
  s_add_u32 m0, s59, 5120
  s_add_u32 s60, s57, 320
  buffer_load_dwordx4 v3, s[4:7], s60 offen sc1 lds
  s_add_u32 m0, s59, 6144
  s_add_u32 s60, s57, 384
  buffer_load_dwordx4 v3, s[4:7], s60 offen sc1 lds
  s_add_u32 m0, s59, 7168
  s_add_u32 s60, s57, 448
  buffer_load_dwordx4 v3, s[4:7], s60 offen sc1 lds
  s_waitcnt vmcnt(0)
  s_barrier
  ds_read_b128 v[32:35], v2 offset:0
  s_nop 2
  ds_read_b128 v[36:39], v2 offset:1024
  s_nop 2
  ds_read_b128 v[40:43], v2 offset:2048
  s_nop 2
  ds_read_b128 v[44:47], v2 offset:3072
  s_nop 2
  ds_read_b128 v[48:51], v2 offset:4096
  s_waitcnt lgkmcnt(4)
  v_mfma_f32_16x16x32_bf16 v[64:67], a[0:3], v[32:35], 0
  s_nop 0
  ds_read_b128 v[52:55], v2 offset:5120
  s_waitcnt lgkmcnt(4)
  v_mfma_f32_16x16x32_bf16 v[64:67], a[4:7], v[36:39], v[64:67]
  s_nop 0
  ds_read_b128 v[56:59], v2 offset:6144
  s_waitcnt lgkmcnt(4)
  v_mfma_f32_16x16x32_bf16 v[64:67], a[8:11], v[40:43], v[64:67]
  s_nop 0
  ds_read_b128 v[60:63], v2 offset:7168
  s_waitcnt lgkmcnt(4)
  v_mfma_f32_16x16x32_bf16 v[64:67], a[12:15], v[44:47], v[64:67]
  s_nop 0
  ds_read_b128 v[32:35], v2 offset:8192
  s_waitcnt lgkmcnt(4)
  v_mfma_f32_16x16x32_bf16 v[64:67], a[16:19], v[48:51], v[64:67]
  s_nop 0
  ds_read_b128 v[36:39], v2 offset:9216
  s_waitcnt lgkmcnt(4)
  v_mfma_f32_16x16x32_bf16 v[64:67], a[20:23], v[52:55], v[64:67]
  s_nop 0
  ds_read_b128 v[40:43], v2 offset:10240
  s_waitcnt lgkmcnt(4)
  v_mfma_f32_16x16x32_bf16 v[64:67], a[24:27], v[56:59], v[64:67]
  s_nop 0
  ds_read_b128 v[44:47], v2 offset:11264
  s_waitcnt lgkmcnt(4)
  v_mfma_f32_16x16x32_bf16 v[64:67], a[28:31], v[60:63], v[64:67]
  s_nop 0
  ds_read_b128 v[48:51], v2 offset:12288
  s_waitcnt lgkmcnt(4)
  v_mfma_f32_16x16x32_bf16 v[64:67], a[32:35], v[32:35], v[64:67]
  s_nop 0
  ds_read_b128 v[32:35], v2 offset:16384
  s_waitcnt lgkmcnt(4)
  v_mfma_f32_16x16x32_bf16 v[64:67], a[36:39], v[36:39], v[64:67]
  s_nop 0
  ds_read_b128 v[36:39], v2 offset:17408
  s_waitcnt lgkmcnt(4)
  v_mfma_f32_16x16x32_bf16 v[64:67], a[40:43], v[40:43], v[64:67]
  s_nop 0
  ds_read_b128 v[52:55], v2 offset:13312
  s_waitcnt lgkmcnt(4)
  v_mfma_f32_16x16x32_bf16 v[64:67], a[44:47], v[44:47], v[64:67]
  s_nop 0
  ds_read_b128 v[40:43], v2 offset:18432
  s_waitcnt lgkmcnt(4)
  v_mfma_f32_16x16x32_bf16 v[64:67], a[48:51], v[48:51], v[64:67]
  s_nop 0
  ds_read_b128 v[56:59], v2 offset:14336
  s_waitcnt lgkmcnt(4)
  v_mfma_f32_16x16x32_bf16 v[68:71], a[0:3], v[32:35], 0
  s_nop 0
  ds_read_b128 v[44:47], v2 offset:19456
  s_waitcnt lgkmcnt(4)
  v_mfma_f32_16x16x32_bf16 v[68:71], a[4:7], v[36:39], v[68:71]
  s_nop 0
  ds_read_b128 v[60:63], v2 offset:15360
  s_waitcnt lgkmcnt(4)
  v_mfma_f32_16x16x32_bf16 v[64:67], a[52:55], v[52:55], v[64:67]
  s_nop 0
  ds_read_b128 v[48:51], v2 offset:20480
  s_waitcnt lgkmcnt(4)
  v_mfma_f32_16x16x32_bf16 v[68:71], a[8:11], v[40:43], v[68:71]
  s_nop 0
  ds_read_b128 v[52:55], v2 offset:21504
  s_waitcnt lgkmcnt(4)
  v_mfma_f32_16x16x32_bf16 v[64:67], a[56:59], v[56:59], v[64:67]
  s_nop 0
  ds_read_b128 v[56:59], v2 offset:22528
  s_waitcnt lgkmcnt(4)
  v_mfma_f32_16x16x32_bf16 v[68:71], a[12:15], v[44:47], v[68:71]
  s_nop 0
  ds_read_b128 v[32:35], v2 offset:24576
  s_waitcnt lgkmcnt(4)
  v_mfma_f32_16x16x32_bf16 v[64:67], a[60:63], v[60:63], v[64:67]
  s_nop 0
  ds_read_b128 v[60:63], v2 offset:23552
  s_waitcnt lgkmcnt(4)
  v_mfma_f32_16x16x32_bf16 v[68:71], a[16:19], v[48:51], v[68:71]
  s_nop 0
  ds_read_b128 v[36:39], v2 offset:25600
  s_waitcnt lgkmcnt(4)
  v_mfma_f32_16x16x32_bf16 v[68:71], a[20:23], v[52:55], v[68:71]
  s_nop 0
  ds_read_b128 v[40:43], v2 offset:26624
  v_max_f32 v64, 0, v64
  s_waitcnt lgkmcnt(4)
  v_mfma_f32_16x16x32_bf16 v[68:71], a[24:27], v[56:59], v[68:71]
  s_nop 0
  ds_read_b128 v[44:47], v2 offset:27648
  v_max_f32 v65, 0, v65
  v_max_f32 v66, 0, v66
  v_max_f32 v67, 0, v67
  ds_read_b128 v[48:51], v2 offset:28672
  s_waitcnt lgkmcnt(4)
  v_mfma_f32_16x16x32_bf16 v[68:71], a[28:31], v[60:63], v[68:71]
  ds_read_b128 v[52:55], v2 offset:29696
  v_cvt_pk_bf16_f32 v72, v64, v65
  v_cvt_pk_bf16_f32 v73, v66, v67
  v_mfma_f32_16x16x32_bf16 v[68:71], a[32:35], v[32:35], v[68:71]
  ds_read_b128 v[56:59], v2 offset:30720
  s_waitcnt lgkmcnt(5)
  v_mfma_f32_16x16x32_bf16 v[68:71], a[36:39], v[36:39], v[68:71]
  ds_read_b128 v[60:63], v2 offset:31744
  s_waitcnt lgkmcnt(5)
  v_mfma_f32_16x16x32_bf16 v[68:71], a[40:43], v[40:43], v[68:71]
  s_waitcnt lgkmcnt(4)
  v_mfma_f32_16x16x32_bf16 v[68:71], a[44:47], v[44:47], v[68:71]
  s_waitcnt lgkmcnt(3)
  v_mfma_f32_16x16x32_bf16 v[68:71], a[48:51], v[48:51], v[68:71]
  s_waitcnt lgkmcnt(2)
  v_mfma_f32_16x16x32_bf16 v[68:71], a[52:55], v[52:55], v[68:71]
  s_waitcnt lgkmcnt(1)
  v_mfma_f32_16x16x32_bf16 v[68:71], a[56:59], v[56:59], v[68:71]
  s_waitcnt lgkmcnt(0)
  v_mfma_f32_16x16x32_bf16 v[68:71], a[60:63], v[60:63], v[68:71]
  s_nop 7
  v_max_f32 v68, 0, v68
  v_max_f32 v69, 0, v69
  v_max_f32 v70, 0, v70
  v_max_f32 v71, 0, v71
  v_cvt_pk_bf16_f32 v74, v68, v69
  v_cvt_pk_bf16_f32 v75, v70, v71
  ds_write_b64 v4, v[72:73] offset:0
  ds_write_b64 v4, v[74:75] offset:2048
  s_waitcnt lgkmcnt(0)
  s_barrier
  ds_read_b128 v[32:35], v2 offset:32768
  s_add_u32 s56, s13, 0
  s_add_u32 s57, s13, 32768
  s_add_u32 s58, s13, 65536
  ds_read_b128 v[36:39], v2 offset:33792
  s_add_u32 s59, s13, 98304
  s_add_u32 s60, s13, 524288
  s_add_u32 s61, s13, 557056
  ds_read_b128 v[40:43], v2 offset:34816
  s_nop 2
  ds_read_b128 v[44:47], v2 offset:35840
  s_waitcnt lgkmcnt(3)
  v_mfma_f32_16x16x32_bf16 v[64:67], v[32:35], a[64:67], 0
  s_waitcnt lgkmcnt(2)
  v_mfma_f32_16x16x32_bf16 v[64:67], v[36:39], a[68:71], v[64:67]
  v_mfma_f32_16x16x32_bf16 v[68:71], v[32:35], a[72:75], 0
  v_mfma_f32_16x16x32_bf16 v[68:71], v[36:39], a[76:79], v[68:71]
  v_mfma_f32_16x16x32_bf16 v[72:75], v[32:35], a[80:83], 0
  v_mfma_f32_16x16x32_bf16 v[72:75], v[36:39], a[84:87], v[72:75]
  v_cvt_pk_bf16_f32 v192, v64, v68
  v_cvt_pk_bf16_f32 v196, v65, v69
  v_mfma_f32_16x16x32_bf16 v[76:79], v[32:35], a[88:91], 0
  v_cvt_pk_bf16_f32 v200, v66, v70
  v_cvt_pk_bf16_f32 v204, v67, v71
  v_mfma_f32_16x16x32_bf16 v[76:79], v[36:39], a[92:95], v[76:79]
  v_mfma_f32_16x16x32_bf16 v[80:83], v[32:35], a[96:99], 0
  v_mfma_f32_16x16x32_bf16 v[80:83], v[36:39], a[100:103], v[80:83]
  v_cvt_pk_bf16_f32 v193, v72, v76
  v_cvt_pk_bf16_f32 v197, v73, v77
  v_mfma_f32_16x16x32_bf16 v[84:87], v[32:35], a[104:107], 0
  v_cvt_pk_bf16_f32 v201, v74, v78
  v_cvt_pk_bf16_f32 v205, v75, v79
  v_mfma_f32_16x16x32_bf16 v[84:87], v[36:39], a[108:111], v[84:87]
  v_mfma_f32_16x16x32_bf16 v[88:91], v[32:35], a[112:115], 0
  v_mfma_f32_16x16x32_bf16 v[88:91], v[36:39], a[116:119], v[88:91]
  v_cvt_pk_bf16_f32 v194, v80, v84
  v_cvt_pk_bf16_f32 v198, v81, v85
  v_mfma_f32_16x16x32_bf16 v[92:95], v[32:35], a[120:123], 0
  v_cvt_pk_bf16_f32 v202, v82, v86
  v_cvt_pk_bf16_f32 v206, v83, v87
  v_mfma_f32_16x16x32_bf16 v[92:95], v[36:39], a[124:127], v[92:95]
  s_waitcnt lgkmcnt(1)
  v_mfma_f32_16x16x32_bf16 v[96:99], v[40:43], a[64:67], 0
  s_waitcnt lgkmcnt(0)
  v_mfma_f32_16x16x32_bf16 v[96:99], v[44:47], a[68:71], v[96:99]
  v_cvt_pk_bf16_f32 v195, v88, v92
  buffer_store_dwordx4 v[192:195], v6, s[4:7], s56 offen sc1
  v_cvt_pk_bf16_f32 v199, v89, v93
  s_add_u32 s56, s13, 589824
  buffer_store_dwordx4 v[196:199], v6, s[4:7], s57 offen sc1
  v_mfma_f32_16x16x32_bf16 v[100:103], v[40:43], a[72:75], 0
  s_add_u32 s57, s13, 622592
  v_cvt_pk_bf16_f32 v203, v90, v94
  v_cvt_pk_bf16_f32 v207, v91, v95
  buffer_store_dwordx4 v[200:203], v6, s[4:7], s58 offen sc1
  v_mfma_f32_16x16x32_bf16 v[100:103], v[44:47], a[76:79], v[100:103]
  v_mfma_f32_16x16x32_bf16 v[104:107], v[40:43], a[80:83], 0
  v_mfma_f32_16x16x32_bf16 v[104:107], v[44:47], a[84:87], v[104:107]
  v_cvt_pk_bf16_f32 v208, v96, v100
  v_cvt_pk_bf16_f32 v212, v97, v101
  v_mfma_f32_16x16x32_bf16 v[108:111], v[40:43], a[88:91], 0
  v_cvt_pk_bf16_f32 v216, v98, v102
  v_cvt_pk_bf16_f32 v220, v99, v103
  v_mfma_f32_16x16x32_bf16 v[108:111], v[44:47], a[92:95], v[108:111]
  v_mfma_f32_16x16x32_bf16 v[112:115], v[40:43], a[96:99], 0
  v_mfma_f32_16x16x32_bf16 v[112:115], v[44:47], a[100:103], v[112:115]
  buffer_store_dwordx4 v[204:207], v6, s[4:7], s59 offen sc1
  v_mfma_f32_16x16x32_bf16 v[116:119], v[40:43], a[104:107], 0
  v_cvt_pk_bf16_f32 v209, v104, v108
  v_cvt_pk_bf16_f32 v213, v105, v109
  v_mfma_f32_16x16x32_bf16 v[116:119], v[44:47], a[108:111], v[116:119]
  v_cvt_pk_bf16_f32 v217, v106, v110
  v_cvt_pk_bf16_f32 v221, v107, v111
  v_mfma_f32_16x16x32_bf16 v[120:123], v[40:43], a[112:115], 0
  v_mfma_f32_16x16x32_bf16 v[120:123], v[44:47], a[116:119], v[120:123]
  v_cvt_pk_bf16_f32 v210, v112, v116
  v_cvt_pk_bf16_f32 v214, v113, v117
  v_mfma_f32_16x16x32_bf16 v[124:127], v[40:43], a[120:123], 0
  v_cvt_pk_bf16_f32 v218, v114, v118
  v_cvt_pk_bf16_f32 v222, v115, v119
  v_mfma_f32_16x16x32_bf16 v[124:127], v[44:47], a[124:127], v[124:127]
  s_nop 7
  v_cvt_pk_bf16_f32 v211, v120, v124
  buffer_store_dwordx4 v[208:211], v6, s[4:7], s60 offen sc1
  v_cvt_pk_bf16_f32 v215, v121, v125
  v_cvt_pk_bf16_f32 v219, v122, v126
  v_cvt_pk_bf16_f32 v223, v123, v127
  buffer_store_dwordx4 v[212:215], v6, s[4:7], s61 offen sc1
  buffer_store_dwordx4 v[216:219], v6, s[4:7], s56 offen sc1
  buffer_store_dwordx4 v[220:223], v6, s[4:7], s57 offen sc1
  s_waitcnt vmcnt(0)
  s_barrier
  s_lshl_b32 s22, s8, 2
  s_add_u32 s22, s22, s23
  s_cmp_lg_u32 s9, 0
  s_cbranch_scc1 L_sg41
  v_cmp_eq_u32 vcc, 0, v1
  v_mov_b32 v120, 0x7ffffff0
  s_nop 0
  v_cndmask_b32 v121, v120, 0, vcc
  v_mov_b32 v120, 1
    buffer_store_dword v120, v121, s[4:7], s22 offen sc1
L_sg41:
L_fs_noprod:
  s_cmp_lg_u32 s9, 0
  s_cbranch_scc1 L_wfp42d
  v_and_b32 v121, 63, v1
  v_cmp_gt_u32 vcc, 22, v121
  v_lshlrev_b32 v121, 2, v121
  s_nop 0
  v_cndmask_b32 v121, 0, v121, vcc
  s_mov_b32 s43, 0
L_wfp42:
    buffer_load_dword v120, v121, s[4:7], s23 offen sc1
    s_waitcnt vmcnt(0)
  v_cmp_eq_u32 vcc, 0, v120
  s_cbranch_vccz L_wfp42d
  s_sleep 1
  s_add_u32 s43, s43, 1
  s_cmp_lt_u32 s43, 400000
  s_cbranch_scc1 L_wfp42
  s_branch L_bail
L_wfp42d:
  s_barrier
  s_lshl_b32 s56, s8, 15
  s_add_u32 s56, s56, s13
  s_lshl_b32 s57, s10, 15
  s_lshl_b32 s58, s8, 10
  s_add_u32 s24, s57, s58
  s_add_u32 s25, s24, 4194304
  buffer_load_dwordx2 v[68:69], v8, s[4:7], s25 offen sc1
  v_cmp_le_u32 vcc, 32, v1
  v_mov_b32 v77, 0x7ff00000
  s_nop 0
  v_cndmask_b32 v76, v7, v77, vcc
  s_add_u32 s59, s56, 0
  buffer_load_dwordx4 v[32:35], v7, s[4:7], s59 offen sc1
  s_add_u32 s59, s56, 4096
  buffer_load_dwordx4 v[36:39], v7, s[4:7], s59 offen sc1
  s_add_u32 s59, s56, 8192
  buffer_load_dwordx4 v[40:43], v7, s[4:7], s59 offen sc1
  s_add_u32 s59, s56, 12288
  buffer_load_dwordx4 v[44:47], v7, s[4:7], s59 offen sc1
  s_add_u32 s59, s56, 16384
  buffer_load_dwordx4 v[48:51], v7, s[4:7], s59 offen sc1
  s_add_u32 s59, s56, 20480
  buffer_load_dwordx4 v[52:55], v76, s[4:7], s59 offen sc1
  s_waitcnt vmcnt(5)
  v_mfma_f32_16x16x32_bf16 v[64:67], v[10:13], v[32:35], 0
  s_waitcnt vmcnt(4)
  v_mfma_f32_16x16x32_bf16 v[64:67], v[10:13], v[36:39], v[64:67]
  s_waitcnt vmcnt(3)
  v_mfma_f32_16x16x32_bf16 v[64:67], v[10:13], v[40:43], v[64:67]
  s_waitcnt vmcnt(2)
  v_mfma_f32_16x16x32_bf16 v[64:67], v[10:13], v[44:47], v[64:67]
  s_waitcnt vmcnt(1)
  v_mfma_f32_16x16x32_bf16 v[64:67], v[10:13], v[48:51], v[64:67]
  s_waitcnt vmcnt(0)
  v_mfma_f32_16x16x32_bf16 v[64:67], v[10:13], v[52:55], v[64:67]
  v_lshlrev_b32 v72, 16, v68
  v_and_b32 v73, 0xffff0000, v68
  v_lshlrev_b32 v74, 16, v69
  v_and_b32 v75, 0xffff0000, v69
  s_nop 3
  v_fma_f32 v72, v64, v18, v72
  v_fma_f32 v73, v65, v19, v73
  v_fma_f32 v74, v66, v20, v74
  v_fma_f32 v75, v67, v21, v75
  v_cvt_pk_bf16_f32 v68, v72, v73
  v_cvt_pk_bf16_f32 v69, v74, v75
  buffer_store_dwordx2 v[68:69], v8, s[44:47], s24 offen
  s_waitcnt vmcnt(0)
  s_barrier
  s_xor_b32 s12, s12, 1
  s_add_u32 s29, s10, 3
  s_cmp_ge_u32 s10, 48
  s_cbranch_scc1 L_nsfsf
  s_add_u32 s29, s10, 2
  s_cmp_lt_u32 s29, 48
  s_cbranch_scc1 L_nsfsf
  s_add_u32 s29, s16, 48
L_nsfsf:
  s_mov_b32 s10, s29
  s_cmp_lt_u32 s10, 64
  s_cbranch_scc1 L_fs_loop
  s_waitcnt vmcnt(0)
  s_endpgm
L_role_c:
  s_mov_b32 s8, s14
  v_and_b32 v1, 63, v0
  v_lshrrev_b32 v2, 6, v0
  s_load_dwordx2 s[4:5], s[0:1], 112
  s_load_dwordx2 s[52:53], s[0:1], 104
  v_readfirstlane_b32 s9, v2
  s_waitcnt lgkmcnt(0)
  s_mov_b32 s6, 268435456
  s_mov_b32 s7, 0x20000
  s_mov_b32 s54, 256
  s_mov_b32 s55, 0x20000
  v_and_b32 v16, 15, v1
  v_lshrrev_b32 v17, 4, v1
  s_mov_b32 s12, 0xaaaaaaaa
  s_mov_b32 s13, 0xaaaaaaaa
  v_mov_b32 v18, 0x4444
  v_mov_b32 v19, 0xeeee
  v_cndmask_b32 v2, v18, v19, s[12:13]
  v_lshlrev_b32 v6, 4, v1
  s_lshl_b32 s56, s9, 11
  v_add_u32 v7, s56, v6
  s_lshl_b32 s56, s9, 15
  s_add_u32 s56, s56, 29696
  v_add_u32 v8, s56, v6
  v_lshrrev_b32 v18, 1, v16
  v_lshlrev_b32 v19, 1, v17
  v_mov_b32 v20, 0x3f803f80
  v_cmp_eq_u32 vcc, v18, v19
  s_nop 1
  v_cndmask_b32 v4, 0, v20, vcc
  v_add_u32 v19, 1, v19
  v_cmp_eq_u32 vcc, v18, v19
  s_nop 1
  v_cndmask_b32 v5, 0, v20, vcc
  v_and_b32 v18, 7, v16
  v_mov_b32 v19, 0x3f80
  v_cmp_eq_u32 vcc, 0, v18
  s_nop 1
  v_cndmask_b32 v24, 0, v19, vcc
  v_mov_b32 v19, 0x3f800000
  v_cmp_eq_u32 vcc, 1, v18
  s_nop 1
  v_cndmask_b32 v24, v24, v19, vcc
  v_mov_b32 v19, 0x3f80
  v_cmp_eq_u32 vcc, 2, v18
  s_nop 1
  v_cndmask_b32 v25, 0, v19, vcc
  v_mov_b32 v19, 0x3f800000
  v_cmp_eq_u32 vcc, 3, v18
  s_nop 1
  v_cndmask_b32 v25, v25, v19, vcc
  v_mov_b32 v19, 0x3f80
  v_cmp_eq_u32 vcc, 4, v18
  s_nop 1
  v_cndmask_b32 v26, 0, v19, vcc
  v_mov_b32 v19, 0x3f800000
  v_cmp_eq_u32 vcc, 5, v18
  s_nop 1
  v_cndmask_b32 v26, v26, v19, vcc
  v_mov_b32 v19, 0x3f80
  v_cmp_eq_u32 vcc, 6, v18
  s_nop 1
  v_cndmask_b32 v27, 0, v19, vcc
  v_mov_b32 v19, 0x3f800000
  v_cmp_eq_u32 vcc, 7, v18
  s_nop 1
  v_cndmask_b32 v27, v27, v19, vcc
  v_add_u32 v18, 20480, v6
  ds_write_b128 v18, v[24:27]
  v_mov_b32 v28, 0
  v_mov_b32 v32, 0x3f803f80
  v_mov_b32 v29, 0
  v_mov_b32 v33, 0x3f803f80
  v_mov_b32 v30, 0
  v_mov_b32 v34, 0x3f803f80
  v_mov_b32 v31, 0
  v_mov_b32 v35, 0x3f803f80
  v_mov_b32 v40, 0
  s_lshl_b32 s56, s9, 2
  v_add_u32 v14, s56, v6
  ds_write_b128 v6, v[32:35] offset:16384
  ds_write_b128 v6, v[28:31] offset:9216
  v_mov_b32 v36, -1
  v_mov_b32 v37, -1
  v_mov_b32 v38, -1
  v_mov_b32 v39, -1
  v_lshlrev_b32 v9, 6, v16
  v_lshlrev_b32 v18, 4, v17
  v_add_u32 v9, v9, v18
  s_lshl_b32 s56, s8, 19
  s_lshl_b32 s57, s9, 11
  s_add_u32 s56, s56, s57
  v_add_u32 v9, s56, v9
  v_and_b32 v18, 1, v17
  v_lshlrev_b32 v18, 8, v18
  v_lshrrev_b32 v19, 1, v17
  v_lshlrev_b32 v19, 6, v19
  v_add_u32 v18, v18, v19
  v_and_b32 v19, 1, v16
  v_lshlrev_b32 v19, 5, v19
  v_add_u32 v18, v18, v19
  v_bfe_u32 v19, v16, 1, 1
  v_lshlrev_b32 v19, 4, v19
  v_add_u32 v18, v18, v19
  v_bfe_u32 v19, v16, 2, 1
  v_lshlrev_b32 v19, 3, v19
  v_add_u32 v18, v18, v19
  s_lshr_b32 s56, s8, 2
  s_lshl_b32 s56, s56, 10
  s_bfe_u32 s57, s8, 0x10001
  s_lshl_b32 s57, s57, 9
  s_add_u32 s56, s56, s57
  s_and_b32 s57, s8, 1
  s_lshl_b32 s57, s57, 7
  s_add_u32 s56, s56, s57
  v_add_u32 v11, s56, v18
  v_lshrrev_b32 v18, 1, v17
  v_lshlrev_b32 v18, 13, v18
  v_and_b32 v19, 1, v17
  v_lshlrev_b32 v19, 7, v19
  v_add_u32 v18, v18, v19
  v_lshlrev_b32 v19, 3, v16
  v_add_u32 v3, v18, v19
  v_lshrrev_b32 v18, 1, v16
  v_lshlrev_b32 v18, 6, v18
  v_lshlrev_b32 v19, 4, v17
  v_add_u32 v18, v18, v19
  s_lshl_b32 s56, s8, 11
  v_add_u32 v12, s56, v18
  v_lshlrev_b32 v18, 3, v16
  v_lshlrev_b32 v19, 9, v17
  v_add_u32 v18, v18, v19
  s_lshl_b32 s56, s8, 11
  v_add_u32 v13, s56, v18
  v_lshrrev_b32 v18, 1, v17
  v_lshlrev_b32 v18, 8, v18
  v_lshlrev_b32 v19, 4, v16
  v_add_u32 v18, v18, v19
  v_and_b32 v19, 1, v17
  v_lshlrev_b32 v19, 3, v19
  v_add_u32 v18, v18, v19
  s_lshr_b32 s56, s9, 1
  s_lshl_b32 s56, s56, 10
  s_and_b32 s57, s9, 1
  s_lshl_b32 s57, s57, 9
  s_add_u32 s56, s56, s57
  s_add_u32 s56, s56, 18432
  v_add_u32 v15, s56, v18
  s_mov_b32 s38, 0x3e0293ee
  s_lshl_b32 s56, s8, 8
  s_lshl_b32 s57, s9, 16
  s_add_u32 s18, s56, s57
  s_add_u32 s19, s18, 32768
  s_lshl_b32 s20, s8, 13
  s_lshl_b32 s57, s9, 11
  s_add_u32 s21, s57, s20
  s_mov_b32 s35, 0
  s_lshl_b32 s62, s35, 18
  s_add_u32 s62, s62, 262144
  s_add_u32 s16, s62, s18
  s_add_u32 s17, s16, 16384
  s_add_u32 s22, s16, 32768
  s_add_u32 s23, s16, 49152
  s_add_u32 s24, s62, s20
  s_add_u32 s25, s24, 4096
  s_add_u32 s61, s35, 2
  s_cmp_ge_u32 s61, 3
  s_cselect_b32 s60, 3, 0
  s_sub_u32 s61, s61, s60
  s_lshl_b32 s61, s61, 18
  s_add_u32 s61, s61, 262144
  s_add_u32 s33, s61, s21
  s_mov_b32 s26, 139264
  s_mov_b32 s34, 131072
  s_lshl_b32 s56, s9, 11
  s_add_u32 s27, s56, 131072
  s_mov_b32 s28, 8396800
  s_mov_b32 s30, 25165824
  s_mov_b32 s31, 58720256
  s_mov_b32 s32, 62914560
  s_lshl_b32 s42, s9, 9
  s_lshl_b32 s43, s9, 7
  s_add_u32 s44, s31, s42
  s_add_u32 s45, s32, s43
  s_mov_b32 s10, 0
  v_mov_b32 v24, -1
  v_mov_b32 v25, -1
  v_mov_b32 v26, -1
  v_mov_b32 v27, -1
  s_lshl_b32 s56, s8, 13
  s_lshl_b32 s57, s9, 11
  s_add_u32 s56, s56, s57
  s_add_u32 s56, s56, 262144
  s_add_u32 s57, s56, 262144
  s_add_u32 s58, s57, 262144
  buffer_store_dwordx4 v[24:27], v6, s[4:7], s56 offen offset:0 sc1
  buffer_store_dwordx4 v[24:27], v6, s[4:7], s56 offen offset:1024 sc1
  buffer_store_dwordx4 v[24:27], v6, s[4:7], s57 offen offset:0 sc1
  buffer_store_dwordx4 v[24:27], v6, s[4:7], s57 offen offset:1024 sc1
  buffer_store_dwordx4 v[24:27], v6, s[4:7], s58 offen offset:0 sc1
  buffer_store_dwordx4 v[24:27], v6, s[4:7], s58 offen offset:1024 sc1
  s_mov_b32 s56, 131072
  s_mov_b32 s57, 139264
  buffer_store_dwordx2 v[24:25], v11, s[4:7], s56 offen sc1
  buffer_store_dwordx2 v[24:25], v11, s[4:7], s57 offen sc1
  s_load_dwordx2 s[80:81], s[0:1], 8
  s_waitcnt lgkmcnt(0)
  s_mov_b32 s82, 8192
  s_mov_b32 s83, 0x20000
  v_and_b32 v16, 15, v1
  v_lshrrev_b32 v17, 4, v1
  v_lshrrev_b32 v20, 1, v16
  v_and_b32 v21, 1, v16
  v_lshlrev_b32 v19, 10, v20
  v_lshlrev_b32 v18, 1, v21
  v_add_u32 v19, v19, v18
  v_and_b32 v18, 1, v17
  v_lshlrev_b32 v18, 7, v18
  v_add_u32 v19, v19, v18
  v_lshrrev_b32 v18, 1, v17
  v_lshlrev_b32 v18, 2, v18
  v_add_u32 v19, v19, v18
  s_lshl_b32 s56, s9, 8
  v_add_u32 v19, s56, v19
  buffer_load_ushort a240, v19, s[80:83], 0 offen offset:0
  buffer_load_ushort a241, v19, s[80:83], 0 offen offset:32
  buffer_load_ushort a242, v19, s[80:83], 0 offen offset:64
  buffer_load_ushort a243, v19, s[80:83], 0 offen offset:96
  buffer_load_ushort a244, v19, s[80:83], 0 offen offset:16
  buffer_load_ushort a245, v19, s[80:83], 0 offen offset:48
  buffer_load_ushort a246, v19, s[80:83], 0 offen offset:80
  buffer_load_ushort a247, v19, s[80:83], 0 offen offset:112
  buffer_load_ushort a248, v19, s[80:83], 0 offen offset:8
  buffer_load_ushort a249, v19, s[80:83], 0 offen offset:40
  buffer_load_ushort a250, v19, s[80:83], 0 offen offset:72
  buffer_load_ushort a251, v19, s[80:83], 0 offen offset:104
  buffer_load_ushort a252, v19, s[80:83], 0 offen offset:24
  buffer_load_ushort a253, v19, s[80:83], 0 offen offset:56
  buffer_load_ushort a254, v19, s[80:83], 0 offen offset:88
  buffer_load_ushort a255, v19, s[80:83], 0 offen offset:120
  v_and_b32 v16, 15, v1
  v_lshrrev_b32 v17, 4, v1
  v_and_b32 v19, 1, v17
  v_lshlrev_b32 v19, 3, v19
  v_lshrrev_b32 v18, 1, v17
  v_lshlrev_b32 v18, 6, v18
  v_add_u32 v18, v18, v19
  v_lshlrev_b32 v18, 13, v18
  v_lshlrev_b32 v19, 2, v16
  v_add_u32 v18, v18, v19
  s_lshl_b32 s56, s9, 6
  s_lshl_b32 s57, s8, 8
  s_add_u32 s56, s56, s57
  v_add_u32 v18, s56, v18
  v_lshlrev_b32 v20, 13, v17
  v_lshlrev_b32 v19, 4, v16
  v_add_u32 v20, v20, v19
  s_lshl_b32 s56, s9, 8
  s_lshl_b32 s57, s8, 17
  s_add_u32 s56, s56, s57
  v_add_u32 v20, s56, v20
  s_mov_b32 s70, 0x05040100
  s_mov_b32 s71, 0x07060302
  s_xor_b32 s72, s9, 0
  s_lshl_b32 s72, s72, 20
  s_xor_b32 s73, s9, 1
  s_lshl_b32 s73, s73, 20
  s_xor_b32 s74, s9, 2
  s_lshl_b32 s74, s74, 20
  s_xor_b32 s75, s9, 3
  s_lshl_b32 s75, s75, 20
  s_mov_b32 s50, 4194304
  s_mov_b32 s51, 0x20000
  s_load_dwordx2 s[48:49], s[0:1], 40
  s_waitcnt lgkmcnt(0)
  s_mov_b32 s58, 0
  buffer_load_dwordx4 v[24:27], v20, s[48:51], s58 offen
  s_mov_b32 s59, 2048
  buffer_load_dwordx4 v[28:31], v20, s[48:51], s59 offen
  s_mov_b32 s60, 4096
  buffer_load_dwordx4 v[32:35], v20, s[48:51], s60 offen
  s_mov_b32 s61, 6144
  buffer_load_dwordx4 v[36:39], v20, s[48:51], s61 offen
  s_mov_b32 s58, 1024
  buffer_load_dwordx4 v[40:43], v20, s[48:51], s58 offen
  s_mov_b32 s59, 3072
  buffer_load_dwordx4 v[44:47], v20, s[48:51], s59 offen
  s_mov_b32 s60, 5120
  buffer_load_dwordx4 v[48:51], v20, s[48:51], s60 offen
  s_mov_b32 s61, 7168
  buffer_load_dwordx4 v[52:55], v20, s[48:51], s61 offen
  s_mov_b32 s58, 32768
  buffer_load_dwordx4 v[56:59], v20, s[48:51], s58 offen
  s_mov_b32 s59, 34816
  buffer_load_dwordx4 v[60:63], v20, s[48:51], s59 offen
  s_mov_b32 s60, 36864
  buffer_load_dwordx4 v[64:67], v20, s[48:51], s60 offen
  s_mov_b32 s61, 38912
  buffer_load_dwordx4 v[68:71], v20, s[48:51], s61 offen
  s_mov_b32 s58, 33792
  buffer_load_dwordx4 v[72:75], v20, s[48:51], s58 offen
  s_mov_b32 s59, 35840
  buffer_load_dwordx4 v[76:79], v20, s[48:51], s59 offen
  s_mov_b32 s60, 37888
  buffer_load_dwordx4 v[80:83], v20, s[48:51], s60 offen
  s_mov_b32 s61, 39936
  buffer_load_dwordx4 v[84:87], v20, s[48:51], s61 offen
  s_mov_b32 s58, 65536
  buffer_load_dwordx4 v[88:91], v20, s[48:51], s58 offen
  s_mov_b32 s59, 67584
  buffer_load_dwordx4 v[92:95], v20, s[48:51], s59 offen
  s_mov_b32 s60, 69632
  buffer_load_dwordx4 v[96:99], v20, s[48:51], s60 offen
  s_mov_b32 s61, 71680
  buffer_load_dwordx4 v[100:103], v20, s[48:51], s61 offen
  s_mov_b32 s58, 66560
  buffer_load_dwordx4 v[104:107], v20, s[48:51], s58 offen
  s_mov_b32 s59, 68608
  buffer_load_dwordx4 v[108:111], v20, s[48:51], s59 offen
  s_mov_b32 s60, 70656
  buffer_load_dwordx4 v[112:115], v20, s[48:51], s60 offen
  s_mov_b32 s61, 72704
  buffer_load_dwordx4 v[116:119], v20, s[48:51], s61 offen
  s_waitcnt vmcnt(22)
  v_perm_b32 v160, v28, v24, s70
  s_waitcnt vmcnt(20)
  v_perm_b32 v161, v36, v32, s70
  s_waitcnt vmcnt(18)
  v_perm_b32 v162, v44, v40, s70
  s_waitcnt vmcnt(16)
  v_perm_b32 v163, v52, v48, s70
  v_perm_b32 v176, v28, v24, s71
  v_perm_b32 v177, v36, v32, s71
  v_perm_b32 v178, v44, v40, s71
  v_perm_b32 v179, v52, v48, s71
  v_perm_b32 v192, v29, v25, s70
  v_perm_b32 v193, v37, v33, s70
  v_perm_b32 v194, v45, v41, s70
  v_perm_b32 v195, v53, v49, s70
  v_perm_b32 v208, v29, v25, s71
  v_perm_b32 v209, v37, v33, s71
  v_perm_b32 v210, v45, v41, s71
  v_perm_b32 v211, v53, v49, s71
  v_perm_b32 v224, v30, v26, s70
  v_perm_b32 v225, v38, v34, s70
  v_perm_b32 v226, v46, v42, s70
  v_perm_b32 v227, v54, v50, s70
  v_perm_b32 v240, v30, v26, s71
  v_perm_b32 v241, v38, v34, s71
  v_perm_b32 v242, v46, v42, s71
  v_perm_b32 v243, v54, v50, s71
  v_perm_b32 v124, v31, v27, s70
  v_perm_b32 v125, v39, v35, s70
  v_perm_b32 v126, v47, v43, s70
  v_perm_b32 v127, v55, v51, s70
  ds_write_b128 v8, v[124:127] offset:24576
  v_perm_b32 v124, v31, v27, s71
  v_perm_b32 v125, v39, v35, s71
  v_perm_b32 v126, v47, v43, s71
  v_perm_b32 v127, v55, v51, s71
  ds_write_b128 v8, v[124:127] offset:28672
  s_mov_b32 s58, 98304
  buffer_load_dwordx4 v[24:27], v20, s[48:51], s58 offen
  s_mov_b32 s59, 100352
  buffer_load_dwordx4 v[28:31], v20, s[48:51], s59 offen
  s_mov_b32 s60, 102400
  buffer_load_dwordx4 v[32:35], v20, s[48:51], s60 offen
  s_mov_b32 s61, 104448
  buffer_load_dwordx4 v[36:39], v20, s[48:51], s61 offen
  s_mov_b32 s58, 99328
  buffer_load_dwordx4 v[40:43], v20, s[48:51], s58 offen
  s_mov_b32 s59, 101376
  buffer_load_dwordx4 v[44:47], v20, s[48:51], s59 offen
  s_mov_b32 s60, 103424
  buffer_load_dwordx4 v[48:51], v20, s[48:51], s60 offen
  s_mov_b32 s61, 105472
  buffer_load_dwordx4 v[52:55], v20, s[48:51], s61 offen
  v_accvgpr_read_b32 v120, a240
  v_accvgpr_read_b32 v121, a241
  v_lshl_or_b32 v124, v121, 16, v120
  v_accvgpr_read_b32 v120, a242
  v_accvgpr_read_b32 v121, a243
  v_lshl_or_b32 v125, v121, 16, v120
  v_accvgpr_read_b32 v120, a244
  v_accvgpr_read_b32 v121, a245
  v_lshl_or_b32 v126, v121, 16, v120
  v_accvgpr_read_b32 v120, a246
  v_accvgpr_read_b32 v121, a247
  v_lshl_or_b32 v127, v121, 16, v120
  ds_write_b128 v7, v[124:127] offset:0
  v_accvgpr_read_b32 v120, a248
  v_accvgpr_read_b32 v121, a249
  v_lshl_or_b32 v124, v121, 16, v120
  v_accvgpr_read_b32 v120, a250
  v_accvgpr_read_b32 v121, a251
  v_lshl_or_b32 v125, v121, 16, v120
  v_accvgpr_read_b32 v120, a252
  v_accvgpr_read_b32 v121, a253
  v_lshl_or_b32 v126, v121, 16, v120
  v_accvgpr_read_b32 v120, a254
  v_accvgpr_read_b32 v121, a255
  v_lshl_or_b32 v127, v121, 16, v120
  ds_write_b128 v7, v[124:127] offset:1024
  s_barrier
  s_cmp_lg_u32 s9, 0
  s_cbranch_scc1 L_cclr43d
  v_mov_b32 v123, 20
  s_mov_b32 s46, 0
L_cclr43:
    buffer_load_dword v122, v123, s[52:55], 0 offen sc1
    s_waitcnt vmcnt(0)
  v_readfirstlane_b32 s63, v122
  s_nop 0
  s_cmp_ge_u32 s63, 16
  s_nop 1
  s_cbranch_scc1 L_cclr43d
  s_sleep 6
  s_add_u32 s46, s46, 1
  s_cmp_lt_u32 s46, 400000
  s_cbranch_scc1 L_cclr43
  s_branch L_bail
L_cclr43d:
  s_barrier
  s_cmp_lg_u32 s9, 0
  s_cbranch_scc1 L_c_arr
  v_mov_b32 v120, 1
  v_mov_b32 v121, 45440
  s_mov_b64 exec, 1
    buffer_atomic_add v120, v121, s[4:7], 0 offen sc1
  s_mov_b64 exec, -1
L_c_arr:
  s_waitcnt vmcnt(22)
  v_perm_b32 v164, v60, v56, s70
  s_waitcnt vmcnt(20)
  v_perm_b32 v165, v68, v64, s70
  s_waitcnt vmcnt(18)
  v_perm_b32 v166, v76, v72, s70
  s_waitcnt vmcnt(16)
  v_perm_b32 v167, v84, v80, s70
  v_perm_b32 v180, v60, v56, s71
  v_perm_b32 v181, v68, v64, s71
  v_perm_b32 v182, v76, v72, s71
  v_perm_b32 v183, v84, v80, s71
  v_perm_b32 v196, v61, v57, s70
  v_perm_b32 v197, v69, v65, s70
  v_perm_b32 v198, v77, v73, s70
  v_perm_b32 v199, v85, v81, s70
  v_perm_b32 v212, v61, v57, s71
  v_perm_b32 v213, v69, v65, s71
  v_perm_b32 v214, v77, v73, s71
  v_perm_b32 v215, v85, v81, s71
  v_perm_b32 v228, v62, v58, s70
  v_perm_b32 v229, v70, v66, s70
  v_perm_b32 v230, v78, v74, s70
  v_perm_b32 v231, v86, v82, s70
  v_perm_b32 v244, v62, v58, s71
  v_perm_b32 v245, v70, v66, s71
  v_perm_b32 v246, v78, v74, s71
  v_perm_b32 v247, v86, v82, s71
  v_perm_b32 v124, v63, v59, s70
  v_perm_b32 v125, v71, v67, s70
  v_perm_b32 v126, v79, v75, s70
  v_perm_b32 v127, v87, v83, s70
  ds_write_b128 v8, v[124:127] offset:25600
  v_perm_b32 v124, v63, v59, s71
  v_perm_b32 v125, v71, v67, s71
  v_perm_b32 v126, v79, v75, s71
  v_perm_b32 v127, v87, v83, s71
  ds_write_b128 v8, v[124:127] offset:29696
  s_waitcnt vmcnt(14)
  v_perm_b32 v168, v92, v88, s70
  s_waitcnt vmcnt(12)
  v_perm_b32 v169, v100, v96, s70
  s_waitcnt vmcnt(10)
  v_perm_b32 v170, v108, v104, s70
  s_waitcnt vmcnt(8)
  v_perm_b32 v171, v116, v112, s70
  v_perm_b32 v184, v92, v88, s71
  v_perm_b32 v185, v100, v96, s71
  v_perm_b32 v186, v108, v104, s71
  v_perm_b32 v187, v116, v112, s71
  v_perm_b32 v200, v93, v89, s70
  v_perm_b32 v201, v101, v97, s70
  v_perm_b32 v202, v109, v105, s70
  v_perm_b32 v203, v117, v113, s70
  v_perm_b32 v216, v93, v89, s71
  v_perm_b32 v217, v101, v97, s71
  v_perm_b32 v218, v109, v105, s71
  v_perm_b32 v219, v117, v113, s71
  v_perm_b32 v232, v94, v90, s70
  v_perm_b32 v233, v102, v98, s70
  v_perm_b32 v234, v110, v106, s70
  v_perm_b32 v235, v118, v114, s70
  v_perm_b32 v248, v94, v90, s71
  v_perm_b32 v249, v102, v98, s71
  v_perm_b32 v250, v110, v106, s71
  v_perm_b32 v251, v118, v114, s71
  v_perm_b32 v124, v95, v91, s70
  v_perm_b32 v125, v103, v99, s70
  v_perm_b32 v126, v111, v107, s70
  v_perm_b32 v127, v119, v115, s70
  ds_write_b128 v8, v[124:127] offset:26624
  v_perm_b32 v124, v95, v91, s71
  v_perm_b32 v125, v103, v99, s71
  v_perm_b32 v126, v111, v107, s71
  v_perm_b32 v127, v119, v115, s71
  ds_write_b128 v8, v[124:127] offset:30720
  s_waitcnt vmcnt(6)
  v_perm_b32 v172, v28, v24, s70
  s_waitcnt vmcnt(4)
  v_perm_b32 v173, v36, v32, s70
  s_waitcnt vmcnt(2)
  v_perm_b32 v174, v44, v40, s70
  s_waitcnt vmcnt(0)
  v_perm_b32 v175, v52, v48, s70
  v_perm_b32 v188, v28, v24, s71
  v_perm_b32 v189, v36, v32, s71
  v_perm_b32 v190, v44, v40, s71
  v_perm_b32 v191, v52, v48, s71
  v_perm_b32 v204, v29, v25, s70
  v_perm_b32 v205, v37, v33, s70
  v_perm_b32 v206, v45, v41, s70
  v_perm_b32 v207, v53, v49, s70
  v_perm_b32 v220, v29, v25, s71
  v_perm_b32 v221, v37, v33, s71
  v_perm_b32 v222, v45, v41, s71
  v_perm_b32 v223, v53, v49, s71
  v_perm_b32 v236, v30, v26, s70
  v_perm_b32 v237, v38, v34, s70
  v_perm_b32 v238, v46, v42, s70
  v_perm_b32 v239, v54, v50, s70
  v_perm_b32 v252, v30, v26, s71
  v_perm_b32 v253, v38, v34, s71
  v_perm_b32 v254, v46, v42, s71
  v_perm_b32 v255, v54, v50, s71
  v_perm_b32 v124, v31, v27, s70
  v_perm_b32 v125, v39, v35, s70
  v_perm_b32 v126, v47, v43, s70
  v_perm_b32 v127, v55, v51, s70
  ds_write_b128 v8, v[124:127] offset:27648
  v_perm_b32 v124, v31, v27, s71
  v_perm_b32 v125, v39, v35, s71
  v_perm_b32 v126, v47, v43, s71
  v_perm_b32 v127, v55, v51, s71
  ds_write_b128 v8, v[124:127] offset:31744
  s_load_dwordx2 s[48:49], s[0:1], 16
  s_waitcnt lgkmcnt(0)
  s_add_u32 s58, s72, 0
  buffer_load_dword v24, v18, s[48:51], s58 offen
  s_add_u32 s59, s72, 131072
  buffer_load_dword v25, v18, s[48:51], s59 offen
  s_add_u32 s60, s72, 8192
  buffer_load_dword v26, v18, s[48:51], s60 offen
  s_add_u32 s61, s72, 139264
  buffer_load_dword v27, v18, s[48:51], s61 offen
  s_add_u32 s58, s72, 262144
  buffer_load_dword v28, v18, s[48:51], s58 offen
  s_add_u32 s59, s72, 393216
  buffer_load_dword v29, v18, s[48:51], s59 offen
  s_add_u32 s60, s72, 270336
  buffer_load_dword v30, v18, s[48:51], s60 offen
  s_add_u32 s61, s72, 401408
  buffer_load_dword v31, v18, s[48:51], s61 offen
  s_add_u32 s58, s72, 16384
  buffer_load_dword v32, v18, s[48:51], s58 offen
  s_add_u32 s59, s72, 147456
  buffer_load_dword v33, v18, s[48:51], s59 offen
  s_add_u32 s60, s72, 24576
  buffer_load_dword v34, v18, s[48:51], s60 offen
  s_add_u32 s61, s72, 155648
  buffer_load_dword v35, v18, s[48:51], s61 offen
  s_add_u32 s58, s72, 278528
  buffer_load_dword v36, v18, s[48:51], s58 offen
  s_add_u32 s59, s72, 409600
  buffer_load_dword v37, v18, s[48:51], s59 offen
  s_add_u32 s60, s72, 286720
  buffer_load_dword v38, v18, s[48:51], s60 offen
  s_add_u32 s61, s72, 417792
  buffer_load_dword v39, v18, s[48:51], s61 offen
  s_add_u32 s58, s72, 32768
  buffer_load_dword v40, v18, s[48:51], s58 offen
  s_add_u32 s59, s72, 163840
  buffer_load_dword v41, v18, s[48:51], s59 offen
  s_add_u32 s60, s72, 40960
  buffer_load_dword v42, v18, s[48:51], s60 offen
  s_add_u32 s61, s72, 172032
  buffer_load_dword v43, v18, s[48:51], s61 offen
  s_add_u32 s58, s72, 294912
  buffer_load_dword v44, v18, s[48:51], s58 offen
  s_add_u32 s59, s72, 425984
  buffer_load_dword v45, v18, s[48:51], s59 offen
  s_add_u32 s60, s72, 303104
  buffer_load_dword v46, v18, s[48:51], s60 offen
  s_add_u32 s61, s72, 434176
  buffer_load_dword v47, v18, s[48:51], s61 offen
  s_add_u32 s58, s72, 49152
  buffer_load_dword v48, v18, s[48:51], s58 offen
  s_add_u32 s59, s72, 180224
  buffer_load_dword v49, v18, s[48:51], s59 offen
  s_add_u32 s60, s72, 57344
  buffer_load_dword v50, v18, s[48:51], s60 offen
  s_add_u32 s61, s72, 188416
  buffer_load_dword v51, v18, s[48:51], s61 offen
  s_add_u32 s58, s72, 311296
  buffer_load_dword v52, v18, s[48:51], s58 offen
  s_add_u32 s59, s72, 442368
  buffer_load_dword v53, v18, s[48:51], s59 offen
  s_add_u32 s60, s72, 319488
  buffer_load_dword v54, v18, s[48:51], s60 offen
  s_add_u32 s61, s72, 450560
  buffer_load_dword v55, v18, s[48:51], s61 offen
  s_add_u32 s58, s73, 0
  buffer_load_dword v56, v18, s[48:51], s58 offen
  s_add_u32 s59, s73, 131072
  buffer_load_dword v57, v18, s[48:51], s59 offen
  s_add_u32 s60, s73, 8192
  buffer_load_dword v58, v18, s[48:51], s60 offen
  s_add_u32 s61, s73, 139264
  buffer_load_dword v59, v18, s[48:51], s61 offen
  s_add_u32 s58, s73, 262144
  buffer_load_dword v60, v18, s[48:51], s58 offen
  s_add_u32 s59, s73, 393216
  buffer_load_dword v61, v18, s[48:51], s59 offen
  s_add_u32 s60, s73, 270336
  buffer_load_dword v62, v18, s[48:51], s60 offen
  s_add_u32 s61, s73, 401408
  buffer_load_dword v63, v18, s[48:51], s61 offen
  s_add_u32 s58, s73, 16384
  buffer_load_dword v64, v18, s[48:51], s58 offen
  s_add_u32 s59, s73, 147456
  buffer_load_dword v65, v18, s[48:51], s59 offen
  s_add_u32 s60, s73, 24576
  buffer_load_dword v66, v18, s[48:51], s60 offen
  s_add_u32 s61, s73, 155648
  buffer_load_dword v67, v18, s[48:51], s61 offen
  s_add_u32 s58, s73, 278528
  buffer_load_dword v68, v18, s[48:51], s58 offen
  s_add_u32 s59, s73, 409600
  buffer_load_dword v69, v18, s[48:51], s59 offen
  s_add_u32 s60, s73, 286720
  buffer_load_dword v70, v18, s[48:51], s60 offen
  s_add_u32 s61, s73, 417792
  buffer_load_dword v71, v18, s[48:51], s61 offen
  s_add_u32 s58, s73, 32768
  buffer_load_dword v72, v18, s[48:51], s58 offen
  s_add_u32 s59, s73, 163840
  buffer_load_dword v73, v18, s[48:51], s59 offen
  s_add_u32 s60, s73, 40960
  buffer_load_dword v74, v18, s[48:51], s60 offen
  s_add_u32 s61, s73, 172032
  buffer_load_dword v75, v18, s[48:51], s61 offen
  s_add_u32 s58, s73, 294912
  buffer_load_dword v76, v18, s[48:51], s58 offen
  s_add_u32 s59, s73, 425984
  buffer_load_dword v77, v18, s[48:51], s59 offen
  s_add_u32 s60, s73, 303104
  buffer_load_dword v78, v18, s[48:51], s60 offen
  s_add_u32 s61, s73, 434176
  buffer_load_dword v79, v18, s[48:51], s61 offen
  s_add_u32 s58, s73, 49152
  buffer_load_dword v80, v18, s[48:51], s58 offen
  s_add_u32 s59, s73, 180224
  buffer_load_dword v81, v18, s[48:51], s59 offen
  s_add_u32 s60, s73, 57344
  buffer_load_dword v82, v18, s[48:51], s60 offen
  s_add_u32 s61, s73, 188416
  buffer_load_dword v83, v18, s[48:51], s61 offen
  s_add_u32 s58, s73, 311296
  buffer_load_dword v84, v18, s[48:51], s58 offen
  s_add_u32 s59, s73, 442368
  buffer_load_dword v85, v18, s[48:51], s59 offen
  s_add_u32 s60, s73, 319488
  buffer_load_dword v86, v18, s[48:51], s60 offen
  s_add_u32 s61, s73, 450560
  buffer_load_dword v87, v18, s[48:51], s61 offen
  s_waitcnt vmcnt(62)
  v_perm_b32 v124, v25, v24, s70
  s_waitcnt vmcnt(60)
  v_perm_b32 v125, v27, v26, s70
  s_waitcnt vmcnt(58)
  v_perm_b32 v126, v29, v28, s70
  s_waitcnt vmcnt(56)
  v_perm_b32 v127, v31, v30, s70
  ds_write_b128 v8, v[124:127] offset:0
  s_waitcnt vmcnt(54)
  v_perm_b32 v124, v33, v32, s70
  s_waitcnt vmcnt(52)
  v_perm_b32 v125, v35, v34, s70
  s_waitcnt vmcnt(50)
  v_perm_b32 v126, v37, v36, s70
  s_waitcnt vmcnt(48)
  v_perm_b32 v127, v39, v38, s70
  ds_write_b128 v8, v[124:127] offset:1024
  v_perm_b32 v124, v25, v24, s71
  v_perm_b32 v125, v27, v26, s71
  v_perm_b32 v126, v29, v28, s71
  v_perm_b32 v127, v31, v30, s71
  ds_write_b128 v8, v[124:127] offset:2048
  v_perm_b32 v124, v33, v32, s71
  v_perm_b32 v125, v35, v34, s71
  v_perm_b32 v126, v37, v36, s71
  v_perm_b32 v127, v39, v38, s71
  ds_write_b128 v8, v[124:127] offset:3072
  s_add_u32 s58, s74, 0
  buffer_load_dword v88, v18, s[48:51], s58 offen
  s_add_u32 s59, s74, 131072
  buffer_load_dword v89, v18, s[48:51], s59 offen
  s_add_u32 s60, s74, 8192
  buffer_load_dword v90, v18, s[48:51], s60 offen
  s_add_u32 s61, s74, 139264
  buffer_load_dword v91, v18, s[48:51], s61 offen
  s_add_u32 s58, s74, 262144
  buffer_load_dword v92, v18, s[48:51], s58 offen
  s_add_u32 s59, s74, 393216
  buffer_load_dword v93, v18, s[48:51], s59 offen
  s_add_u32 s60, s74, 270336
  buffer_load_dword v94, v18, s[48:51], s60 offen
  s_add_u32 s61, s74, 401408
  buffer_load_dword v95, v18, s[48:51], s61 offen
  s_add_u32 s58, s74, 16384
  buffer_load_dword v96, v18, s[48:51], s58 offen
  s_add_u32 s59, s74, 147456
  buffer_load_dword v97, v18, s[48:51], s59 offen
  s_add_u32 s60, s74, 24576
  buffer_load_dword v98, v18, s[48:51], s60 offen
  s_add_u32 s61, s74, 155648
  buffer_load_dword v99, v18, s[48:51], s61 offen
  s_add_u32 s58, s74, 278528
  buffer_load_dword v100, v18, s[48:51], s58 offen
  s_add_u32 s59, s74, 409600
  buffer_load_dword v101, v18, s[48:51], s59 offen
  s_add_u32 s60, s74, 286720
  buffer_load_dword v102, v18, s[48:51], s60 offen
  s_add_u32 s61, s74, 417792
  buffer_load_dword v103, v18, s[48:51], s61 offen
  s_waitcnt vmcnt(62)
  v_perm_b32 v124, v41, v40, s70
  s_waitcnt vmcnt(60)
  v_perm_b32 v125, v43, v42, s70
  s_waitcnt vmcnt(58)
  v_perm_b32 v126, v45, v44, s70
  s_waitcnt vmcnt(56)
  v_perm_b32 v127, v47, v46, s70
  ds_write_b128 v8, v[124:127] offset:4096
  s_waitcnt vmcnt(54)
  v_perm_b32 v124, v49, v48, s70
  s_waitcnt vmcnt(52)
  v_perm_b32 v125, v51, v50, s70
  s_waitcnt vmcnt(50)
  v_perm_b32 v126, v53, v52, s70
  s_waitcnt vmcnt(48)
  v_perm_b32 v127, v55, v54, s70
  ds_write_b128 v8, v[124:127] offset:5120
  v_perm_b32 v124, v41, v40, s71
  v_perm_b32 v125, v43, v42, s71
  v_perm_b32 v126, v45, v44, s71
  v_perm_b32 v127, v47, v46, s71
  ds_write_b128 v8, v[124:127] offset:6144
  v_perm_b32 v124, v49, v48, s71
  v_perm_b32 v125, v51, v50, s71
  v_perm_b32 v126, v53, v52, s71
  v_perm_b32 v127, v55, v54, s71
  ds_write_b128 v8, v[124:127] offset:7168
  s_add_u32 s58, s74, 32768
  buffer_load_dword v104, v18, s[48:51], s58 offen
  s_add_u32 s59, s74, 163840
  buffer_load_dword v105, v18, s[48:51], s59 offen
  s_add_u32 s60, s74, 40960
  buffer_load_dword v106, v18, s[48:51], s60 offen
  s_add_u32 s61, s74, 172032
  buffer_load_dword v107, v18, s[48:51], s61 offen
  s_add_u32 s58, s74, 294912
  buffer_load_dword v108, v18, s[48:51], s58 offen
  s_add_u32 s59, s74, 425984
  buffer_load_dword v109, v18, s[48:51], s59 offen
  s_add_u32 s60, s74, 303104
  buffer_load_dword v110, v18, s[48:51], s60 offen
  s_add_u32 s61, s74, 434176
  buffer_load_dword v111, v18, s[48:51], s61 offen
  s_add_u32 s58, s74, 49152
  buffer_load_dword v112, v18, s[48:51], s58 offen
  s_add_u32 s59, s74, 180224
  buffer_load_dword v113, v18, s[48:51], s59 offen
  s_add_u32 s60, s74, 57344
  buffer_load_dword v114, v18, s[48:51], s60 offen
  s_add_u32 s61, s74, 188416
  buffer_load_dword v115, v18, s[48:51], s61 offen
  s_add_u32 s58, s74, 311296
  buffer_load_dword v116, v18, s[48:51], s58 offen
  s_add_u32 s59, s74, 442368
  buffer_load_dword v117, v18, s[48:51], s59 offen
  s_add_u32 s60, s74, 319488
  buffer_load_dword v118, v18, s[48:51], s60 offen
  s_add_u32 s61, s74, 450560
  buffer_load_dword v119, v18, s[48:51], s61 offen
  s_waitcnt vmcnt(62)
  v_perm_b32 v120, v57, v56, s70
  v_accvgpr_write_b32 a0, v120
  s_waitcnt vmcnt(60)
  v_perm_b32 v121, v59, v58, s70
  v_accvgpr_write_b32 a1, v121
  s_waitcnt vmcnt(58)
  v_perm_b32 v122, v61, v60, s70
  v_accvgpr_write_b32 a2, v122
  s_waitcnt vmcnt(56)
  v_perm_b32 v123, v63, v62, s70
  v_accvgpr_write_b32 a3, v123
  s_waitcnt vmcnt(54)
  v_perm_b32 v120, v65, v64, s70
  v_accvgpr_write_b32 a4, v120
  s_waitcnt vmcnt(52)
  v_perm_b32 v121, v67, v66, s70
  v_accvgpr_write_b32 a5, v121
  s_waitcnt vmcnt(50)
  v_perm_b32 v122, v69, v68, s70
  v_accvgpr_write_b32 a6, v122
  s_waitcnt vmcnt(48)
  v_perm_b32 v123, v71, v70, s70
  v_accvgpr_write_b32 a7, v123
  v_perm_b32 v120, v57, v56, s71
  v_accvgpr_write_b32 a8, v120
  v_perm_b32 v121, v59, v58, s71
  v_accvgpr_write_b32 a9, v121
  v_perm_b32 v122, v61, v60, s71
  v_accvgpr_write_b32 a10, v122
  v_perm_b32 v123, v63, v62, s71
  v_accvgpr_write_b32 a11, v123
  v_perm_b32 v120, v65, v64, s71
  v_accvgpr_write_b32 a12, v120
  v_perm_b32 v121, v67, v66, s71
  v_accvgpr_write_b32 a13, v121
  v_perm_b32 v122, v69, v68, s71
  v_accvgpr_write_b32 a14, v122
  v_perm_b32 v123, v71, v70, s71
  v_accvgpr_write_b32 a15, v123
  s_add_u32 s58, s75, 0
  buffer_load_dword v24, v18, s[48:51], s58 offen
  s_add_u32 s59, s75, 131072
  buffer_load_dword v25, v18, s[48:51], s59 offen
  s_add_u32 s60, s75, 8192
  buffer_load_dword v26, v18, s[48:51], s60 offen
  s_add_u32 s61, s75, 139264
  buffer_load_dword v27, v18, s[48:51], s61 offen
  s_add_u32 s58, s75, 262144
  buffer_load_dword v28, v18, s[48:51], s58 offen
  s_add_u32 s59, s75, 393216
  buffer_load_dword v29, v18, s[48:51], s59 offen
  s_add_u32 s60, s75, 270336
  buffer_load_dword v30, v18, s[48:51], s60 offen
  s_add_u32 s61, s75, 401408
  buffer_load_dword v31, v18, s[48:51], s61 offen
  s_add_u32 s58, s75, 16384
  buffer_load_dword v32, v18, s[48:51], s58 offen
  s_add_u32 s59, s75, 147456
  buffer_load_dword v33, v18, s[48:51], s59 offen
  s_add_u32 s60, s75, 24576
  buffer_load_dword v34, v18, s[48:51], s60 offen
  s_add_u32 s61, s75, 155648
  buffer_load_dword v35, v18, s[48:51], s61 offen
  s_add_u32 s58, s75, 278528
  buffer_load_dword v36, v18, s[48:51], s58 offen
  s_add_u32 s59, s75, 409600
  buffer_load_dword v37, v18, s[48:51], s59 offen
  s_add_u32 s60, s75, 286720
  buffer_load_dword v38, v18, s[48:51], s60 offen
  s_add_u32 s61, s75, 417792
  buffer_load_dword v39, v18, s[48:51], s61 offen
  s_waitcnt vmcnt(62)
  v_perm_b32 v120, v73, v72, s70
  v_accvgpr_write_b32 a16, v120
  s_waitcnt vmcnt(60)
  v_perm_b32 v121, v75, v74, s70
  v_accvgpr_write_b32 a17, v121
  s_waitcnt vmcnt(58)
  v_perm_b32 v122, v77, v76, s70
  v_accvgpr_write_b32 a18, v122
  s_waitcnt vmcnt(56)
  v_perm_b32 v123, v79, v78, s70
  v_accvgpr_write_b32 a19, v123
  s_waitcnt vmcnt(54)
  v_perm_b32 v120, v81, v80, s70
  v_accvgpr_write_b32 a20, v120
  s_waitcnt vmcnt(52)
  v_perm_b32 v121, v83, v82, s70
  v_accvgpr_write_b32 a21, v121
  s_waitcnt vmcnt(50)
  v_perm_b32 v122, v85, v84, s70
  v_accvgpr_write_b32 a22, v122
  s_waitcnt vmcnt(48)
  v_perm_b32 v123, v87, v86, s70
  v_accvgpr_write_b32 a23, v123
  v_perm_b32 v120, v73, v72, s71
  v_accvgpr_write_b32 a24, v120
  v_perm_b32 v121, v75, v74, s71
  v_accvgpr_write_b32 a25, v121
  v_perm_b32 v122, v77, v76, s71
  v_accvgpr_write_b32 a26, v122
  v_perm_b32 v123, v79, v78, s71
  v_accvgpr_write_b32 a27, v123
  v_perm_b32 v120, v81, v80, s71
  v_accvgpr_write_b32 a28, v120
  v_perm_b32 v121, v83, v82, s71
  v_accvgpr_write_b32 a29, v121
  v_perm_b32 v122, v85, v84, s71
  v_accvgpr_write_b32 a30, v122
  v_perm_b32 v123, v87, v86, s71
  v_accvgpr_write_b32 a31, v123
  s_add_u32 s58, s75, 32768
  buffer_load_dword v40, v18, s[48:51], s58 offen
  s_add_u32 s59, s75, 163840
  buffer_load_dword v41, v18, s[48:51], s59 offen
  s_add_u32 s60, s75, 40960
  buffer_load_dword v42, v18, s[48:51], s60 offen
  s_add_u32 s61, s75, 172032
  buffer_load_dword v43, v18, s[48:51], s61 offen
  s_add_u32 s58, s75, 294912
  buffer_load_dword v44, v18, s[48:51], s58 offen
  s_add_u32 s59, s75, 425984
  buffer_load_dword v45, v18, s[48:51], s59 offen
  s_add_u32 s60, s75, 303104
  buffer_load_dword v46, v18, s[48:51], s60 offen
  s_add_u32 s61, s75, 434176
  buffer_load_dword v47, v18, s[48:51], s61 offen
  s_add_u32 s58, s75, 49152
  buffer_load_dword v48, v18, s[48:51], s58 offen
  s_add_u32 s59, s75, 180224
  buffer_load_dword v49, v18, s[48:51], s59 offen
  s_add_u32 s60, s75, 57344
  buffer_load_dword v50, v18, s[48:51], s60 offen
  s_add_u32 s61, s75, 188416
  buffer_load_dword v51, v18, s[48:51], s61 offen
  s_add_u32 s58, s75, 311296
  buffer_load_dword v52, v18, s[48:51], s58 offen
  s_add_u32 s59, s75, 442368
  buffer_load_dword v53, v18, s[48:51], s59 offen
  s_add_u32 s60, s75, 319488
  buffer_load_dword v54, v18, s[48:51], s60 offen
  s_add_u32 s61, s75, 450560
  buffer_load_dword v55, v18, s[48:51], s61 offen
  s_waitcnt vmcnt(62)
  v_perm_b32 v120, v89, v88, s70
  v_accvgpr_write_b32 a32, v120
  s_waitcnt vmcnt(60)
  v_perm_b32 v121, v91, v90, s70
  v_accvgpr_write_b32 a33, v121
  s_waitcnt vmcnt(58)
  v_perm_b32 v122, v93, v92, s70
  v_accvgpr_write_b32 a34, v122
  s_waitcnt vmcnt(56)
  v_perm_b32 v123, v95, v94, s70
  v_accvgpr_write_b32 a35, v123
  s_waitcnt vmcnt(54)
  v_perm_b32 v120, v97, v96, s70
  v_accvgpr_write_b32 a36, v120
  s_waitcnt vmcnt(52)
  v_perm_b32 v121, v99, v98, s70
  v_accvgpr_write_b32 a37, v121
  s_waitcnt vmcnt(50)
  v_perm_b32 v122, v101, v100, s70
  v_accvgpr_write_b32 a38, v122
  s_waitcnt vmcnt(48)
  v_perm_b32 v123, v103, v102, s70
  v_accvgpr_write_b32 a39, v123
  v_perm_b32 v120, v89, v88, s71
  v_accvgpr_write_b32 a40, v120
  v_perm_b32 v121, v91, v90, s71
  v_accvgpr_write_b32 a41, v121
  v_perm_b32 v122, v93, v92, s71
  v_accvgpr_write_b32 a42, v122
  v_perm_b32 v123, v95, v94, s71
  v_accvgpr_write_b32 a43, v123
  v_perm_b32 v120, v97, v96, s71
  v_accvgpr_write_b32 a44, v120
  v_perm_b32 v121, v99, v98, s71
  v_accvgpr_write_b32 a45, v121
  v_perm_b32 v122, v101, v100, s71
  v_accvgpr_write_b32 a46, v122
  v_perm_b32 v123, v103, v102, s71
  v_accvgpr_write_b32 a47, v123
  s_load_dwordx2 s[48:49], s[0:1], 24
  s_waitcnt lgkmcnt(0)
  s_add_u32 s58, s72, 0
  buffer_load_dword v56, v18, s[48:51], s58 offen
  s_add_u32 s59, s72, 131072
  buffer_load_dword v57, v18, s[48:51], s59 offen
  s_add_u32 s60, s72, 8192
  buffer_load_dword v58, v18, s[48:51], s60 offen
  s_add_u32 s61, s72, 139264
  buffer_load_dword v59, v18, s[48:51], s61 offen
  s_add_u32 s58, s72, 262144
  buffer_load_dword v60, v18, s[48:51], s58 offen
  s_add_u32 s59, s72, 393216
  buffer_load_dword v61, v18, s[48:51], s59 offen
  s_add_u32 s60, s72, 270336
  buffer_load_dword v62, v18, s[48:51], s60 offen
  s_add_u32 s61, s72, 401408
  buffer_load_dword v63, v18, s[48:51], s61 offen
  s_add_u32 s58, s72, 16384
  buffer_load_dword v64, v18, s[48:51], s58 offen
  s_add_u32 s59, s72, 147456
  buffer_load_dword v65, v18, s[48:51], s59 offen
  s_add_u32 s60, s72, 24576
  buffer_load_dword v66, v18, s[48:51], s60 offen
  s_add_u32 s61, s72, 155648
  buffer_load_dword v67, v18, s[48:51], s61 offen
  s_add_u32 s58, s72, 278528
  buffer_load_dword v68, v18, s[48:51], s58 offen
  s_add_u32 s59, s72, 409600
  buffer_load_dword v69, v18, s[48:51], s59 offen
  s_add_u32 s60, s72, 286720
  buffer_load_dword v70, v18, s[48:51], s60 offen
  s_add_u32 s61, s72, 417792
  buffer_load_dword v71, v18, s[48:51], s61 offen
  s_waitcnt vmcnt(62)
  v_perm_b32 v120, v105, v104, s70
  v_accvgpr_write_b32 a48, v120
  s_waitcnt vmcnt(60)
  v_perm_b32 v121, v107, v106, s70
  v_accvgpr_write_b32 a49, v121
  s_waitcnt vmcnt(58)
  v_perm_b32 v122, v109, v108, s70
  v_accvgpr_write_b32 a50, v122
  s_waitcnt vmcnt(56)
  v_perm_b32 v123, v111, v110, s70
  v_accvgpr_write_b32 a51, v123
  s_waitcnt vmcnt(54)
  v_perm_b32 v120, v113, v112, s70
  v_accvgpr_write_b32 a52, v120
  s_waitcnt vmcnt(52)
  v_perm_b32 v121, v115, v114, s70
  v_accvgpr_write_b32 a53, v121
  s_waitcnt vmcnt(50)
  v_perm_b32 v122, v117, v116, s70
  v_accvgpr_write_b32 a54, v122
  s_waitcnt vmcnt(48)
  v_perm_b32 v123, v119, v118, s70
  v_accvgpr_write_b32 a55, v123
  v_perm_b32 v120, v105, v104, s71
  v_accvgpr_write_b32 a56, v120
  v_perm_b32 v121, v107, v106, s71
  v_accvgpr_write_b32 a57, v121
  v_perm_b32 v122, v109, v108, s71
  v_accvgpr_write_b32 a58, v122
  v_perm_b32 v123, v111, v110, s71
  v_accvgpr_write_b32 a59, v123
  v_perm_b32 v120, v113, v112, s71
  v_accvgpr_write_b32 a60, v120
  v_perm_b32 v121, v115, v114, s71
  v_accvgpr_write_b32 a61, v121
  v_perm_b32 v122, v117, v116, s71
  v_accvgpr_write_b32 a62, v122
  v_perm_b32 v123, v119, v118, s71
  v_accvgpr_write_b32 a63, v123
  s_add_u32 s58, s72, 32768
  buffer_load_dword v72, v18, s[48:51], s58 offen
  s_add_u32 s59, s72, 163840
  buffer_load_dword v73, v18, s[48:51], s59 offen
  s_add_u32 s60, s72, 40960
  buffer_load_dword v74, v18, s[48:51], s60 offen
  s_add_u32 s61, s72, 172032
  buffer_load_dword v75, v18, s[48:51], s61 offen
  s_add_u32 s58, s72, 294912
  buffer_load_dword v76, v18, s[48:51], s58 offen
  s_add_u32 s59, s72, 425984
  buffer_load_dword v77, v18, s[48:51], s59 offen
  s_add_u32 s60, s72, 303104
  buffer_load_dword v78, v18, s[48:51], s60 offen
  s_add_u32 s61, s72, 434176
  buffer_load_dword v79, v18, s[48:51], s61 offen
  s_add_u32 s58, s72, 49152
  buffer_load_dword v80, v18, s[48:51], s58 offen
  s_add_u32 s59, s72, 180224
  buffer_load_dword v81, v18, s[48:51], s59 offen
  s_add_u32 s60, s72, 57344
  buffer_load_dword v82, v18, s[48:51], s60 offen
  s_add_u32 s61, s72, 188416
  buffer_load_dword v83, v18, s[48:51], s61 offen
  s_add_u32 s58, s72, 311296
  buffer_load_dword v84, v18, s[48:51], s58 offen
  s_add_u32 s59, s72, 442368
  buffer_load_dword v85, v18, s[48:51], s59 offen
  s_add_u32 s60, s72, 319488
  buffer_load_dword v86, v18, s[48:51], s60 offen
  s_add_u32 s61, s72, 450560
  buffer_load_dword v87, v18, s[48:51], s61 offen
  s_waitcnt vmcnt(62)
  v_perm_b32 v120, v25, v24, s70
  v_accvgpr_write_b32 a64, v120
  s_waitcnt vmcnt(60)
  v_perm_b32 v121, v27, v26, s70
  v_accvgpr_write_b32 a65, v121
  s_waitcnt vmcnt(58)
  v_perm_b32 v122, v29, v28, s70
  v_accvgpr_write_b32 a66, v122
  s_waitcnt vmcnt(56)
  v_perm_b32 v123, v31, v30, s70
  v_accvgpr_write_b32 a67, v123
  s_waitcnt vmcnt(54)
  v_perm_b32 v120, v33, v32, s70
  v_accvgpr_write_b32 a68, v120
  s_waitcnt vmcnt(52)
  v_perm_b32 v121, v35, v34, s70
  v_accvgpr_write_b32 a69, v121
  s_waitcnt vmcnt(50)
  v_perm_b32 v122, v37, v36, s70
  v_accvgpr_write_b32 a70, v122
  s_waitcnt vmcnt(48)
  v_perm_b32 v123, v39, v38, s70
  v_accvgpr_write_b32 a71, v123
  v_perm_b32 v120, v25, v24, s71
  v_accvgpr_write_b32 a72, v120
  v_perm_b32 v121, v27, v26, s71
  v_accvgpr_write_b32 a73, v121
  v_perm_b32 v122, v29, v28, s71
  v_accvgpr_write_b32 a74, v122
  v_perm_b32 v123, v31, v30, s71
  v_accvgpr_write_b32 a75, v123
  v_perm_b32 v120, v33, v32, s71
  v_accvgpr_write_b32 a76, v120
  v_perm_b32 v121, v35, v34, s71
  v_accvgpr_write_b32 a77, v121
  v_perm_b32 v122, v37, v36, s71
  v_accvgpr_write_b32 a78, v122
  v_perm_b32 v123, v39, v38, s71
  v_accvgpr_write_b32 a79, v123
  s_add_u32 s58, s73, 0
  buffer_load_dword v88, v18, s[48:51], s58 offen
  s_add_u32 s59, s73, 131072
  buffer_load_dword v89, v18, s[48:51], s59 offen
  s_add_u32 s60, s73, 8192
  buffer_load_dword v90, v18, s[48:51], s60 offen
  s_add_u32 s61, s73, 139264
  buffer_load_dword v91, v18, s[48:51], s61 offen
  s_add_u32 s58, s73, 262144
  buffer_load_dword v92, v18, s[48:51], s58 offen
  s_add_u32 s59, s73, 393216
  buffer_load_dword v93, v18, s[48:51], s59 offen
  s_add_u32 s60, s73, 270336
  buffer_load_dword v94, v18, s[48:51], s60 offen
  s_add_u32 s61, s73, 401408
  buffer_load_dword v95, v18, s[48:51], s61 offen
  s_add_u32 s58, s73, 16384
  buffer_load_dword v96, v18, s[48:51], s58 offen
  s_add_u32 s59, s73, 147456
  buffer_load_dword v97, v18, s[48:51], s59 offen
  s_add_u32 s60, s73, 24576
  buffer_load_dword v98, v18, s[48:51], s60 offen
  s_add_u32 s61, s73, 155648
  buffer_load_dword v99, v18, s[48:51], s61 offen
  s_add_u32 s58, s73, 278528
  buffer_load_dword v100, v18, s[48:51], s58 offen
  s_add_u32 s59, s73, 409600
  buffer_load_dword v101, v18, s[48:51], s59 offen
  s_add_u32 s60, s73, 286720
  buffer_load_dword v102, v18, s[48:51], s60 offen
  s_add_u32 s61, s73, 417792
  buffer_load_dword v103, v18, s[48:51], s61 offen
  s_waitcnt vmcnt(62)
  v_perm_b32 v120, v41, v40, s70
  v_accvgpr_write_b32 a80, v120
  s_waitcnt vmcnt(60)
  v_perm_b32 v121, v43, v42, s70
  v_accvgpr_write_b32 a81, v121
  s_waitcnt vmcnt(58)
  v_perm_b32 v122, v45, v44, s70
  v_accvgpr_write_b32 a82, v122
  s_waitcnt vmcnt(56)
  v_perm_b32 v123, v47, v46, s70
  v_accvgpr_write_b32 a83, v123
  s_waitcnt vmcnt(54)
  v_perm_b32 v120, v49, v48, s70
  v_accvgpr_write_b32 a84, v120
  s_waitcnt vmcnt(52)
  v_perm_b32 v121, v51, v50, s70
  v_accvgpr_write_b32 a85, v121
  s_waitcnt vmcnt(50)
  v_perm_b32 v122, v53, v52, s70
  v_accvgpr_write_b32 a86, v122
  s_waitcnt vmcnt(48)
  v_perm_b32 v123, v55, v54, s70
  v_accvgpr_write_b32 a87, v123
  v_perm_b32 v120, v41, v40, s71
  v_accvgpr_write_b32 a88, v120
  v_perm_b32 v121, v43, v42, s71
  v_accvgpr_write_b32 a89, v121
  v_perm_b32 v122, v45, v44, s71
  v_accvgpr_write_b32 a90, v122
  v_perm_b32 v123, v47, v46, s71
  v_accvgpr_write_b32 a91, v123
  v_perm_b32 v120, v49, v48, s71
  v_accvgpr_write_b32 a92, v120
  v_perm_b32 v121, v51, v50, s71
  v_accvgpr_write_b32 a93, v121
  v_perm_b32 v122, v53, v52, s71
  v_accvgpr_write_b32 a94, v122
  v_perm_b32 v123, v55, v54, s71
  v_accvgpr_write_b32 a95, v123
  s_add_u32 s58, s73, 32768
  buffer_load_dword v104, v18, s[48:51], s58 offen
  s_add_u32 s59, s73, 163840
  buffer_load_dword v105, v18, s[48:51], s59 offen
  s_add_u32 s60, s73, 40960
  buffer_load_dword v106, v18, s[48:51], s60 offen
  s_add_u32 s61, s73, 172032
  buffer_load_dword v107, v18, s[48:51], s61 offen
  s_add_u32 s58, s73, 294912
  buffer_load_dword v108, v18, s[48:51], s58 offen
  s_add_u32 s59, s73, 425984
  buffer_load_dword v109, v18, s[48:51], s59 offen
  s_add_u32 s60, s73, 303104
  buffer_load_dword v110, v18, s[48:51], s60 offen
  s_add_u32 s61, s73, 434176
  buffer_load_dword v111, v18, s[48:51], s61 offen
  s_add_u32 s58, s73, 49152
  buffer_load_dword v112, v18, s[48:51], s58 offen
  s_add_u32 s59, s73, 180224
  buffer_load_dword v113, v18, s[48:51], s59 offen
  s_add_u32 s60, s73, 57344
  buffer_load_dword v114, v18, s[48:51], s60 offen
  s_add_u32 s61, s73, 188416
  buffer_load_dword v115, v18, s[48:51], s61 offen
  s_add_u32 s58, s73, 311296
  buffer_load_dword v116, v18, s[48:51], s58 offen
  s_add_u32 s59, s73, 442368
  buffer_load_dword v117, v18, s[48:51], s59 offen
  s_add_u32 s60, s73, 319488
  buffer_load_dword v118, v18, s[48:51], s60 offen
  s_add_u32 s61, s73, 450560
  buffer_load_dword v119, v18, s[48:51], s61 offen
  s_waitcnt vmcnt(62)
  v_perm_b32 v120, v57, v56, s70
  v_accvgpr_write_b32 a96, v120
  s_waitcnt vmcnt(60)
  v_perm_b32 v121, v59, v58, s70
  v_accvgpr_write_b32 a97, v121
  s_waitcnt vmcnt(58)
  v_perm_b32 v122, v61, v60, s70
  v_accvgpr_write_b32 a98, v122
  s_waitcnt vmcnt(56)
  v_perm_b32 v123, v63, v62, s70
  v_accvgpr_write_b32 a99, v123
  s_waitcnt vmcnt(54)
  v_perm_b32 v120, v65, v64, s70
  v_accvgpr_write_b32 a100, v120
  s_waitcnt vmcnt(52)
  v_perm_b32 v121, v67, v66, s70
  v_accvgpr_write_b32 a101, v121
  s_waitcnt vmcnt(50)
  v_perm_b32 v122, v69, v68, s70
  v_accvgpr_write_b32 a102, v122
  s_waitcnt vmcnt(48)
  v_perm_b32 v123, v71, v70, s70
  v_accvgpr_write_b32 a103, v123
  v_perm_b32 v120, v57, v56, s71
  v_accvgpr_write_b32 a104, v120
  v_perm_b32 v121, v59, v58, s71
  v_accvgpr_write_b32 a105, v121
  v_perm_b32 v122, v61, v60, s71
  v_accvgpr_write_b32 a106, v122
  v_perm_b32 v123, v63, v62, s71
  v_accvgpr_write_b32 a107, v123
  v_perm_b32 v120, v65, v64, s71
  v_accvgpr_write_b32 a108, v120
  v_perm_b32 v121, v67, v66, s71
  v_accvgpr_write_b32 a109, v121
  v_perm_b32 v122, v69, v68, s71
  v_accvgpr_write_b32 a110, v122
  v_perm_b32 v123, v71, v70, s71
  v_accvgpr_write_b32 a111, v123
  s_add_u32 s58, s74, 0
  buffer_load_dword v24, v18, s[48:51], s58 offen
  s_add_u32 s59, s74, 131072
  buffer_load_dword v25, v18, s[48:51], s59 offen
  s_add_u32 s60, s74, 8192
  buffer_load_dword v26, v18, s[48:51], s60 offen
  s_add_u32 s61, s74, 139264
  buffer_load_dword v27, v18, s[48:51], s61 offen
  s_add_u32 s58, s74, 262144
  buffer_load_dword v28, v18, s[48:51], s58 offen
  s_add_u32 s59, s74, 393216
  buffer_load_dword v29, v18, s[48:51], s59 offen
  s_add_u32 s60, s74, 270336
  buffer_load_dword v30, v18, s[48:51], s60 offen
  s_add_u32 s61, s74, 401408
  buffer_load_dword v31, v18, s[48:51], s61 offen
  s_add_u32 s58, s74, 16384
  buffer_load_dword v32, v18, s[48:51], s58 offen
  s_add_u32 s59, s74, 147456
  buffer_load_dword v33, v18, s[48:51], s59 offen
  s_add_u32 s60, s74, 24576
  buffer_load_dword v34, v18, s[48:51], s60 offen
  s_add_u32 s61, s74, 155648
  buffer_load_dword v35, v18, s[48:51], s61 offen
  s_add_u32 s58, s74, 278528
  buffer_load_dword v36, v18, s[48:51], s58 offen
  s_add_u32 s59, s74, 409600
  buffer_load_dword v37, v18, s[48:51], s59 offen
  s_add_u32 s60, s74, 286720
  buffer_load_dword v38, v18, s[48:51], s60 offen
  s_add_u32 s61, s74, 417792
  buffer_load_dword v39, v18, s[48:51], s61 offen
  s_waitcnt vmcnt(62)
  v_perm_b32 v120, v73, v72, s70
  v_accvgpr_write_b32 a112, v120
  s_waitcnt vmcnt(60)
  v_perm_b32 v121, v75, v74, s70
  v_accvgpr_write_b32 a113, v121
  s_waitcnt vmcnt(58)
  v_perm_b32 v122, v77, v76, s70
  v_accvgpr_write_b32 a114, v122
  s_waitcnt vmcnt(56)
  v_perm_b32 v123, v79, v78, s70
  v_accvgpr_write_b32 a115, v123
  s_waitcnt vmcnt(54)
  v_perm_b32 v120, v81, v80, s70
  v_accvgpr_write_b32 a116, v120
  s_waitcnt vmcnt(52)
  v_perm_b32 v121, v83, v82, s70
  v_accvgpr_write_b32 a117, v121
  s_waitcnt vmcnt(50)
  v_perm_b32 v122, v85, v84, s70
  v_accvgpr_write_b32 a118, v122
  s_waitcnt vmcnt(48)
  v_perm_b32 v123, v87, v86, s70
  v_accvgpr_write_b32 a119, v123
  v_perm_b32 v120, v73, v72, s71
  v_accvgpr_write_b32 a120, v120
  v_perm_b32 v121, v75, v74, s71
  v_accvgpr_write_b32 a121, v121
  v_perm_b32 v122, v77, v76, s71
  v_accvgpr_write_b32 a122, v122
  v_perm_b32 v123, v79, v78, s71
  v_accvgpr_write_b32 a123, v123
  v_perm_b32 v120, v81, v80, s71
  v_accvgpr_write_b32 a124, v120
  v_perm_b32 v121, v83, v82, s71
  v_accvgpr_write_b32 a125, v121
  v_perm_b32 v122, v85, v84, s71
  v_accvgpr_write_b32 a126, v122
  v_perm_b32 v123, v87, v86, s71
  v_accvgpr_write_b32 a127, v123
  s_add_u32 s58, s74, 32768
  buffer_load_dword v40, v18, s[48:51], s58 offen
  s_add_u32 s59, s74, 163840
  buffer_load_dword v41, v18, s[48:51], s59 offen
  s_add_u32 s60, s74, 40960
  buffer_load_dword v42, v18, s[48:51], s60 offen
  s_add_u32 s61, s74, 172032
  buffer_load_dword v43, v18, s[48:51], s61 offen
  s_add_u32 s58, s74, 294912
  buffer_load_dword v44, v18, s[48:51], s58 offen
  s_add_u32 s59, s74, 425984
  buffer_load_dword v45, v18, s[48:51], s59 offen
  s_add_u32 s60, s74, 303104
  buffer_load_dword v46, v18, s[48:51], s60 offen
  s_add_u32 s61, s74, 434176
  buffer_load_dword v47, v18, s[48:51], s61 offen
  s_add_u32 s58, s74, 49152
  buffer_load_dword v48, v18, s[48:51], s58 offen
  s_add_u32 s59, s74, 180224
  buffer_load_dword v49, v18, s[48:51], s59 offen
  s_add_u32 s60, s74, 57344
  buffer_load_dword v50, v18, s[48:51], s60 offen
  s_add_u32 s61, s74, 188416
  buffer_load_dword v51, v18, s[48:51], s61 offen
  s_add_u32 s58, s74, 311296
  buffer_load_dword v52, v18, s[48:51], s58 offen
  s_add_u32 s59, s74, 442368
  buffer_load_dword v53, v18, s[48:51], s59 offen
  s_add_u32 s60, s74, 319488
  buffer_load_dword v54, v18, s[48:51], s60 offen
  s_add_u32 s61, s74, 450560
  buffer_load_dword v55, v18, s[48:51], s61 offen
  s_waitcnt vmcnt(62)
  v_perm_b32 v124, v89, v88, s70
  s_waitcnt vmcnt(60)
  v_perm_b32 v125, v91, v90, s70
  s_waitcnt vmcnt(58)
  v_perm_b32 v126, v93, v92, s70
  s_waitcnt vmcnt(56)
  v_perm_b32 v127, v95, v94, s70
  ds_write_b128 v8, v[124:127] offset:8192
  s_waitcnt vmcnt(54)
  v_perm_b32 v124, v97, v96, s70
  s_waitcnt vmcnt(52)
  v_perm_b32 v125, v99, v98, s70
  s_waitcnt vmcnt(50)
  v_perm_b32 v126, v101, v100, s70
  s_waitcnt vmcnt(48)
  v_perm_b32 v127, v103, v102, s70
  ds_write_b128 v8, v[124:127] offset:9216
  v_perm_b32 v124, v89, v88, s71
  v_perm_b32 v125, v91, v90, s71
  v_perm_b32 v126, v93, v92, s71
  v_perm_b32 v127, v95, v94, s71
  ds_write_b128 v8, v[124:127] offset:10240
  v_perm_b32 v124, v97, v96, s71
  v_perm_b32 v125, v99, v98, s71
  v_perm_b32 v126, v101, v100, s71
  v_perm_b32 v127, v103, v102, s71
  ds_write_b128 v8, v[124:127] offset:11264
  s_add_u32 s58, s75, 0
  buffer_load_dword v56, v18, s[48:51], s58 offen
  s_add_u32 s59, s75, 131072
  buffer_load_dword v57, v18, s[48:51], s59 offen
  s_add_u32 s60, s75, 8192
  buffer_load_dword v58, v18, s[48:51], s60 offen
  s_add_u32 s61, s75, 139264
  buffer_load_dword v59, v18, s[48:51], s61 offen
  s_add_u32 s58, s75, 262144
  buffer_load_dword v60, v18, s[48:51], s58 offen
  s_add_u32 s59, s75, 393216
  buffer_load_dword v61, v18, s[48:51], s59 offen
  s_add_u32 s60, s75, 270336
  buffer_load_dword v62, v18, s[48:51], s60 offen
  s_add_u32 s61, s75, 401408
  buffer_load_dword v63, v18, s[48:51], s61 offen
  s_add_u32 s58, s75, 16384
  buffer_load_dword v64, v18, s[48:51], s58 offen
  s_add_u32 s59, s75, 147456
  buffer_load_dword v65, v18, s[48:51], s59 offen
  s_add_u32 s60, s75, 24576
  buffer_load_dword v66, v18, s[48:51], s60 offen
  s_add_u32 s61, s75, 155648
  buffer_load_dword v67, v18, s[48:51], s61 offen
  s_add_u32 s58, s75, 278528
  buffer_load_dword v68, v18, s[48:51], s58 offen
  s_add_u32 s59, s75, 409600
  buffer_load_dword v69, v18, s[48:51], s59 offen
  s_add_u32 s60, s75, 286720
  buffer_load_dword v70, v18, s[48:51], s60 offen
  s_add_u32 s61, s75, 417792
  buffer_load_dword v71, v18, s[48:51], s61 offen
  s_waitcnt vmcnt(62)
  v_perm_b32 v124, v105, v104, s70
  s_waitcnt vmcnt(60)
  v_perm_b32 v125, v107, v106, s70
  s_waitcnt vmcnt(58)
  v_perm_b32 v126, v109, v108, s70
  s_waitcnt vmcnt(56)
  v_perm_b32 v127, v111, v110, s70
  ds_write_b128 v8, v[124:127] offset:12288
  s_waitcnt vmcnt(54)
  v_perm_b32 v124, v113, v112, s70
  s_waitcnt vmcnt(52)
  v_perm_b32 v125, v115, v114, s70
  s_waitcnt vmcnt(50)
  v_perm_b32 v126, v117, v116, s70
  s_waitcnt vmcnt(48)
  v_perm_b32 v127, v119, v118, s70
  ds_write_b128 v8, v[124:127] offset:13312
  v_perm_b32 v124, v105, v104, s71
  v_perm_b32 v125, v107, v106, s71
  v_perm_b32 v126, v109, v108, s71
  v_perm_b32 v127, v111, v110, s71
  ds_write_b128 v8, v[124:127] offset:14336
  v_perm_b32 v124, v113, v112, s71
  v_perm_b32 v125, v115, v114, s71
  v_perm_b32 v126, v117, v116, s71
  v_perm_b32 v127, v119, v118, s71
  ds_write_b128 v8, v[124:127] offset:15360
  s_add_u32 s58, s75, 32768
  buffer_load_dword v72, v18, s[48:51], s58 offen
  s_add_u32 s59, s75, 163840
  buffer_load_dword v73, v18, s[48:51], s59 offen
  s_add_u32 s60, s75, 40960
  buffer_load_dword v74, v18, s[48:51], s60 offen
  s_add_u32 s61, s75, 172032
  buffer_load_dword v75, v18, s[48:51], s61 offen
  s_add_u32 s58, s75, 294912
  buffer_load_dword v76, v18, s[48:51], s58 offen
  s_add_u32 s59, s75, 425984
  buffer_load_dword v77, v18, s[48:51], s59 offen
  s_add_u32 s60, s75, 303104
  buffer_load_dword v78, v18, s[48:51], s60 offen
  s_add_u32 s61, s75, 434176
  buffer_load_dword v79, v18, s[48:51], s61 offen
  s_add_u32 s58, s75, 49152
  buffer_load_dword v80, v18, s[48:51], s58 offen
  s_add_u32 s59, s75, 180224
  buffer_load_dword v81, v18, s[48:51], s59 offen
  s_add_u32 s60, s75, 57344
  buffer_load_dword v82, v18, s[48:51], s60 offen
  s_add_u32 s61, s75, 188416
  buffer_load_dword v83, v18, s[48:51], s61 offen
  s_add_u32 s58, s75, 311296
  buffer_load_dword v84, v18, s[48:51], s58 offen
  s_add_u32 s59, s75, 442368
  buffer_load_dword v85, v18, s[48:51], s59 offen
  s_add_u32 s60, s75, 319488
  buffer_load_dword v86, v18, s[48:51], s60 offen
  s_add_u32 s61, s75, 450560
  buffer_load_dword v87, v18, s[48:51], s61 offen
  s_waitcnt vmcnt(62)
  v_perm_b32 v120, v25, v24, s70
  v_accvgpr_write_b32 a128, v120
  s_waitcnt vmcnt(60)
  v_perm_b32 v121, v27, v26, s70
  v_accvgpr_write_b32 a129, v121
  s_waitcnt vmcnt(58)
  v_perm_b32 v122, v29, v28, s70
  v_accvgpr_write_b32 a130, v122
  s_waitcnt vmcnt(56)
  v_perm_b32 v123, v31, v30, s70
  v_accvgpr_write_b32 a131, v123
  s_waitcnt vmcnt(54)
  v_perm_b32 v120, v33, v32, s70
  v_accvgpr_write_b32 a132, v120
  s_waitcnt vmcnt(52)
  v_perm_b32 v121, v35, v34, s70
  v_accvgpr_write_b32 a133, v121
  s_waitcnt vmcnt(50)
  v_perm_b32 v122, v37, v36, s70
  v_accvgpr_write_b32 a134, v122
  s_waitcnt vmcnt(48)
  v_perm_b32 v123, v39, v38, s70
  v_accvgpr_write_b32 a135, v123
  v_perm_b32 v120, v25, v24, s71
  v_accvgpr_write_b32 a136, v120
  v_perm_b32 v121, v27, v26, s71
  v_accvgpr_write_b32 a137, v121
  v_perm_b32 v122, v29, v28, s71
  v_accvgpr_write_b32 a138, v122
  v_perm_b32 v123, v31, v30, s71
  v_accvgpr_write_b32 a139, v123
  v_perm_b32 v120, v33, v32, s71
  v_accvgpr_write_b32 a140, v120
  v_perm_b32 v121, v35, v34, s71
  v_accvgpr_write_b32 a141, v121
  v_perm_b32 v122, v37, v36, s71
  v_accvgpr_write_b32 a142, v122
  v_perm_b32 v123, v39, v38, s71
  v_accvgpr_write_b32 a143, v123
  s_load_dwordx2 s[48:49], s[0:1], 32
  s_waitcnt lgkmcnt(0)
  s_add_u32 s58, s72, 0
  buffer_load_dword v88, v18, s[48:51], s58 offen
  s_add_u32 s59, s72, 131072
  buffer_load_dword v89, v18, s[48:51], s59 offen
  s_add_u32 s60, s72, 8192
  buffer_load_dword v90, v18, s[48:51], s60 offen
  s_add_u32 s61, s72, 139264
  buffer_load_dword v91, v18, s[48:51], s61 offen
  s_add_u32 s58, s72, 262144
  buffer_load_dword v92, v18, s[48:51], s58 offen
  s_add_u32 s59, s72, 393216
  buffer_load_dword v93, v18, s[48:51], s59 offen
  s_add_u32 s60, s72, 270336
  buffer_load_dword v94, v18, s[48:51], s60 offen
  s_add_u32 s61, s72, 401408
  buffer_load_dword v95, v18, s[48:51], s61 offen
  s_add_u32 s58, s72, 16384
  buffer_load_dword v96, v18, s[48:51], s58 offen
  s_add_u32 s59, s72, 147456
  buffer_load_dword v97, v18, s[48:51], s59 offen
  s_add_u32 s60, s72, 24576
  buffer_load_dword v98, v18, s[48:51], s60 offen
  s_add_u32 s61, s72, 155648
  buffer_load_dword v99, v18, s[48:51], s61 offen
  s_add_u32 s58, s72, 278528
  buffer_load_dword v100, v18, s[48:51], s58 offen
  s_add_u32 s59, s72, 409600
  buffer_load_dword v101, v18, s[48:51], s59 offen
  s_add_u32 s60, s72, 286720
  buffer_load_dword v102, v18, s[48:51], s60 offen
  s_add_u32 s61, s72, 417792
  buffer_load_dword v103, v18, s[48:51], s61 offen
  s_waitcnt vmcnt(62)
  v_perm_b32 v120, v41, v40, s70
  v_accvgpr_write_b32 a144, v120
  s_waitcnt vmcnt(60)
  v_perm_b32 v121, v43, v42, s70
  v_accvgpr_write_b32 a145, v121
  s_waitcnt vmcnt(58)
  v_perm_b32 v122, v45, v44, s70
  v_accvgpr_write_b32 a146, v122
  s_waitcnt vmcnt(56)
  v_perm_b32 v123, v47, v46, s70
  v_accvgpr_write_b32 a147, v123
  s_waitcnt vmcnt(54)
  v_perm_b32 v120, v49, v48, s70
  v_accvgpr_write_b32 a148, v120
  s_waitcnt vmcnt(52)
  v_perm_b32 v121, v51, v50, s70
  v_accvgpr_write_b32 a149, v121
  s_waitcnt vmcnt(50)
  v_perm_b32 v122, v53, v52, s70
  v_accvgpr_write_b32 a150, v122
  s_waitcnt vmcnt(48)
  v_perm_b32 v123, v55, v54, s70
  v_accvgpr_write_b32 a151, v123
  v_perm_b32 v120, v41, v40, s71
  v_accvgpr_write_b32 a152, v120
  v_perm_b32 v121, v43, v42, s71
  v_accvgpr_write_b32 a153, v121
  v_perm_b32 v122, v45, v44, s71
  v_accvgpr_write_b32 a154, v122
  v_perm_b32 v123, v47, v46, s71
  v_accvgpr_write_b32 a155, v123
  v_perm_b32 v120, v49, v48, s71
  v_accvgpr_write_b32 a156, v120
  v_perm_b32 v121, v51, v50, s71
  v_accvgpr_write_b32 a157, v121
  v_perm_b32 v122, v53, v52, s71
  v_accvgpr_write_b32 a158, v122
  v_perm_b32 v123, v55, v54, s71
  v_accvgpr_write_b32 a159, v123
  s_add_u32 s58, s72, 32768
  buffer_load_dword v104, v18, s[48:51], s58 offen
  s_add_u32 s59, s72, 163840
  buffer_load_dword v105, v18, s[48:51], s59 offen
  s_add_u32 s60, s72, 40960
  buffer_load_dword v106, v18, s[48:51], s60 offen
  s_add_u32 s61, s72, 172032
  buffer_load_dword v107, v18, s[48:51], s61 offen
  s_add_u32 s58, s72, 294912
  buffer_load_dword v108, v18, s[48:51], s58 offen
  s_add_u32 s59, s72, 425984
  buffer_load_dword v109, v18, s[48:51], s59 offen
  s_add_u32 s60, s72, 303104
  buffer_load_dword v110, v18, s[48:51], s60 offen
  s_add_u32 s61, s72, 434176
  buffer_load_dword v111, v18, s[48:51], s61 offen
  s_add_u32 s58, s72, 49152
  buffer_load_dword v112, v18, s[48:51], s58 offen
  s_add_u32 s59, s72, 180224
  buffer_load_dword v113, v18, s[48:51], s59 offen
  s_add_u32 s60, s72, 57344
  buffer_load_dword v114, v18, s[48:51], s60 offen
  s_add_u32 s61, s72, 188416
  buffer_load_dword v115, v18, s[48:51], s61 offen
  s_add_u32 s58, s72, 311296
  buffer_load_dword v116, v18, s[48:51], s58 offen
  s_add_u32 s59, s72, 442368
  buffer_load_dword v117, v18, s[48:51], s59 offen
  s_add_u32 s60, s72, 319488
  buffer_load_dword v118, v18, s[48:51], s60 offen
  s_add_u32 s61, s72, 450560
  buffer_load_dword v119, v18, s[48:51], s61 offen
  s_waitcnt vmcnt(62)
  v_perm_b32 v120, v57, v56, s70
  v_accvgpr_write_b32 a160, v120
  s_waitcnt vmcnt(60)
  v_perm_b32 v121, v59, v58, s70
  v_accvgpr_write_b32 a161, v121
  s_waitcnt vmcnt(58)
  v_perm_b32 v122, v61, v60, s70
  v_accvgpr_write_b32 a162, v122
  s_waitcnt vmcnt(56)
  v_perm_b32 v123, v63, v62, s70
  v_accvgpr_write_b32 a163, v123
  s_waitcnt vmcnt(54)
  v_perm_b32 v120, v65, v64, s70
  v_accvgpr_write_b32 a164, v120
  s_waitcnt vmcnt(52)
  v_perm_b32 v121, v67, v66, s70
  v_accvgpr_write_b32 a165, v121
  s_waitcnt vmcnt(50)
  v_perm_b32 v122, v69, v68, s70
  v_accvgpr_write_b32 a166, v122
  s_waitcnt vmcnt(48)
  v_perm_b32 v123, v71, v70, s70
  v_accvgpr_write_b32 a167, v123
  v_perm_b32 v120, v57, v56, s71
  v_accvgpr_write_b32 a168, v120
  v_perm_b32 v121, v59, v58, s71
  v_accvgpr_write_b32 a169, v121
  v_perm_b32 v122, v61, v60, s71
  v_accvgpr_write_b32 a170, v122
  v_perm_b32 v123, v63, v62, s71
  v_accvgpr_write_b32 a171, v123
  v_perm_b32 v120, v65, v64, s71
  v_accvgpr_write_b32 a172, v120
  v_perm_b32 v121, v67, v66, s71
  v_accvgpr_write_b32 a173, v121
  v_perm_b32 v122, v69, v68, s71
  v_accvgpr_write_b32 a174, v122
  v_perm_b32 v123, v71, v70, s71
  v_accvgpr_write_b32 a175, v123
  s_add_u32 s58, s73, 0
  buffer_load_dword v24, v18, s[48:51], s58 offen
  s_add_u32 s59, s73, 131072
  buffer_load_dword v25, v18, s[48:51], s59 offen
  s_add_u32 s60, s73, 8192
  buffer_load_dword v26, v18, s[48:51], s60 offen
  s_add_u32 s61, s73, 139264
  buffer_load_dword v27, v18, s[48:51], s61 offen
  s_add_u32 s58, s73, 262144
  buffer_load_dword v28, v18, s[48:51], s58 offen
  s_add_u32 s59, s73, 393216
  buffer_load_dword v29, v18, s[48:51], s59 offen
  s_add_u32 s60, s73, 270336
  buffer_load_dword v30, v18, s[48:51], s60 offen
  s_add_u32 s61, s73, 401408
  buffer_load_dword v31, v18, s[48:51], s61 offen
  s_add_u32 s58, s73, 16384
  buffer_load_dword v32, v18, s[48:51], s58 offen
  s_add_u32 s59, s73, 147456
  buffer_load_dword v33, v18, s[48:51], s59 offen
  s_add_u32 s60, s73, 24576
  buffer_load_dword v34, v18, s[48:51], s60 offen
  s_add_u32 s61, s73, 155648
  buffer_load_dword v35, v18, s[48:51], s61 offen
  s_add_u32 s58, s73, 278528
  buffer_load_dword v36, v18, s[48:51], s58 offen
  s_add_u32 s59, s73, 409600
  buffer_load_dword v37, v18, s[48:51], s59 offen
  s_add_u32 s60, s73, 286720
  buffer_load_dword v38, v18, s[48:51], s60 offen
  s_add_u32 s61, s73, 417792
  buffer_load_dword v39, v18, s[48:51], s61 offen
  s_waitcnt vmcnt(62)
  v_perm_b32 v120, v73, v72, s70
  v_accvgpr_write_b32 a176, v120
  s_waitcnt vmcnt(60)
  v_perm_b32 v121, v75, v74, s70
  v_accvgpr_write_b32 a177, v121
  s_waitcnt vmcnt(58)
  v_perm_b32 v122, v77, v76, s70
  v_accvgpr_write_b32 a178, v122
  s_waitcnt vmcnt(56)
  v_perm_b32 v123, v79, v78, s70
  v_accvgpr_write_b32 a179, v123
  s_waitcnt vmcnt(54)
  v_perm_b32 v120, v81, v80, s70
  v_accvgpr_write_b32 a180, v120
  s_waitcnt vmcnt(52)
  v_perm_b32 v121, v83, v82, s70
  v_accvgpr_write_b32 a181, v121
  s_waitcnt vmcnt(50)
  v_perm_b32 v122, v85, v84, s70
  v_accvgpr_write_b32 a182, v122
  s_waitcnt vmcnt(48)
  v_perm_b32 v123, v87, v86, s70
  v_accvgpr_write_b32 a183, v123
  v_perm_b32 v120, v73, v72, s71
  v_accvgpr_write_b32 a184, v120
  v_perm_b32 v121, v75, v74, s71
  v_accvgpr_write_b32 a185, v121
  v_perm_b32 v122, v77, v76, s71
  v_accvgpr_write_b32 a186, v122
  v_perm_b32 v123, v79, v78, s71
  v_accvgpr_write_b32 a187, v123
  v_perm_b32 v120, v81, v80, s71
  v_accvgpr_write_b32 a188, v120
  v_perm_b32 v121, v83, v82, s71
  v_accvgpr_write_b32 a189, v121
  v_perm_b32 v122, v85, v84, s71
  v_accvgpr_write_b32 a190, v122
  v_perm_b32 v123, v87, v86, s71
  v_accvgpr_write_b32 a191, v123
  s_add_u32 s58, s73, 32768
  buffer_load_dword v40, v18, s[48:51], s58 offen
  s_add_u32 s59, s73, 163840
  buffer_load_dword v41, v18, s[48:51], s59 offen
  s_add_u32 s60, s73, 40960
  buffer_load_dword v42, v18, s[48:51], s60 offen
  s_add_u32 s61, s73, 172032
  buffer_load_dword v43, v18, s[48:51], s61 offen
  s_add_u32 s58, s73, 294912
  buffer_load_dword v44, v18, s[48:51], s58 offen
  s_add_u32 s59, s73, 425984
  buffer_load_dword v45, v18, s[48:51], s59 offen
  s_add_u32 s60, s73, 303104
  buffer_load_dword v46, v18, s[48:51], s60 offen
  s_add_u32 s61, s73, 434176
  buffer_load_dword v47, v18, s[48:51], s61 offen
  s_add_u32 s58, s73, 49152
  buffer_load_dword v48, v18, s[48:51], s58 offen
  s_add_u32 s59, s73, 180224
  buffer_load_dword v49, v18, s[48:51], s59 offen
  s_add_u32 s60, s73, 57344
  buffer_load_dword v50, v18, s[48:51], s60 offen
  s_add_u32 s61, s73, 188416
  buffer_load_dword v51, v18, s[48:51], s61 offen
  s_add_u32 s58, s73, 311296
  buffer_load_dword v52, v18, s[48:51], s58 offen
  s_add_u32 s59, s73, 442368
  buffer_load_dword v53, v18, s[48:51], s59 offen
  s_add_u32 s60, s73, 319488
  buffer_load_dword v54, v18, s[48:51], s60 offen
  s_add_u32 s61, s73, 450560
  buffer_load_dword v55, v18, s[48:51], s61 offen
  s_waitcnt vmcnt(62)
  v_perm_b32 v120, v89, v88, s70
  v_accvgpr_write_b32 a192, v120
  s_waitcnt vmcnt(60)
  v_perm_b32 v121, v91, v90, s70
  v_accvgpr_write_b32 a193, v121
  s_waitcnt vmcnt(58)
  v_perm_b32 v122, v93, v92, s70
  v_accvgpr_write_b32 a194, v122
  s_waitcnt vmcnt(56)
  v_perm_b32 v123, v95, v94, s70
  v_accvgpr_write_b32 a195, v123
  s_waitcnt vmcnt(54)
  v_perm_b32 v120, v97, v96, s70
  v_accvgpr_write_b32 a196, v120
  s_waitcnt vmcnt(52)
  v_perm_b32 v121, v99, v98, s70
  v_accvgpr_write_b32 a197, v121
  s_waitcnt vmcnt(50)
  v_perm_b32 v122, v101, v100, s70
  v_accvgpr_write_b32 a198, v122
  s_waitcnt vmcnt(48)
  v_perm_b32 v123, v103, v102, s70
  v_accvgpr_write_b32 a199, v123
  v_perm_b32 v120, v89, v88, s71
  v_accvgpr_write_b32 a200, v120
  v_perm_b32 v121, v91, v90, s71
  v_accvgpr_write_b32 a201, v121
  v_perm_b32 v122, v93, v92, s71
  v_accvgpr_write_b32 a202, v122
  v_perm_b32 v123, v95, v94, s71
  v_accvgpr_write_b32 a203, v123
  v_perm_b32 v120, v97, v96, s71
  v_accvgpr_write_b32 a204, v120
  v_perm_b32 v121, v99, v98, s71
  v_accvgpr_write_b32 a205, v121
  v_perm_b32 v122, v101, v100, s71
  v_accvgpr_write_b32 a206, v122
  v_perm_b32 v123, v103, v102, s71
  v_accvgpr_write_b32 a207, v123
  s_add_u32 s58, s74, 0
  buffer_load_dword v56, v18, s[48:51], s58 offen
  s_add_u32 s59, s74, 131072
  buffer_load_dword v57, v18, s[48:51], s59 offen
  s_add_u32 s60, s74, 8192
  buffer_load_dword v58, v18, s[48:51], s60 offen
  s_add_u32 s61, s74, 139264
  buffer_load_dword v59, v18, s[48:51], s61 offen
  s_add_u32 s58, s74, 262144
  buffer_load_dword v60, v18, s[48:51], s58 offen
  s_add_u32 s59, s74, 393216
  buffer_load_dword v61, v18, s[48:51], s59 offen
  s_add_u32 s60, s74, 270336
  buffer_load_dword v62, v18, s[48:51], s60 offen
  s_add_u32 s61, s74, 401408
  buffer_load_dword v63, v18, s[48:51], s61 offen
  s_add_u32 s58, s74, 16384
  buffer_load_dword v64, v18, s[48:51], s58 offen
  s_add_u32 s59, s74, 147456
  buffer_load_dword v65, v18, s[48:51], s59 offen
  s_add_u32 s60, s74, 24576
  buffer_load_dword v66, v18, s[48:51], s60 offen
  s_add_u32 s61, s74, 155648
  buffer_load_dword v67, v18, s[48:51], s61 offen
  s_add_u32 s58, s74, 278528
  buffer_load_dword v68, v18, s[48:51], s58 offen
  s_add_u32 s59, s74, 409600
  buffer_load_dword v69, v18, s[48:51], s59 offen
  s_add_u32 s60, s74, 286720
  buffer_load_dword v70, v18, s[48:51], s60 offen
  s_add_u32 s61, s74, 417792
  buffer_load_dword v71, v18, s[48:51], s61 offen
  s_waitcnt vmcnt(62)
  v_perm_b32 v120, v105, v104, s70
  v_accvgpr_write_b32 a208, v120
  s_waitcnt vmcnt(60)
  v_perm_b32 v121, v107, v106, s70
  v_accvgpr_write_b32 a209, v121
  s_waitcnt vmcnt(58)
  v_perm_b32 v122, v109, v108, s70
  v_accvgpr_write_b32 a210, v122
  s_waitcnt vmcnt(56)
  v_perm_b32 v123, v111, v110, s70
  v_accvgpr_write_b32 a211, v123
  s_waitcnt vmcnt(54)
  v_perm_b32 v120, v113, v112, s70
  v_accvgpr_write_b32 a212, v120
  s_waitcnt vmcnt(52)
  v_perm_b32 v121, v115, v114, s70
  v_accvgpr_write_b32 a213, v121
  s_waitcnt vmcnt(50)
  v_perm_b32 v122, v117, v116, s70
  v_accvgpr_write_b32 a214, v122
  s_waitcnt vmcnt(48)
  v_perm_b32 v123, v119, v118, s70
  v_accvgpr_write_b32 a215, v123
  v_perm_b32 v120, v105, v104, s71
  v_accvgpr_write_b32 a216, v120
  v_perm_b32 v121, v107, v106, s71
  v_accvgpr_write_b32 a217, v121
  v_perm_b32 v122, v109, v108, s71
  v_accvgpr_write_b32 a218, v122
  v_perm_b32 v123, v111, v110, s71
  v_accvgpr_write_b32 a219, v123
  v_perm_b32 v120, v113, v112, s71
  v_accvgpr_write_b32 a220, v120
  v_perm_b32 v121, v115, v114, s71
  v_accvgpr_write_b32 a221, v121
  v_perm_b32 v122, v117, v116, s71
  v_accvgpr_write_b32 a222, v122
  v_perm_b32 v123, v119, v118, s71
  v_accvgpr_write_b32 a223, v123
  s_add_u32 s58, s74, 32768
  buffer_load_dword v72, v18, s[48:51], s58 offen
  s_add_u32 s59, s74, 163840
  buffer_load_dword v73, v18, s[48:51], s59 offen
  s_add_u32 s60, s74, 40960
  buffer_load_dword v74, v18, s[48:51], s60 offen
  s_add_u32 s61, s74, 172032
  buffer_load_dword v75, v18, s[48:51], s61 offen
  s_add_u32 s58, s74, 294912
  buffer_load_dword v76, v18, s[48:51], s58 offen
  s_add_u32 s59, s74, 425984
  buffer_load_dword v77, v18, s[48:51], s59 offen
  s_add_u32 s60, s74, 303104
  buffer_load_dword v78, v18, s[48:51], s60 offen
  s_add_u32 s61, s74, 434176
  buffer_load_dword v79, v18, s[48:51], s61 offen
  s_add_u32 s58, s74, 49152
  buffer_load_dword v80, v18, s[48:51], s58 offen
  s_add_u32 s59, s74, 180224
  buffer_load_dword v81, v18, s[48:51], s59 offen
  s_add_u32 s60, s74, 57344
  buffer_load_dword v82, v18, s[48:51], s60 offen
  s_add_u32 s61, s74, 188416
  buffer_load_dword v83, v18, s[48:51], s61 offen
  s_add_u32 s58, s74, 311296
  buffer_load_dword v84, v18, s[48:51], s58 offen
  s_add_u32 s59, s74, 442368
  buffer_load_dword v85, v18, s[48:51], s59 offen
  s_add_u32 s60, s74, 319488
  buffer_load_dword v86, v18, s[48:51], s60 offen
  s_add_u32 s61, s74, 450560
  buffer_load_dword v87, v18, s[48:51], s61 offen
  s_waitcnt vmcnt(62)
  v_perm_b32 v120, v25, v24, s70
  v_accvgpr_write_b32 a224, v120
  s_waitcnt vmcnt(60)
  v_perm_b32 v121, v27, v26, s70
  v_accvgpr_write_b32 a225, v121
  s_waitcnt vmcnt(58)
  v_perm_b32 v122, v29, v28, s70
  v_accvgpr_write_b32 a226, v122
  s_waitcnt vmcnt(56)
  v_perm_b32 v123, v31, v30, s70
  v_accvgpr_write_b32 a227, v123
  s_waitcnt vmcnt(54)
  v_perm_b32 v120, v33, v32, s70
  v_accvgpr_write_b32 a228, v120
  s_waitcnt vmcnt(52)
  v_perm_b32 v121, v35, v34, s70
  v_accvgpr_write_b32 a229, v121
  s_waitcnt vmcnt(50)
  v_perm_b32 v122, v37, v36, s70
  v_accvgpr_write_b32 a230, v122
  s_waitcnt vmcnt(48)
  v_perm_b32 v123, v39, v38, s70
  v_accvgpr_write_b32 a231, v123
  v_perm_b32 v120, v25, v24, s71
  v_accvgpr_write_b32 a232, v120
  v_perm_b32 v121, v27, v26, s71
  v_accvgpr_write_b32 a233, v121
  v_perm_b32 v122, v29, v28, s71
  v_accvgpr_write_b32 a234, v122
  v_perm_b32 v123, v31, v30, s71
  v_accvgpr_write_b32 a235, v123
  v_perm_b32 v120, v33, v32, s71
  v_accvgpr_write_b32 a236, v120
  v_perm_b32 v121, v35, v34, s71
  v_accvgpr_write_b32 a237, v121
  v_perm_b32 v122, v37, v36, s71
  v_accvgpr_write_b32 a238, v122
  v_perm_b32 v123, v39, v38, s71
  v_accvgpr_write_b32 a239, v123
  s_add_u32 s58, s75, 0
  buffer_load_dword v88, v18, s[48:51], s58 offen
  s_add_u32 s59, s75, 131072
  buffer_load_dword v89, v18, s[48:51], s59 offen
  s_add_u32 s60, s75, 8192
  buffer_load_dword v90, v18, s[48:51], s60 offen
  s_add_u32 s61, s75, 139264
  buffer_load_dword v91, v18, s[48:51], s61 offen
  s_add_u32 s58, s75, 262144
  buffer_load_dword v92, v18, s[48:51], s58 offen
  s_add_u32 s59, s75, 393216
  buffer_load_dword v93, v18, s[48:51], s59 offen
  s_add_u32 s60, s75, 270336
  buffer_load_dword v94, v18, s[48:51], s60 offen
  s_add_u32 s61, s75, 401408
  buffer_load_dword v95, v18, s[48:51], s61 offen
  s_add_u32 s58, s75, 16384
  buffer_load_dword v96, v18, s[48:51], s58 offen
  s_add_u32 s59, s75, 147456
  buffer_load_dword v97, v18, s[48:51], s59 offen
  s_add_u32 s60, s75, 24576
  buffer_load_dword v98, v18, s[48:51], s60 offen
  s_add_u32 s61, s75, 155648
  buffer_load_dword v99, v18, s[48:51], s61 offen
  s_add_u32 s58, s75, 278528
  buffer_load_dword v100, v18, s[48:51], s58 offen
  s_add_u32 s59, s75, 409600
  buffer_load_dword v101, v18, s[48:51], s59 offen
  s_add_u32 s60, s75, 286720
  buffer_load_dword v102, v18, s[48:51], s60 offen
  s_add_u32 s61, s75, 417792
  buffer_load_dword v103, v18, s[48:51], s61 offen
  s_waitcnt vmcnt(62)
  v_perm_b32 v120, v41, v40, s70
  v_accvgpr_write_b32 a240, v120
  s_waitcnt vmcnt(60)
  v_perm_b32 v121, v43, v42, s70
  v_accvgpr_write_b32 a241, v121
  s_waitcnt vmcnt(58)
  v_perm_b32 v122, v45, v44, s70
  v_accvgpr_write_b32 a242, v122
  s_waitcnt vmcnt(56)
  v_perm_b32 v123, v47, v46, s70
  v_accvgpr_write_b32 a243, v123
  s_waitcnt vmcnt(54)
  v_perm_b32 v120, v49, v48, s70
  v_accvgpr_write_b32 a244, v120
  s_waitcnt vmcnt(52)
  v_perm_b32 v121, v51, v50, s70
  v_accvgpr_write_b32 a245, v121
  s_waitcnt vmcnt(50)
  v_perm_b32 v122, v53, v52, s70
  v_accvgpr_write_b32 a246, v122
  s_waitcnt vmcnt(48)
  v_perm_b32 v123, v55, v54, s70
  v_accvgpr_write_b32 a247, v123
  v_perm_b32 v120, v41, v40, s71
  v_accvgpr_write_b32 a248, v120
  v_perm_b32 v121, v43, v42, s71
  v_accvgpr_write_b32 a249, v121
  v_perm_b32 v122, v45, v44, s71
  v_accvgpr_write_b32 a250, v122
  v_perm_b32 v123, v47, v46, s71
  v_accvgpr_write_b32 a251, v123
  v_perm_b32 v120, v49, v48, s71
  v_accvgpr_write_b32 a252, v120
  v_perm_b32 v121, v51, v50, s71
  v_accvgpr_write_b32 a253, v121
  v_perm_b32 v122, v53, v52, s71
  v_accvgpr_write_b32 a254, v122
  v_perm_b32 v123, v55, v54, s71
  v_accvgpr_write_b32 a255, v123
  s_add_u32 s58, s75, 32768
  buffer_load_dword v104, v18, s[48:51], s58 offen
  s_add_u32 s59, s75, 163840
  buffer_load_dword v105, v18, s[48:51], s59 offen
  s_add_u32 s60, s75, 40960
  buffer_load_dword v106, v18, s[48:51], s60 offen
  s_add_u32 s61, s75, 172032
  buffer_load_dword v107, v18, s[48:51], s61 offen
  s_add_u32 s58, s75, 294912
  buffer_load_dword v108, v18, s[48:51], s58 offen
  s_add_u32 s59, s75, 425984
  buffer_load_dword v109, v18, s[48:51], s59 offen
  s_add_u32 s60, s75, 303104
  buffer_load_dword v110, v18, s[48:51], s60 offen
  s_add_u32 s61, s75, 434176
  buffer_load_dword v111, v18, s[48:51], s61 offen
  s_add_u32 s58, s75, 49152
  buffer_load_dword v112, v18, s[48:51], s58 offen
  s_add_u32 s59, s75, 180224
  buffer_load_dword v113, v18, s[48:51], s59 offen
  s_add_u32 s60, s75, 57344
  buffer_load_dword v114, v18, s[48:51], s60 offen
  s_add_u32 s61, s75, 188416
  buffer_load_dword v115, v18, s[48:51], s61 offen
  s_add_u32 s58, s75, 311296
  buffer_load_dword v116, v18, s[48:51], s58 offen
  s_add_u32 s59, s75, 442368
  buffer_load_dword v117, v18, s[48:51], s59 offen
  s_add_u32 s60, s75, 319488
  buffer_load_dword v118, v18, s[48:51], s60 offen
  s_add_u32 s61, s75, 450560
  buffer_load_dword v119, v18, s[48:51], s61 offen
  s_waitcnt vmcnt(62)
  v_perm_b32 v124, v57, v56, s70
  s_waitcnt vmcnt(60)
  v_perm_b32 v125, v59, v58, s70
  s_waitcnt vmcnt(58)
  v_perm_b32 v126, v61, v60, s70
  s_waitcnt vmcnt(56)
  v_perm_b32 v127, v63, v62, s70
  ds_write_b128 v8, v[124:127] offset:16384
  s_waitcnt vmcnt(54)
  v_perm_b32 v124, v65, v64, s70
  s_waitcnt vmcnt(52)
  v_perm_b32 v125, v67, v66, s70
  s_waitcnt vmcnt(50)
  v_perm_b32 v126, v69, v68, s70
  s_waitcnt vmcnt(48)
  v_perm_b32 v127, v71, v70, s70
  ds_write_b128 v8, v[124:127] offset:17408
  v_perm_b32 v124, v57, v56, s71
  v_perm_b32 v125, v59, v58, s71
  v_perm_b32 v126, v61, v60, s71
  v_perm_b32 v127, v63, v62, s71
  ds_write_b128 v8, v[124:127] offset:18432
  v_perm_b32 v124, v65, v64, s71
  v_perm_b32 v125, v67, v66, s71
  v_perm_b32 v126, v69, v68, s71
  v_perm_b32 v127, v71, v70, s71
  ds_write_b128 v8, v[124:127] offset:19456
  s_waitcnt vmcnt(46)
  v_perm_b32 v124, v73, v72, s70
  s_waitcnt vmcnt(44)
  v_perm_b32 v125, v75, v74, s70
  s_waitcnt vmcnt(42)
  v_perm_b32 v126, v77, v76, s70
  s_waitcnt vmcnt(40)
  v_perm_b32 v127, v79, v78, s70
  ds_write_b128 v8, v[124:127] offset:20480
  s_waitcnt vmcnt(38)
  v_perm_b32 v124, v81, v80, s70
  s_waitcnt vmcnt(36)
  v_perm_b32 v125, v83, v82, s70
  s_waitcnt vmcnt(34)
  v_perm_b32 v126, v85, v84, s70
  s_waitcnt vmcnt(32)
  v_perm_b32 v127, v87, v86, s70
  ds_write_b128 v8, v[124:127] offset:21504
  v_perm_b32 v124, v73, v72, s71
  v_perm_b32 v125, v75, v74, s71
  v_perm_b32 v126, v77, v76, s71
  v_perm_b32 v127, v79, v78, s71
  ds_write_b128 v8, v[124:127] offset:22528
  v_perm_b32 v124, v81, v80, s71
  v_perm_b32 v125, v83, v82, s71
  v_perm_b32 v126, v85, v84, s71
  v_perm_b32 v127, v87, v86, s71
  ds_write_b128 v8, v[124:127] offset:23552
  s_waitcnt vmcnt(30)
  v_perm_b32 v128, v89, v88, s70
  s_waitcnt vmcnt(28)
  v_perm_b32 v129, v91, v90, s70
  s_waitcnt vmcnt(26)
  v_perm_b32 v130, v93, v92, s70
  s_waitcnt vmcnt(24)
  v_perm_b32 v131, v95, v94, s70
  s_waitcnt vmcnt(22)
  v_perm_b32 v132, v97, v96, s70
  s_waitcnt vmcnt(20)
  v_perm_b32 v133, v99, v98, s70
  s_waitcnt vmcnt(18)
  v_perm_b32 v134, v101, v100, s70
  s_waitcnt vmcnt(16)
  v_perm_b32 v135, v103, v102, s70
  v_perm_b32 v136, v89, v88, s71
  v_perm_b32 v137, v91, v90, s71
  v_perm_b32 v138, v93, v92, s71
  v_perm_b32 v139, v95, v94, s71
  v_perm_b32 v140, v97, v96, s71
  v_perm_b32 v141, v99, v98, s71
  v_perm_b32 v142, v101, v100, s71
  v_perm_b32 v143, v103, v102, s71
  s_waitcnt vmcnt(14)
  v_perm_b32 v144, v105, v104, s70
  s_waitcnt vmcnt(12)
  v_perm_b32 v145, v107, v106, s70
  s_waitcnt vmcnt(10)
  v_perm_b32 v146, v109, v108, s70
  s_waitcnt vmcnt(8)
  v_perm_b32 v147, v111, v110, s70
  s_waitcnt vmcnt(6)
  v_perm_b32 v148, v113, v112, s70
  s_waitcnt vmcnt(4)
  v_perm_b32 v149, v115, v114, s70
  s_waitcnt vmcnt(2)
  v_perm_b32 v150, v117, v116, s70
  s_waitcnt vmcnt(0)
  v_perm_b32 v151, v119, v118, s70
  v_perm_b32 v152, v105, v104, s71
  v_perm_b32 v153, v107, v106, s71
  v_perm_b32 v154, v109, v108, s71
  v_perm_b32 v155, v111, v110, s71
  v_perm_b32 v156, v113, v112, s71
  v_perm_b32 v157, v115, v114, s71
  v_perm_b32 v158, v117, v116, s71
  v_perm_b32 v159, v119, v118, s71
  ds_read_b128 v[40:43], v7 offset:0
  ds_read_b128 v[44:47], v7 offset:1024
  v_mov_b32 v24, -1
  v_mov_b32 v25, -1
  v_mov_b32 v26, -1
  v_mov_b32 v27, -1
  ds_write_b128 v7, v[24:27] offset:8192
  ds_write_b32 v14, v24 offset:17408
  ds_write_b64 v15, v[24:25]
  s_waitcnt lgkmcnt(0)
  s_barrier
  ds_read_b128 v[96:99], v8 offset:0
  ds_read_b128 v[100:103], v8 offset:1024
  ds_read_b128 v[104:107], v8 offset:2048
  ds_read_b128 v[108:111], v8 offset:3072
  ds_read_b128 v[112:115], v8 offset:4096
  ds_read_b128 v[116:119], v8 offset:5120
  ds_read_b128 v[120:123], v8 offset:6144
  ds_read_b128 v[124:127], v8 offset:7168
  v_mov_b64 v[72:73], 0
  v_mov_b64 v[74:75], 0
  v_mov_b64 v[76:77], 0
  v_mov_b64 v[78:79], 0
  v_mov_b64 v[80:81], 0
  v_mov_b64 v[82:83], 0
  v_mov_b64 v[84:85], 0
  v_mov_b64 v[86:87], 0
  v_mov_b64 v[88:89], 0
  v_mov_b64 v[90:91], 0
  v_mov_b64 v[92:93], 0
  v_mov_b64 v[94:95], 0
  s_cmp_lg_u32 s9, 0
  s_cbranch_scc1 L_c_rdy
  v_mov_b32 v20, 1
  v_mov_b32 v21, 45312
  s_mov_b64 exec, 1
    buffer_atomic_add v20, v21, s[4:7], 0 offen sc1
  s_mov_b64 exec, -1
L_c_rdy:
  s_lshl_b32 s56, s8, 7
  s_lshl_b32 s57, s9, 2
  s_add_u32 s56, s56, s57
  s_add_u32 s39, s56, 8192
  s_add_u32 s47, s56, 16384
  s_lshl_b32 s14, s8, 7
  s_add_u32 s14, s14, 8192
  v_mov_b64 v[20:21], 0
  v_mov_b64 v[22:23], 0
  ds_write_b128 v6, v[20:23] offset:21504
  s_mov_b32 m0, 21504
  v_cmp_eq_u32 vcc, 0, v1
  v_mov_b32 v0, 0x7ffffff0
  s_nop 0
  v_cndmask_b32 v10, v0, 0, vcc
  s_mov_b32 s46, 0
L_c_gb_loop:
  v_mov_b32 v1, 45440
  buffer_load_dword v16, v1, s[4:7], 0 offen sc1
  v_mov_b32 v0, 96
  buffer_load_dword v17, v0, s[52:55], 0 offen sc1
  v_mov_b32 v20, 0
  buffer_load_dword v18, v20, s[4:7], s39 offen sc1
  s_mov_b32 s57, 8388608
  buffer_load_dwordx4 v[24:27], v9, s[4:7], s57 offen sc1
  buffer_load_dwordx4 v[28:31], v9, s[4:7], s57 offen offset:1024 sc1
  s_waitcnt vmcnt(0)
  v_readfirstlane_b32 s58, v16
  v_readfirstlane_b32 s56, v17
  v_readfirstlane_b32 s37, v18
  s_nop 0
  s_cmp_lt_u32 s37, 2
  s_nop 1
  s_cbranch_scc1 L_c_gb_again
  s_cmp_ge_u32 s58, 32
  s_cbranch_scc1 L_c_gb_done
L_c_gb_again:
  s_sleep 2
  s_add_u32 s46, s46, 1
  s_cmp_lt_u32 s46, 400000
  s_cbranch_scc1 L_c_gb_loop
  s_branch L_bail
L_c_gb_done:
  s_waitcnt lgkmcnt(0)
  s_barrier
  s_memtime s[64:65]
  s_waitcnt lgkmcnt(0)
  s_cmp_lg_u32 s56, 0
  s_cbranch_scc1 L_d_step
L_c_step:
  v_smfmac_f32_16x16x64_bf16 v[72:75], v[40:43], v[96:103], v2
  s_mov_b64 vcc, s[12:13]
  v_xor_b32 v16, 2048, v7
  v_smfmac_f32_16x16x64_bf16 v[76:79], v[40:43], v[104:111], v2
  v_xor_b32 v17, 4096, v7
  v_smfmac_f32_16x16x64_bf16 v[72:75], v[44:47], v[112:119], v2
  v_xor_b32 v18, 6144, v7
  v_smfmac_f32_16x16x64_bf16 v[76:79], v[44:47], v[120:127], v2
  v_smfmac_f32_16x16x64_bf16 v[80:83], v[40:43], a[96:103], v2
  v_smfmac_f32_16x16x64_bf16 v[84:87], v[40:43], a[104:111], v2
  s_waitcnt lgkmcnt(0)
  s_barrier
  v_smfmac_f32_16x16x64_bf16 v[80:83], v[44:47], a[112:119], v2
  ds_read_b128 v[48:51], v16 offset:0
  buffer_load_dwordx4 v[32:35], v9, s[4:7], s30 offen sc1
  v_smfmac_f32_16x16x64_bf16 v[84:87], v[44:47], a[120:127], v2
  ds_read_b128 v[52:55], v16 offset:1024
  buffer_load_dwordx4 v[36:39], v9, s[4:7], s30 offen offset:1024 sc1
  v_smfmac_f32_16x16x64_bf16 v[88:91], v[40:43], a[192:199], v2
  ds_read_b128 v[56:59], v17 offset:0
  v_smfmac_f32_16x16x64_bf16 v[92:95], v[40:43], a[200:207], v2
  ds_read_b128 v[60:63], v17 offset:1024
  v_smfmac_f32_16x16x64_bf16 v[88:91], v[44:47], a[208:215], v2
  ds_read_b128 v[64:67], v18 offset:0
  v_smfmac_f32_16x16x64_bf16 v[92:95], v[44:47], a[216:223], v2
  ds_read_b128 v[68:71], v18 offset:1024
  s_waitcnt lgkmcnt(5)
  v_smfmac_f32_16x16x64_bf16 v[72:75], v[48:51], a[0:7], v2
  ds_read_b128 v[96:99], v8 offset:8192
  s_xor_b32 s27, s27, 0x2000
  v_smfmac_f32_16x16x64_bf16 v[76:79], v[48:51], a[8:15], v2
  ds_read_b128 v[100:103], v8 offset:9216
  s_waitcnt lgkmcnt(6)
  v_smfmac_f32_16x16x64_bf16 v[72:75], v[52:55], a[16:23], v2
  ds_read_b128 v[104:107], v8 offset:10240
  v_smfmac_f32_16x16x64_bf16 v[76:79], v[52:55], a[24:31], v2
  ds_read_b128 v[108:111], v8 offset:11264
  s_waitcnt lgkmcnt(7)
  v_smfmac_f32_16x16x64_bf16 v[72:75], v[56:59], a[32:39], v2
  ds_read_b128 v[112:115], v8 offset:12288
  v_smfmac_f32_16x16x64_bf16 v[76:79], v[56:59], a[40:47], v2
  ds_read_b128 v[116:119], v8 offset:13312
  s_waitcnt lgkmcnt(8)
  v_smfmac_f32_16x16x64_bf16 v[72:75], v[60:63], a[48:55], v2
  ds_read_b128 v[120:123], v8 offset:14336
  v_smfmac_f32_16x16x64_bf16 v[76:79], v[60:63], a[56:63], v2
  ds_read_b128 v[124:127], v8 offset:15360
  s_waitcnt lgkmcnt(9)
  v_smfmac_f32_16x16x64_bf16 v[72:75], v[64:67], a[64:71], v2
  v_mov_b32_e64 v0, s10
  buffer_store_dword v0, v10, s[4:7], s47 offen sc1
  v_smfmac_f32_16x16x64_bf16 v[76:79], v[64:67], a[72:79], v2
  s_waitcnt lgkmcnt(8)
  v_smfmac_f32_16x16x64_bf16 v[72:75], v[68:71], a[80:87], v2
  buffer_load_dwordx4 v10, s[4:7], s14 offen sc1 lds
  v_smfmac_f32_16x16x64_bf16 v[76:79], v[68:71], a[88:95], v2
  s_waitcnt lgkmcnt(6)
  v_smfmac_f32_16x16x64_bf16 v[80:83], v[48:51], v[96:103], v2
  s_waitcnt lgkmcnt(4)
  v_smfmac_f32_16x16x64_bf16 v[84:87], v[48:51], v[104:111], v2
  s_waitcnt lgkmcnt(2)
  v_smfmac_f32_16x16x64_bf16 v[80:83], v[52:55], v[112:119], v2
  ds_read_b128 v[96:99], v8 offset:16384
  v_cvt_pk_bf16_f32 v16, v72, v73
  s_waitcnt lgkmcnt(1)
  v_smfmac_f32_16x16x64_bf16 v[84:87], v[52:55], v[120:127], v2
  ds_read_b128 v[100:103], v8 offset:17408
  v_cvt_pk_bf16_f32 v17, v74, v75
  v_smfmac_f32_16x16x64_bf16 v[80:83], v[56:59], a[128:135], v2
  ds_read_b128 v[104:107], v8 offset:18432
  v_cvt_pk_bf16_f32 v18, v76, v77
  v_smfmac_f32_16x16x64_bf16 v[84:87], v[56:59], a[136:143], v2
  ds_read_b128 v[108:111], v8 offset:19456
  v_cvt_pk_bf16_f32 v19, v78, v79
  v_smfmac_f32_16x16x64_bf16 v[80:83], v[60:63], a[144:151], v2
  ds_read_b128 v[112:115], v8 offset:20480
  v_mfma_f32_16x16x16_bf16 v[72:75], v[16:17], v[4:5], 0
  ds_read_b128 v[116:119], v8 offset:21504
  v_mfma_f32_16x16x16_bf16 v[76:79], v[18:19], v[4:5], 0
  ds_read_b128 v[120:123], v8 offset:22528
  v_smfmac_f32_16x16x64_bf16 v[84:87], v[60:63], a[152:159], v2
  ds_read_b128 v[124:127], v8 offset:23552
  v_smfmac_f32_16x16x64_bf16 v[80:83], v[64:67], a[160:167], v2
  v_cvt_pk_bf16_f32 v16, v72, v76
  v_cvt_pk_bf16_f32 v17, v73, v77
  v_smfmac_f32_16x16x64_bf16 v[84:87], v[64:67], a[168:175], v2
  v_cvt_pk_bf16_f32 v18, v74, v78
  v_cvt_pk_bf16_f32 v19, v75, v79
  v_smfmac_f32_16x16x64_bf16 v[80:83], v[68:71], a[176:183], v2
  v_mfma_f32_16x16x32_bf16 v[72:75], v[24:27], v[16:19], 0
  v_mfma_f32_16x16x32_bf16 v[76:79], v[28:31], v[16:19], 0
  v_smfmac_f32_16x16x64_bf16 v[84:87], v[68:71], a[184:191], v2
  v_smfmac_f32_16x16x64_bf16 v[88:91], v[48:51], a[224:231], v2
  v_cndmask_b32 v72, v72, v76, vcc
  v_smfmac_f32_16x16x64_bf16 v[92:95], v[48:51], a[232:239], v2
  v_cndmask_b32 v73, v73, v77, vcc
  v_cndmask_b32 v74, v74, v78, vcc
  v_cndmask_b32_e64 v75, v75, v79, vcc
  v_cvt_pk_bf16_f32 v20, v80, v81
  v_cvt_pk_bf16_f32 v21, v82, v83
  v_cvt_pk_bf16_f32 v22, v84, v85
  v_cvt_pk_bf16_f32 v23, v86, v87
  v_mfma_f32_16x16x16_bf16 v[80:83], v[20:21], v[4:5], 0
  ds_write_b128 v7, v[72:75] offset:8192
  v_mfma_f32_16x16x16_bf16 v[84:87], v[22:23], v[4:5], 0
  s_waitcnt lgkmcnt(7)
  v_smfmac_f32_16x16x64_bf16 v[88:91], v[56:59], v[96:103], v2
  buffer_load_dwordx4 v[24:27], v9, s[4:7], s28 offen sc1
  s_waitcnt lgkmcnt(5)
  v_smfmac_f32_16x16x64_bf16 v[92:95], v[56:59], v[104:111], v2
  buffer_load_dwordx4 v[28:31], v9, s[4:7], s28 offen offset:1024 sc1
  v_cvt_pk_bf16_f32 v20, v80, v84
  v_cvt_pk_bf16_f32 v21, v81, v85
  v_cvt_pk_bf16_f32 v22, v82, v86
  v_cvt_pk_bf16_f32 v23, v83, v87
  s_nop 0
  s_nop 0
  v_mfma_f32_16x16x32_bf16 v[80:83], v[20:23], v[16:19], 0
  s_waitcnt lgkmcnt(3)
  v_smfmac_f32_16x16x64_bf16 v[88:91], v[60:63], v[112:119], v2
  ds_read_b128 v[72:75], v6 offset:8192
  s_waitcnt lgkmcnt(2)
  v_smfmac_f32_16x16x64_bf16 v[92:95], v[60:63], v[120:127], v2
  ds_read_b128 v[76:79], v6 offset:10240
  v_cndmask_b32_e64 v80, v80, v82, vcc
  ds_write_b32 v14, v80 offset:17408
  v_smfmac_f32_16x16x64_bf16 v[88:91], v[52:55], a[240:247], v2
  ds_read_b128 v[104:107], v6 offset:12288
  v_smfmac_f32_16x16x64_bf16 v[92:95], v[52:55], a[248:255], v2
  ds_read_b128 v[108:111], v6 offset:14336
  v_smfmac_f32_16x16x64_bf16 v[88:91], v[64:67], v[128:135], v2
  ds_read_b128 v[96:99], v6 offset:16384
  v_smfmac_f32_16x16x64_bf16 v[92:95], v[64:67], v[136:143], v2
  buffer_store_dwordx4 v[20:23], v12, s[4:7], s44 offen sc1
  ds_read_b128 v[84:87], v6 offset:17408
  v_smfmac_f32_16x16x64_bf16 v[88:91], v[68:71], v[144:151], v2
  s_waitcnt lgkmcnt(5)
  v_add_f32 v72, v72, v76
  v_add_f32_e64 v73, v73, v77
  v_smfmac_f32_16x16x64_bf16 v[92:95], v[68:71], v[152:159], v2
  v_add_f32 v74, v74, v78
  v_add_f32 v75, v75, v79
  s_waitcnt lgkmcnt(2)
  v_add_f32 v104, v104, v108
  v_add_f32 v105, v105, v109
  v_add_f32 v106, v106, v110
  v_add_f32 v107, v107, v111
  v_add_f32 v72, v72, v104
  v_add_f32 v73, v73, v105
  v_add_f32 v74, v74, v106
  v_add_f32_e64 v75, v75, v107
  v_max3_f32 v0, v72, v73, v74
  v_max_f32 v0, v0, v75
  s_waitcnt lgkmcnt(0)
  v_add_f32 v84, v84, v85
  v_add_f32 v86, v86, v87
  v_add_f32_e64 v84, v84, v86
  v_cmp_u_f32 s[40:41], v72, v84
  v_max_f32 v0, v0, v84
  v_add_f32 v88, v88, v89
  v_add_f32_e64 v90, v90, v91
  s_cmp_lg_u64 s[40:41], 0
  s_cbranch_scc1 L_c_xretry
L_c_xok:
  v_max_f32_dpp v0, v0, v0 quad_perm:[1,0,3,2] row_mask:0xf bank_mask:0xf
  v_mov_b32 v1, v0
  v_add_f32 v92, v92, v93
  v_add_f32 v94, v94, v95
  v_permlane16_swap_b32 v0, v1
  v_max_f32 v0, v0, v1
  v_mov_b32 v1, v0
  v_cvt_pk_bf16_f32 v88, v88, v90
  v_cvt_pk_bf16_f32 v89, v92, v94
  v_permlane32_swap_b32 v0, v1
  v_max_f32 v0, v0, v1
  v_mul_f32_e64 v0, s38, v0
  v_fma_f32 v72, v72, s38, -v0
  v_fma_f32 v73, v73, s38, -v0
  v_fma_f32 v74, v74, s38, -v0
  v_fma_f32 v75, v75, s38, -v0
  v_fma_f32 v84, v84, s38, -v0
  v_exp_f32 v72, v72
  v_exp_f32 v73, v73
  v_exp_f32 v74, v74
  v_exp_f32 v75, v75
  v_exp_f32_e64 v84, v84
  v_cvt_pk_bf16_f32 v86, v72, v73
  v_cvt_pk_bf16_f32 v87, v74, v75
  v_cvt_pk_bf16_f32 v92, v92, v94
  v_mov_b32_dpp v76, v86 quad_perm:[1,0,3,2] row_mask:0xf bank_mask:0xf
  v_mov_b32_dpp v77, v87 quad_perm:[1,0,3,2] row_mask:0xf bank_mask:0xf
  v_mov_b32_dpp v85, v84 quad_perm:[1,0,3,2] row_mask:0xf bank_mask:0xf
  v_cndmask_b32 v16, v86, v76, vcc
  v_cndmask_b32 v18, v76, v86, vcc
  v_cndmask_b32 v17, v87, v77, vcc
  v_cndmask_b32 v19, v77, v87, vcc
  v_cvt_pk_bf16_f32 v78, v84, v85
  v_cvt_pk_bf16_f32 v79, v85, v84
  v_mfma_f32_16x16x32_bf16 v[72:75], v[96:99], v[16:19], 0
  ds_read_b128 v[104:107], v8 offset:26624
  v_cndmask_b32 v78, v78, v79, vcc
  v_mov_b32_e64 v79, 0
  s_waitcnt vmcnt(6)
  v_mfma_f32_16x16x32_bf16 v[80:83], v[32:35], v[16:19], 0
  ds_read_b128 v[108:111], v8 offset:27648
  v_mov_b32 v93, 0
  s_waitcnt vmcnt(5)
  v_mfma_f32_16x16x32_bf16 v[84:87], v[36:39], v[16:19], 0
  ds_read_b128 v[112:115], v8 offset:28672
  v_mfma_f32_16x16x16_bf16 v[72:75], v[96:97], v[78:79], v[72:75]
  ds_read_b128 v[116:119], v8 offset:29696
  v_mfma_f32_16x16x16_bf16 v[80:83], v[88:89], v[78:79], v[80:83]
  ds_read_b128 v[120:123], v8 offset:30720
  v_mfma_f32_16x16x16_bf16 v[84:87], v[92:93], v[78:79], v[84:87]
  ds_read_b128 v[124:127], v8 offset:31744
  buffer_store_dwordx2 v[88:89], v13, s[4:7], s45 offen sc1
  v_rcp_f32 v1, v72
  s_nop 0
  v_cndmask_b32 v80, v80, v82, vcc
  v_cndmask_b32 v81, v81, v83, vcc
  v_mul_f32 v80, v80, v1
  v_mul_f32 v81, v81, v1
  v_cvt_pk_bf16_f32 v76, v80, v81
  v_cndmask_b32 v84, v84, v86, vcc
  v_cndmask_b32 v85, v85, v87, vcc
  v_mul_f32 v84, v84, v1
  v_mul_f32 v85, v85, v1
  v_cvt_pk_bf16_f32 v77, v84, v85
  ds_write_b64 v15, v[76:77]
  v_mov_b64 v[32:33], -1
  v_mov_b64 v[34:35], -1
  buffer_store_dwordx4 v[32:35], v6, s[4:7], s33 offen offset:0
  buffer_store_dwordx4 v[32:35], v6, s[4:7], s33 offen offset:1024
  v_mov_b64 v[40:41], 0
  v_mov_b64 v[42:43], 0
  v_mov_b64 v[44:45], 0
  v_mov_b64 v[46:47], 0
  v_mov_b64 v[48:49], 0
  v_mov_b64 v[50:51], 0
  v_mov_b64 v[52:53], 0
  v_mov_b64 v[54:55], 0
  v_mov_b64 v[56:57], 0
  v_mov_b64 v[58:59], 0
  v_mov_b64 v[60:61], 0
  v_mov_b64 v[62:63], 0
  v_mov_b64 v[64:65], 0
  v_mov_b64 v[66:67], 0
  v_mov_b64 v[68:69], 0
  v_mov_b64 v[70:71], 0
  s_waitcnt lgkmcnt(0)
  s_barrier
  ds_read_b128 v[72:75], v6 offset:18432
  s_nop 1
  ds_read_b128 v[76:79], v6 offset:19456
  s_waitcnt lgkmcnt(1)
  v_smfmac_f32_16x16x64_bf16 v[40:43], v[72:75], v[160:167], v2
  ds_read_b128 v[96:99], v8 offset:24576
  s_waitcnt lgkmcnt(1)
  v_smfmac_f32_16x16x64_bf16 v[40:43], v[76:79], v[168:175], v2
  ds_read_b128 v[100:103], v8 offset:25600
  v_smfmac_f32_16x16x64_bf16 v[44:47], v[72:75], v[176:183], v2
  v_smfmac_f32_16x16x64_bf16 v[44:47], v[76:79], v[184:191], v2
  v_add_f32 v40, v40, v41
  v_add_f32_e64 v42, v42, v43
  v_smfmac_f32_16x16x64_bf16 v[48:51], v[72:75], v[192:199], v2
  v_cvt_pk_bf16_f32 v80, v40, v42
  v_smfmac_f32_16x16x64_bf16 v[48:51], v[76:79], v[200:207], v2
  ds_write_b128 v7, v[32:35] offset:8192
  v_add_f32 v44, v44, v45
  v_add_f32 v46, v46, v47
  v_smfmac_f32_16x16x64_bf16 v[52:55], v[72:75], v[208:215], v2
  ds_write_b32 v14, v32 offset:17408
  v_cvt_pk_bf16_f32 v81, v44, v46
  v_smfmac_f32_16x16x64_bf16 v[52:55], v[76:79], v[216:223], v2
  buffer_store_dwordx2 v[80:81], v3, s[4:7], s16 offen
  v_add_f32 v48, v48, v49
  v_add_f32 v50, v50, v51
  v_smfmac_f32_16x16x64_bf16 v[56:59], v[72:75], v[224:231], v2
  v_cvt_pk_bf16_f32 v82, v48, v50
  v_smfmac_f32_16x16x64_bf16 v[56:59], v[76:79], v[232:239], v2
  v_add_f32 v52, v52, v53
  v_add_f32 v54, v54, v55
  v_smfmac_f32_16x16x64_bf16 v[60:63], v[72:75], v[240:247], v2
  v_cvt_pk_bf16_f32 v83, v52, v54
  v_smfmac_f32_16x16x64_bf16 v[60:63], v[76:79], v[248:255], v2
  buffer_store_dwordx2 v[82:83], v3, s[4:7], s17 offen
  v_add_f32 v56, v56, v57
  v_add_f32_e64 v58, v58, v59
  s_waitcnt lgkmcnt(2)
  v_smfmac_f32_16x16x64_bf16 v[64:67], v[72:75], v[96:103], v2
  v_cvt_pk_bf16_f32 v84, v56, v58
  v_smfmac_f32_16x16x64_bf16 v[64:67], v[76:79], v[104:111], v2
  v_add_f32 v60, v60, v61
  v_add_f32 v62, v62, v63
  v_smfmac_f32_16x16x64_bf16 v[68:71], v[72:75], v[112:119], v2
  v_cvt_pk_bf16_f32 v85, v60, v62
  v_smfmac_f32_16x16x64_bf16 v[68:71], v[76:79], v[120:127], v2
  buffer_store_dwordx2 v[84:85], v3, s[4:7], s22 offen
  v_add_f32 v64, v64, v65
  v_add_f32_e64 v66, v66, v67
  s_nop 0
  v_cvt_pk_bf16_f32 v86, v64, v66
  s_nop 2
  v_add_f32 v68, v68, v69
  v_add_f32_e64 v70, v70, v71
  v_cvt_pk_bf16_f32 v87, v68, v70
  buffer_store_dwordx2 v[86:87], v3, s[4:7], s23 offen
  s_add_u32 s28, s28, 8192
  s_add_u32 s30, s30, 8192
  s_add_u32 s31, s31, 65536
  s_add_u32 s32, s32, 65536
  s_add_u32 s10, s10, 1
  s_add_u32 s44, s31, s42
  s_add_u32 s45, s32, s43
  s_cmp_lg_u32 s9, 0
  s_cbranch_scc1 L_c_b0
  v_add_u32 v0, 20480, v6
  ds_read_b128 v[72:75], v0
  v_mov_b64 v[88:89], -1
  s_mov_b32 s46, 0
  s_sleep 1
  s_sleep 1
  s_sleep 1
  s_nop 15
  s_nop 2
  buffer_load_dwordx4 v[40:43], v6, s[4:7], s24 offen offset:0 sc1
  buffer_load_dwordx4 v[44:47], v6, s[4:7], s24 offen offset:1024 sc1
  buffer_load_dwordx4 v[48:51], v6, s[4:7], s24 offen offset:2048 sc1
  buffer_load_dwordx4 v[52:55], v6, s[4:7], s24 offen offset:3072 sc1
  buffer_load_dwordx4 v[56:59], v6, s[4:7], s25 offen offset:0 sc1
  buffer_load_dwordx4 v[60:63], v6, s[4:7], s25 offen offset:1024 sc1
  buffer_load_dwordx4 v[64:67], v6, s[4:7], s25 offen offset:2048 sc1
  buffer_load_dwordx4 v[68:71], v6, s[4:7], s25 offen offset:3072 sc1
  s_sleep 1
  s_nop 15
  buffer_load_dwordx4 v[96:99], v6, s[4:7], s24 offen offset:0 sc1
  buffer_load_dwordx4 v[100:103], v6, s[4:7], s24 offen offset:1024 sc1
  buffer_load_dwordx4 v[104:107], v6, s[4:7], s24 offen offset:2048 sc1
  buffer_load_dwordx4 v[108:111], v6, s[4:7], s24 offen offset:3072 sc1
  buffer_load_dwordx4 v[112:115], v6, s[4:7], s25 offen offset:0 sc1
  buffer_load_dwordx4 v[116:119], v6, s[4:7], s25 offen offset:1024 sc1
  buffer_load_dwordx4 v[120:123], v6, s[4:7], s25 offen offset:2048 sc1
  buffer_load_dwordx4 v[124:127], v6, s[4:7], s25 offen offset:3072 sc1
  s_waitcnt lgkmcnt(0)
L_c_rA:
  s_waitcnt vmcnt(15)
  v_mfma_f32_16x16x32_bf16 v[76:79], v[40:43], v[72:75], 0
  v_max_u32 v90, v40, v42
  s_waitcnt vmcnt(14)
  v_mfma_f32_16x16x32_bf16 v[76:79], v[44:47], v[72:75], v[76:79]
  v_max3_u32 v90, v90, v44, v46
  s_waitcnt vmcnt(13)
  v_mfma_f32_16x16x32_bf16 v[76:79], v[48:51], v[72:75], v[76:79]
  v_max3_u32 v90, v90, v48, v50
  s_waitcnt vmcnt(12)
  v_mfma_f32_16x16x32_bf16 v[76:79], v[52:55], v[72:75], v[76:79]
  v_max3_u32 v90, v90, v52, v54
  s_waitcnt vmcnt(11)
  v_mfma_f32_16x16x32_bf16 v[76:79], v[56:59], v[72:75], v[76:79]
  v_max3_u32 v90, v90, v56, v58
  s_waitcnt vmcnt(10)
  v_mfma_f32_16x16x32_bf16 v[76:79], v[60:63], v[72:75], v[76:79]
  v_max3_u32 v90, v90, v60, v62
  s_waitcnt vmcnt(9)
  v_mfma_f32_16x16x32_bf16 v[76:79], v[64:67], v[72:75], v[76:79]
  v_max3_u32 v90, v90, v64, v66
  s_waitcnt vmcnt(8)
  v_mfma_f32_16x16x32_bf16 v[76:79], v[68:71], v[72:75], v[76:79]
  v_max3_u32 v90, v90, v68, v70
  v_cmp_eq_u32_e64 vcc, -1, v90
  s_nop 4
  s_cbranch_vccnz L_c_rAfail
  v_cvt_pk_bf16_f32 v76, v76, v77
  v_cvt_pk_bf16_f32 v77, v78, v79
  buffer_store_dwordx2 v[76:77], v11, s[4:7], s26 offen
  buffer_store_dwordx2 v[88:89], v11, s[4:7], s34 offen
L_c_rdone:
L_c_b0:
  s_barrier
  s_xor_b32 s26, s26, 0x2000
  s_xor_b32 s34, s34, 0x2000
  s_add_u32 s35, s35, 1
  s_cmp_eq_u32 s35, 3
  s_cselect_b32 s35, 0, s35
  s_lshl_b32 s62, s35, 18
  s_add_u32 s62, s62, 262144
  s_add_u32 s16, s62, s18
  s_add_u32 s17, s16, 16384
  s_add_u32 s22, s16, 32768
  s_add_u32 s23, s16, 49152
  s_add_u32 s24, s62, s20
  s_add_u32 s25, s24, 4096
  s_add_u32 s61, s35, 2
  s_cmp_ge_u32 s61, 3
  s_cselect_b32 s60, 3, 0
  s_sub_u32 s61, s61, s60
  s_lshl_b32 s61, s61, 18
  s_add_u32 s61, s61, 262144
  s_add_u32 s33, s61, s21
  s_mov_b32 s46, 0
  s_nop 4
  buffer_load_dwordx4 v[40:43], v6, s[4:7], s27 offen sc1
  buffer_load_dwordx4 v[44:47], v6, s[4:7], s27 offen offset:1024 sc1
  ds_read_b128 v[84:87], v6 offset:21504
  s_add_u32 s56, s10, 2
  s_min_u32 s56, s56, 64
  s_waitcnt lgkmcnt(0)
  v_readlane_b32 s57, v84, 0
  v_readlane_b32 s58, v85, 0
  v_readlane_b32 s59, v86, 0
  v_readlane_b32 s60, v87, 0
  s_min_u32 s57, s57, s58
  s_min_u32 s59, s59, s60
  s_min_u32 s57, s57, s59
  s_max_u32 s37, s37, s57
  s_cmp_lt_u32 s37, s56
  s_cbranch_scc1 L_c_needslow
L_c_needok:
  s_waitcnt vmcnt(2)
  v_mov_b64 v[72:73], 0
  v_mov_b64 v[74:75], 0
  v_mov_b64 v[76:77], 0
  v_mov_b64 v[78:79], 0
  v_mov_b64 v[80:81], 0
  v_mov_b64 v[82:83], 0
  v_mov_b64 v[84:85], 0
  v_mov_b64 v[86:87], 0
  v_mov_b64 v[88:89], 0
  v_mov_b64 v[90:91], 0
  v_mov_b64 v[92:93], 0
  v_mov_b64_e64 v[94:95], 0
  ds_read_b128 v[96:99], v8 offset:0
  ds_read_b128 v[100:103], v8 offset:1024
  ds_read_b128 v[104:107], v8 offset:2048
  ds_read_b128 v[108:111], v8 offset:3072
  ds_read_b128 v[112:115], v8 offset:4096
  ds_read_b128 v[116:119], v8 offset:5120
  ds_read_b128 v[120:123], v8 offset:6144
  ds_read_b128 v[124:127], v8 offset:7168
  s_nop 6
  buffer_load_dwordx4 v[32:35], v6, s[4:7], s27 offen sc1
  buffer_load_dwordx4 v[36:39], v6, s[4:7], s27 offen offset:1024 sc1
L_c_pA:
  s_waitcnt vmcnt(2)
  ds_write_b128 v7, v[40:43] offset:0
  ds_write_b128 v7, v[44:47] offset:1024
  v_max3_u32 v0, v40, v42, v44
  v_max_u32 v0, v0, v46
  v_cmp_eq_u32 vcc, -1, v0
  s_cbranch_vccnz L_c_pAfail
L_c_pdone:
  s_waitcnt lgkmcnt(2)
  s_cmp_lt_u32 s10, 63
  s_nop 0
  s_cbranch_scc1 L_c_step
L_c_last:
  s_add_u32 s42, s31, s42
  s_add_u32 s43, s32, s43
  v_xor_b32 v16, 2048, v7
  v_xor_b32 v17, 4096, v7
  v_xor_b32 v18, 6144, v7
  s_waitcnt vmcnt(0) lgkmcnt(0)
  s_barrier
  ds_read_b128 v[48:51], v16 offset:0
  ds_read_b128 v[52:55], v16 offset:1024
  ds_read_b128 v[56:59], v17 offset:0
  ds_read_b128 v[60:63], v17 offset:1024
  ds_read_b128 v[64:67], v18 offset:0
  ds_read_b128 v[68:71], v18 offset:1024
  ds_read_b128 v[96:99], v8 offset:8192
  ds_read_b128 v[100:103], v8 offset:9216
  ds_read_b128 v[104:107], v8 offset:10240
  ds_read_b128 v[108:111], v8 offset:11264
  ds_read_b128 v[112:115], v8 offset:12288
  ds_read_b128 v[116:119], v8 offset:13312
  ds_read_b128 v[120:123], v8 offset:14336
  ds_read_b128 v[124:127], v8 offset:15360
  v_smfmac_f32_16x16x64_bf16 v[80:83], v[40:43], a[96:103], v2
  v_smfmac_f32_16x16x64_bf16 v[84:87], v[40:43], a[104:111], v2
  v_smfmac_f32_16x16x64_bf16 v[80:83], v[44:47], a[112:119], v2
  v_smfmac_f32_16x16x64_bf16 v[84:87], v[44:47], a[120:127], v2
  s_waitcnt lgkmcnt(6)
  v_smfmac_f32_16x16x64_bf16 v[80:83], v[48:51], v[96:103], v2
  s_waitcnt lgkmcnt(4)
  v_smfmac_f32_16x16x64_bf16 v[84:87], v[48:51], v[104:111], v2
  s_waitcnt lgkmcnt(2)
  v_smfmac_f32_16x16x64_bf16 v[80:83], v[52:55], v[112:119], v2
  s_waitcnt lgkmcnt(0)
  v_smfmac_f32_16x16x64_bf16 v[84:87], v[52:55], v[120:127], v2
  v_smfmac_f32_16x16x64_bf16 v[80:83], v[56:59], a[128:135], v2
  v_smfmac_f32_16x16x64_bf16 v[84:87], v[56:59], a[136:143], v2
  v_smfmac_f32_16x16x64_bf16 v[80:83], v[60:63], a[144:151], v2
  v_smfmac_f32_16x16x64_bf16 v[84:87], v[60:63], a[152:159], v2
  v_smfmac_f32_16x16x64_bf16 v[80:83], v[64:67], a[160:167], v2
  v_smfmac_f32_16x16x64_bf16 v[84:87], v[64:67], a[168:175], v2
  v_smfmac_f32_16x16x64_bf16 v[80:83], v[68:71], a[176:183], v2
  v_smfmac_f32_16x16x64_bf16 v[84:87], v[68:71], a[184:191], v2
  ds_read_b128 v[96:99], v8 offset:16384
  ds_read_b128 v[100:103], v8 offset:17408
  ds_read_b128 v[104:107], v8 offset:18432
  ds_read_b128 v[108:111], v8 offset:19456
  ds_read_b128 v[112:115], v8 offset:20480
  ds_read_b128 v[116:119], v8 offset:21504
  ds_read_b128 v[120:123], v8 offset:22528
  ds_read_b128 v[124:127], v8 offset:23552
  v_cvt_pk_bf16_f32 v20, v80, v81
  v_cvt_pk_bf16_f32 v21, v82, v83
  v_cvt_pk_bf16_f32 v22, v84, v85
  v_cvt_pk_bf16_f32 v23, v86, v87
  v_mfma_f32_16x16x16_bf16 v[80:83], v[20:21], v[4:5], 0
  v_mfma_f32_16x16x16_bf16 v[84:87], v[22:23], v[4:5], 0
  v_smfmac_f32_16x16x64_bf16 v[88:91], v[40:43], a[192:199], v2
  v_smfmac_f32_16x16x64_bf16 v[92:95], v[40:43], a[200:207], v2
  v_smfmac_f32_16x16x64_bf16 v[88:91], v[44:47], a[208:215], v2
  v_smfmac_f32_16x16x64_bf16 v[92:95], v[44:47], a[216:223], v2
  v_smfmac_f32_16x16x64_bf16 v[88:91], v[48:51], a[224:231], v2
  v_smfmac_f32_16x16x64_bf16 v[92:95], v[48:51], a[232:239], v2
  v_smfmac_f32_16x16x64_bf16 v[88:91], v[52:55], a[240:247], v2
  v_smfmac_f32_16x16x64_bf16 v[92:95], v[52:55], a[248:255], v2
  v_smfmac_f32_16x16x64_bf16 v[88:91], v[64:67], v[128:135], v2
  v_smfmac_f32_16x16x64_bf16 v[92:95], v[64:67], v[136:143], v2
  v_smfmac_f32_16x16x64_bf16 v[88:91], v[68:71], v[144:151], v2
  v_smfmac_f32_16x16x64_bf16 v[92:95], v[68:71], v[152:159], v2
  s_waitcnt lgkmcnt(6)
  v_smfmac_f32_16x16x64_bf16 v[88:91], v[56:59], v[96:103], v2
  s_waitcnt lgkmcnt(4)
  v_smfmac_f32_16x16x64_bf16 v[92:95], v[56:59], v[104:111], v2
  s_waitcnt lgkmcnt(2)
  v_smfmac_f32_16x16x64_bf16 v[88:91], v[60:63], v[112:119], v2
  s_waitcnt lgkmcnt(0)
  v_smfmac_f32_16x16x64_bf16 v[92:95], v[60:63], v[120:127], v2
  v_cvt_pk_bf16_f32 v20, v80, v84
  v_cvt_pk_bf16_f32 v21, v81, v85
  v_cvt_pk_bf16_f32 v22, v82, v86
  v_cvt_pk_bf16_f32 v23, v83, v87
  buffer_store_dwordx4 v[20:23], v12, s[4:7], s42 offen sc1
  v_add_f32 v88, v88, v89
  v_add_f32 v90, v90, v91
  s_nop 0
  v_add_f32 v92, v92, v93
  v_add_f32 v94, v94, v95
  v_cvt_pk_bf16_f32 v88, v88, v90
  v_cvt_pk_bf16_f32 v89, v92, v94
  buffer_store_dwordx2 v[88:89], v13, s[4:7], s43 offen sc1
  s_waitcnt vmcnt(0) lgkmcnt(0)
  v_mov_b32 v0, 64
  buffer_store_dword v0, v10, s[4:7], s47 offen sc1
  s_waitcnt vmcnt(0)
  s_branch L_c_fin
L_c_rAfail:
  s_add_u32 s46, s46, 1
  s_cmp_ge_u32 s46, 20000
  s_cbranch_scc1 L_bail
  buffer_load_dwordx4 v[40:43], v6, s[4:7], s24 offen offset:0 sc1
  buffer_load_dwordx4 v[44:47], v6, s[4:7], s24 offen offset:1024 sc1
  buffer_load_dwordx4 v[48:51], v6, s[4:7], s24 offen offset:2048 sc1
  buffer_load_dwordx4 v[52:55], v6, s[4:7], s24 offen offset:3072 sc1
  buffer_load_dwordx4 v[56:59], v6, s[4:7], s25 offen offset:0 sc1
  buffer_load_dwordx4 v[60:63], v6, s[4:7], s25 offen offset:1024 sc1
  buffer_load_dwordx4 v[64:67], v6, s[4:7], s25 offen offset:2048 sc1
  buffer_load_dwordx4 v[68:71], v6, s[4:7], s25 offen offset:3072 sc1
  s_waitcnt vmcnt(15)
  v_mfma_f32_16x16x32_bf16 v[80:83], v[96:99], v[72:75], 0
  v_max_u32 v90, v96, v98
  s_waitcnt vmcnt(14)
  v_mfma_f32_16x16x32_bf16 v[80:83], v[100:103], v[72:75], v[80:83]
  v_max3_u32 v90, v90, v100, v102
  s_waitcnt vmcnt(13)
  v_mfma_f32_16x16x32_bf16 v[80:83], v[104:107], v[72:75], v[80:83]
  v_max3_u32 v90, v90, v104, v106
  s_waitcnt vmcnt(12)
  v_mfma_f32_16x16x32_bf16 v[80:83], v[108:111], v[72:75], v[80:83]
  v_max3_u32 v90, v90, v108, v110
  s_waitcnt vmcnt(11)
  v_mfma_f32_16x16x32_bf16 v[80:83], v[112:115], v[72:75], v[80:83]
  v_max3_u32 v90, v90, v112, v114
  s_waitcnt vmcnt(10)
  v_mfma_f32_16x16x32_bf16 v[80:83], v[116:119], v[72:75], v[80:83]
  v_max3_u32 v90, v90, v116, v118
  s_waitcnt vmcnt(9)
  v_mfma_f32_16x16x32_bf16 v[80:83], v[120:123], v[72:75], v[80:83]
  v_max3_u32 v90, v90, v120, v122
  s_waitcnt vmcnt(8)
  v_mfma_f32_16x16x32_bf16 v[80:83], v[124:127], v[72:75], v[80:83]
  v_max3_u32 v90, v90, v124, v126
  v_cmp_eq_u32 vcc, -1, v90
  s_nop 4
  s_cbranch_vccnz L_c_rBfail
  v_cvt_pk_bf16_f32 v80, v80, v81
  v_cvt_pk_bf16_f32 v81, v82, v83
  buffer_store_dwordx2 v[80:81], v11, s[4:7], s26 offen
  buffer_store_dwordx2 v[88:89], v11, s[4:7], s34 offen
  s_branch L_c_rdone
L_c_rBfail:
  buffer_load_dwordx4 v[96:99], v6, s[4:7], s24 offen offset:0 sc1
  buffer_load_dwordx4 v[100:103], v6, s[4:7], s24 offen offset:1024 sc1
  buffer_load_dwordx4 v[104:107], v6, s[4:7], s24 offen offset:2048 sc1
  buffer_load_dwordx4 v[108:111], v6, s[4:7], s24 offen offset:3072 sc1
  buffer_load_dwordx4 v[112:115], v6, s[4:7], s25 offen offset:0 sc1
  buffer_load_dwordx4 v[116:119], v6, s[4:7], s25 offen offset:1024 sc1
  buffer_load_dwordx4 v[120:123], v6, s[4:7], s25 offen offset:2048 sc1
  buffer_load_dwordx4 v[124:127], v6, s[4:7], s25 offen offset:3072 sc1
  s_branch L_c_rA
L_c_pAfail:
  s_add_u32 s46, s46, 1
  s_cmp_ge_u32 s46, 20000
  s_cbranch_scc1 L_bail
  buffer_load_dwordx4 v[40:43], v6, s[4:7], s27 offen sc1
  buffer_load_dwordx4 v[44:47], v6, s[4:7], s27 offen offset:1024 sc1
  s_waitcnt vmcnt(2)
  ds_write_b128 v7, v[32:35] offset:0
  ds_write_b128 v7, v[36:39] offset:1024
  v_max3_u32 v0, v32, v34, v36
  v_max_u32 v0, v0, v38
  v_cmp_eq_u32 vcc, -1, v0
  s_cbranch_vccnz L_c_pBfail
  s_waitcnt vmcnt(0)
  s_nop 1
  s_branch L_c_pdone
L_c_pBfail:
  buffer_load_dwordx4 v[32:35], v6, s[4:7], s27 offen sc1
  buffer_load_dwordx4 v[36:39], v6, s[4:7], s27 offen offset:1024 sc1
  s_branch L_c_pA
L_c_xretry:
  s_nop 15
  s_mov_b32 s46, 0
L_c_xr_loop:
  ds_read_b128 v[72:75], v6 offset:8192
  ds_read_b128 v[76:79], v6 offset:10240
  ds_read_b128 v[104:107], v6 offset:12288
  ds_read_b128 v[108:111], v6 offset:14336
  ds_read_b128 v[84:87], v6 offset:17408
  s_waitcnt lgkmcnt(0)
  v_max3_u32 v1, v84, v85, v86
  v_max_u32 v1, v1, v87
  v_max3_u32 v1, v1, v72, v73
  v_max3_u32 v1, v1, v74, v75
  v_max3_u32 v1, v1, v76, v77
  v_max3_u32 v1, v1, v78, v79
  v_max3_u32 v1, v1, v104, v105
  v_max3_u32 v1, v1, v106, v107
  v_max3_u32 v1, v1, v108, v109
  v_max3_u32 v1, v1, v110, v111
  v_cmp_eq_u32 vcc, -1, v1
  s_cbranch_vccz L_c_xr_ok
  s_add_u32 s46, s46, 1
  s_cmp_lt_u32 s46, 20000
  s_nop 0
  s_cbranch_scc1 L_c_xr_loop
  s_branch L_bail
L_c_xr_ok:
  v_add_f32 v72, v72, v76
  v_add_f32 v73, v73, v77
  v_add_f32 v74, v74, v78
  v_add_f32 v75, v75, v79
  v_add_f32 v104, v104, v108
  v_add_f32 v105, v105, v109
  v_add_f32 v106, v106, v110
  v_add_f32 v107, v107, v111
  v_add_f32 v72, v72, v104
  v_add_f32 v73, v73, v105
  v_add_f32 v74, v74, v106
  v_add_f32 v75, v75, v107
  v_max3_f32 v0, v72, v73, v74
  v_max_f32 v0, v0, v75
  v_add_f32 v84, v84, v85
  v_add_f32 v86, v86, v87
  v_add_f32 v84, v84, v86
  v_max_f32 v0, v0, v84
  s_mov_b64 vcc, s[12:13]
  s_branch L_c_xok
L_c_needslow:
  s_mov_b32 s95, s56
  s_mov_b32 s46, 0
L_cncs:
  v_mov_b32 v1, 0
  buffer_load_dword v0, v1, s[4:7], s39 offen sc1
  s_waitcnt vmcnt(0)
  v_readfirstlane_b32 s37, v0
  s_nop 0
  s_cmp_ge_u32 s37, s95
  s_nop 1
  s_cbranch_scc1 L_cncsd
  s_sleep 2
  s_add_u32 s46, s46, 1
  s_cmp_lt_u32 s46, 400000
  s_cbranch_scc1 L_cncs
  s_branch L_bail
L_cncsd:
  s_branch L_c_needok
  s_nop 0
L_d_step:
  v_smfmac_f32_16x16x64_bf16 v[72:75], v[40:43], v[96:103], v2
  s_mov_b64 vcc, s[12:13]
  v_xor_b32 v16, 2048, v7
  v_smfmac_f32_16x16x64_bf16 v[76:79], v[40:43], v[104:111], v2
  v_xor_b32 v17, 4096, v7
  v_smfmac_f32_16x16x64_bf16 v[72:75], v[44:47], v[112:119], v2
  v_xor_b32 v18, 6144, v7
  v_smfmac_f32_16x16x64_bf16 v[76:79], v[44:47], v[120:127], v2
  v_smfmac_f32_16x16x64_bf16 v[80:83], v[40:43], a[96:103], v2
  v_smfmac_f32_16x16x64_bf16 v[84:87], v[40:43], a[104:111], v2
  s_waitcnt lgkmcnt(0)
  s_barrier
  v_smfmac_f32_16x16x64_bf16 v[80:83], v[44:47], a[112:119], v2
  ds_read_b128 v[48:51], v16 offset:0
  buffer_load_dwordx4 v[32:35], v9, s[4:7], s30 offen sc1
  v_smfmac_f32_16x16x64_bf16 v[84:87], v[44:47], a[120:127], v2
  ds_read_b128 v[52:55], v16 offset:1024
  buffer_load_dwordx4 v[36:39], v9, s[4:7], s30 offen offset:1024 sc1
  v_smfmac_f32_16x16x64_bf16 v[88:91], v[40:43], a[192:199], v2
  ds_read_b128 v[56:59], v17 offset:0
  v_smfmac_f32_16x16x64_bf16 v[92:95], v[40:43], a[200:207], v2
  ds_read_b128 v[60:63], v17 offset:1024
  v_smfmac_f32_16x16x64_bf16 v[88:91], v[44:47], a[208:215], v2
  ds_read_b128 v[64:67], v18 offset:0
  v_smfmac_f32_16x16x64_bf16 v[92:95], v[44:47], a[216:223], v2
  ds_read_b128 v[68:71], v18 offset:1024
  s_waitcnt lgkmcnt(5)
  v_smfmac_f32_16x16x64_bf16 v[72:75], v[48:51], a[0:7], v2
  ds_read_b128 v[96:99], v8 offset:8192
  s_xor_b32 s27, s27, 0x2000
  v_smfmac_f32_16x16x64_bf16 v[76:79], v[48:51], a[8:15], v2
  ds_read_b128 v[100:103], v8 offset:9216
  s_waitcnt lgkmcnt(6)
  v_smfmac_f32_16x16x64_bf16 v[72:75], v[52:55], a[16:23], v2
  ds_read_b128 v[104:107], v8 offset:10240
  v_smfmac_f32_16x16x64_bf16 v[76:79], v[52:55], a[24:31], v2
  ds_read_b128 v[108:111], v8 offset:11264
  s_waitcnt lgkmcnt(7)
  v_smfmac_f32_16x16x64_bf16 v[72:75], v[56:59], a[32:39], v2
  ds_read_b128 v[112:115], v8 offset:12288
  v_smfmac_f32_16x16x64_bf16 v[76:79], v[56:59], a[40:47], v2
  ds_read_b128 v[116:119], v8 offset:13312
  s_waitcnt lgkmcnt(8)
  v_smfmac_f32_16x16x64_bf16 v[72:75], v[60:63], a[48:55], v2
  ds_read_b128 v[120:123], v8 offset:14336
  v_smfmac_f32_16x16x64_bf16 v[76:79], v[60:63], a[56:63], v2
  ds_read_b128 v[124:127], v8 offset:15360
  s_waitcnt lgkmcnt(9)
  v_smfmac_f32_16x16x64_bf16 v[72:75], v[64:67], a[64:71], v2
  v_mov_b32_e64 v0, s10
  buffer_store_dword v0, v10, s[4:7], s47 offen sc1
  v_smfmac_f32_16x16x64_bf16 v[76:79], v[64:67], a[72:79], v2
  s_waitcnt lgkmcnt(8)
  v_smfmac_f32_16x16x64_bf16 v[72:75], v[68:71], a[80:87], v2
  buffer_load_dwordx4 v10, s[4:7], s14 offen sc1 lds
  v_smfmac_f32_16x16x64_bf16 v[76:79], v[68:71], a[88:95], v2
  s_waitcnt lgkmcnt(6)
  v_smfmac_f32_16x16x64_bf16 v[80:83], v[48:51], v[96:103], v2
  s_waitcnt lgkmcnt(4)
  v_smfmac_f32_16x16x64_bf16 v[84:87], v[48:51], v[104:111], v2
  s_waitcnt lgkmcnt(2)
  v_smfmac_f32_16x16x64_bf16 v[80:83], v[52:55], v[112:119], v2
  ds_read_b128 v[96:99], v8 offset:16384
  v_cvt_pk_bf16_f32 v16, v72, v73
  s_waitcnt lgkmcnt(1)
  v_smfmac_f32_16x16x64_bf16 v[84:87], v[52:55], v[120:127], v2
  ds_read_b128 v[100:103], v8 offset:17408
  v_cvt_pk_bf16_f32 v17, v74, v75
  v_smfmac_f32_16x16x64_bf16 v[80:83], v[56:59], a[128:135], v2
  ds_read_b128 v[104:107], v8 offset:18432
  v_cvt_pk_bf16_f32 v18, v76, v77
  v_smfmac_f32_16x16x64_bf16 v[84:87], v[56:59], a[136:143], v2
  ds_read_b128 v[108:111], v8 offset:19456
  v_cvt_pk_bf16_f32 v19, v78, v79
  v_smfmac_f32_16x16x64_bf16 v[80:83], v[60:63], a[144:151], v2
  ds_read_b128 v[112:115], v8 offset:20480
  v_mfma_f32_16x16x16_bf16 v[72:75], v[16:17], v[4:5], 0
  ds_read_b128 v[116:119], v8 offset:21504
  v_mfma_f32_16x16x16_bf16 v[76:79], v[18:19], v[4:5], 0
  ds_read_b128 v[120:123], v8 offset:22528
  v_smfmac_f32_16x16x64_bf16 v[84:87], v[60:63], a[152:159], v2
  ds_read_b128 v[124:127], v8 offset:23552
  v_smfmac_f32_16x16x64_bf16 v[80:83], v[64:67], a[160:167], v2
  v_cvt_pk_bf16_f32 v16, v72, v76
  v_cvt_pk_bf16_f32 v17, v73, v77
  v_smfmac_f32_16x16x64_bf16 v[84:87], v[64:67], a[168:175], v2
  v_cvt_pk_bf16_f32 v18, v74, v78
  v_cvt_pk_bf16_f32 v19, v75, v79
  v_smfmac_f32_16x16x64_bf16 v[80:83], v[68:71], a[176:183], v2
  v_mfma_f32_16x16x32_bf16 v[72:75], v[24:27], v[16:19], 0
  v_mfma_f32_16x16x32_bf16 v[76:79], v[28:31], v[16:19], 0
  v_smfmac_f32_16x16x64_bf16 v[84:87], v[68:71], a[184:191], v2
  v_smfmac_f32_16x16x64_bf16 v[88:91], v[48:51], a[224:231], v2
  v_cndmask_b32 v72, v72, v76, vcc
  v_smfmac_f32_16x16x64_bf16 v[92:95], v[48:51], a[232:239], v2
  v_cndmask_b32 v73, v73, v77, vcc
  v_cndmask_b32 v74, v74, v78, vcc
  v_cndmask_b32_e64 v75, v75, v79, vcc
  v_cvt_pk_bf16_f32 v20, v80, v81
  v_cvt_pk_bf16_f32 v21, v82, v83
  v_cvt_pk_bf16_f32 v22, v84, v85
  v_cvt_pk_bf16_f32 v23, v86, v87
  v_mfma_f32_16x16x16_bf16 v[80:83], v[20:21], v[4:5], 0
  ds_write_b128 v7, v[72:75] offset:8192
  v_mfma_f32_16x16x16_bf16 v[84:87], v[22:23], v[4:5], 0
  s_waitcnt lgkmcnt(7)
  v_smfmac_f32_16x16x64_bf16 v[88:91], v[56:59], v[96:103], v2
  buffer_load_dwordx4 v[24:27], v9, s[4:7], s28 offen sc1
  s_waitcnt lgkmcnt(5)
  v_smfmac_f32_16x16x64_bf16 v[92:95], v[56:59], v[104:111], v2
  buffer_load_dwordx4 v[28:31], v9, s[4:7], s28 offen offset:1024 sc1
  v_cvt_pk_bf16_f32 v20, v80, v84
  v_cvt_pk_bf16_f32 v21, v81, v85
  v_cvt_pk_bf16_f32 v22, v82, v86
  v_cvt_pk_bf16_f32 v23, v83, v87
  s_nop 0
  s_nop 0
  v_mfma_f32_16x16x32_bf16 v[80:83], v[20:23], v[16:19], 0
  s_waitcnt lgkmcnt(3)
  v_smfmac_f32_16x16x64_bf16 v[88:91], v[60:63], v[112:119], v2
  ds_read_b128 v[72:75], v6 offset:8192
  s_waitcnt lgkmcnt(2)
  v_smfmac_f32_16x16x64_bf16 v[92:95], v[60:63], v[120:127], v2
  ds_read_b128 v[76:79], v6 offset:10240
  v_cndmask_b32_e64 v80, v80, v82, vcc
  ds_write_b32 v14, v80 offset:17408
  v_smfmac_f32_16x16x64_bf16 v[88:91], v[52:55], a[240:247], v2
  ds_read_b128 v[104:107], v6 offset:12288
  v_smfmac_f32_16x16x64_bf16 v[92:95], v[52:55], a[248:255], v2
  ds_read_b128 v[108:111], v6 offset:14336
  v_smfmac_f32_16x16x64_bf16 v[88:91], v[64:67], v[128:135], v2
  ds_read_b128 v[96:99], v6 offset:16384
  v_smfmac_f32_16x16x64_bf16 v[92:95], v[64:67], v[136:143], v2
  buffer_store_dwordx4 v[20:23], v12, s[4:7], s44 offen sc1
  ds_read_b128 v[84:87], v6 offset:17408
  v_smfmac_f32_16x16x64_bf16 v[88:91], v[68:71], v[144:151], v2
  s_waitcnt lgkmcnt(5)
  v_add_f32 v72, v72, v76
  v_add_f32_e64 v73, v73, v77
  v_smfmac_f32_16x16x64_bf16 v[92:95], v[68:71], v[152:159], v2
  v_add_f32 v74, v74, v78
  v_add_f32 v75, v75, v79
  s_waitcnt lgkmcnt(2)
  v_add_f32 v104, v104, v108
  v_add_f32 v105, v105, v109
  v_add_f32 v106, v106, v110
  v_add_f32 v107, v107, v111
  v_add_f32 v72, v72, v104
  v_add_f32 v73, v73, v105
  v_add_f32 v74, v74, v106
  v_add_f32_e64 v75, v75, v107
  v_max3_f32 v0, v72, v73, v74
  v_max_f32 v0, v0, v75
  s_waitcnt lgkmcnt(0)
  v_add_f32 v84, v84, v85
  v_add_f32 v86, v86, v87
  v_add_f32_e64 v84, v84, v86
  v_cmp_u_f32 s[40:41], v72, v84
  v_max_f32 v0, v0, v84
  v_add_f32 v88, v88, v89
  v_add_f32_e64 v90, v90, v91
  s_cmp_lg_u64 s[40:41], 0
  s_cbranch_scc1 L_d_xretry
L_d_xok:
  v_max_f32_dpp v0, v0, v0 quad_perm:[1,0,3,2] row_mask:0xf bank_mask:0xf
  v_mov_b32 v1, v0
  v_add_f32 v92, v92, v93
  v_add_f32 v94, v94, v95
  v_permlane16_swap_b32 v0, v1
  v_max_f32 v0, v0, v1
  v_mov_b32 v1, v0
  v_cvt_pk_bf16_f32 v88, v88, v90
  v_cvt_pk_bf16_f32 v89, v92, v94
  v_permlane32_swap_b32 v0, v1
  v_max_f32 v0, v0, v1
  v_mul_f32_e64 v0, s38, v0
  v_fma_f32 v72, v72, s38, -v0
  v_fma_f32 v73, v73, s38, -v0
  v_fma_f32 v74, v74, s38, -v0
  v_fma_f32 v75, v75, s38, -v0
  v_fma_f32 v84, v84, s38, -v0
  v_exp_f32 v72, v72
  v_exp_f32 v73, v73
  v_exp_f32 v74, v74
  v_exp_f32 v75, v75
  v_exp_f32_e64 v84, v84
  v_cvt_pk_bf16_f32 v86, v72, v73
  v_cvt_pk_bf16_f32 v87, v74, v75
  v_cvt_pk_bf16_f32 v92, v92, v94
  v_mov_b32_dpp v76, v86 quad_perm:[1,0,3,2] row_mask:0xf bank_mask:0xf
  v_mov_b32_dpp v77, v87 quad_perm:[1,0,3,2] row_mask:0xf bank_mask:0xf
  v_mov_b32_dpp v85, v84 quad_perm:[1,0,3,2] row_mask:0xf bank_mask:0xf
  v_cndmask_b32 v16, v86, v76, vcc
  v_cndmask_b32 v18, v76, v86, vcc
  v_cndmask_b32 v17, v87, v77, vcc
  v_cndmask_b32 v19, v77, v87, vcc
  v_cvt_pk_bf16_f32 v78, v84, v85
  v_cvt_pk_bf16_f32 v79, v85, v84
  v_mfma_f32_16x16x32_bf16 v[72:75], v[96:99], v[16:19], 0
  ds_read_b128 v[104:107], v8 offset:26624
  v_cndmask_b32 v78, v78, v79, vcc
  v_mov_b32_e64 v79, 0
  s_waitcnt vmcnt(6)
  v_mfma_f32_16x16x32_bf16 v[80:83], v[32:35], v[16:19], 0
  ds_read_b128 v[108:111], v8 offset:27648
  v_mov_b32 v93, 0
  s_waitcnt vmcnt(5)
  v_mfma_f32_16x16x32_bf16 v[84:87], v[36:39], v[16:19], 0
  ds_read_b128 v[112:115], v8 offset:28672
  v_mfma_f32_16x16x16_bf16 v[72:75], v[96:97], v[78:79], v[72:75]
  ds_read_b128 v[116:119], v8 offset:29696
  v_mfma_f32_16x16x16_bf16 v[80:83], v[88:89], v[78:79], v[80:83]
  ds_read_b128 v[120:123], v8 offset:30720
  v_mfma_f32_16x16x16_bf16 v[84:87], v[92:93], v[78:79], v[84:87]
  ds_read_b128 v[124:127], v8 offset:31744
  buffer_store_dwordx2 v[88:89], v13, s[4:7], s45 offen sc1
  v_rcp_f32 v1, v72
  s_nop 0
  v_cndmask_b32 v80, v80, v82, vcc
  v_cndmask_b32 v81, v81, v83, vcc
  v_mul_f32 v80, v80, v1
  v_mul_f32 v81, v81, v1
  v_cvt_pk_bf16_f32 v76, v80, v81
  v_cndmask_b32 v84, v84, v86, vcc
  v_cndmask_b32 v85, v85, v87, vcc
  v_mul_f32 v84, v84, v1
  v_mul_f32 v85, v85, v1
  v_cvt_pk_bf16_f32 v77, v84, v85
  ds_write_b64 v15, v[76:77]
  v_mov_b64 v[32:33], -1
  v_mov_b64 v[34:35], -1
  buffer_store_dwordx4 v[32:35], v6, s[4:7], s33 offen offset:0 sc1
  buffer_store_dwordx4 v[32:35], v6, s[4:7], s33 offen offset:1024 sc1
  v_mov_b64 v[40:41], 0
  v_mov_b64 v[42:43], 0
  v_mov_b64 v[44:45], 0
  v_mov_b64 v[46:47], 0
  v_mov_b64 v[48:49], 0
  v_mov_b64 v[50:51], 0
  v_mov_b64 v[52:53], 0
  v_mov_b64 v[54:55], 0
  v_mov_b64 v[56:57], 0
  v_mov_b64 v[58:59], 0
  v_mov_b64 v[60:61], 0
  v_mov_b64 v[62:63], 0
  v_mov_b64 v[64:65], 0
  v_mov_b64 v[66:67], 0
  v_mov_b64 v[68:69], 0
  v_mov_b64 v[70:71], 0
  s_waitcnt lgkmcnt(0)
  s_barrier
  ds_read_b128 v[72:75], v6 offset:18432
  s_nop 1
  ds_read_b128 v[76:79], v6 offset:19456
  s_waitcnt lgkmcnt(1)
  v_smfmac_f32_16x16x64_bf16 v[40:43], v[72:75], v[160:167], v2
  ds_read_b128 v[96:99], v8 offset:24576
  s_waitcnt lgkmcnt(1)
  v_smfmac_f32_16x16x64_bf16 v[40:43], v[76:79], v[168:175], v2
  ds_read_b128 v[100:103], v8 offset:25600
  v_smfmac_f32_16x16x64_bf16 v[44:47], v[72:75], v[176:183], v2
  v_smfmac_f32_16x16x64_bf16 v[44:47], v[76:79], v[184:191], v2
  v_add_f32 v40, v40, v41
  v_add_f32_e64 v42, v42, v43
  v_smfmac_f32_16x16x64_bf16 v[48:51], v[72:75], v[192:199], v2
  v_cvt_pk_bf16_f32 v80, v40, v42
  v_smfmac_f32_16x16x64_bf16 v[48:51], v[76:79], v[200:207], v2
  ds_write_b128 v7, v[32:35] offset:8192
  v_add_f32 v44, v44, v45
  v_add_f32 v46, v46, v47
  v_smfmac_f32_16x16x64_bf16 v[52:55], v[72:75], v[208:215], v2
  ds_write_b32 v14, v32 offset:17408
  v_cvt_pk_bf16_f32 v81, v44, v46
  v_smfmac_f32_16x16x64_bf16 v[52:55], v[76:79], v[216:223], v2
  buffer_store_dwordx2 v[80:81], v3, s[4:7], s16 offen sc1
  v_add_f32 v48, v48, v49
  v_add_f32 v50, v50, v51
  v_smfmac_f32_16x16x64_bf16 v[56:59], v[72:75], v[224:231], v2
  v_cvt_pk_bf16_f32 v82, v48, v50
  v_smfmac_f32_16x16x64_bf16 v[56:59], v[76:79], v[232:239], v2
  v_add_f32 v52, v52, v53
  v_add_f32 v54, v54, v55
  v_smfmac_f32_16x16x64_bf16 v[60:63], v[72:75], v[240:247], v2
  v_cvt_pk_bf16_f32 v83, v52, v54
  v_smfmac_f32_16x16x64_bf16 v[60:63], v[76:79], v[248:255], v2
  buffer_store_dwordx2 v[82:83], v3, s[4:7], s17 offen sc1
  v_add_f32 v56, v56, v57
  v_add_f32_e64 v58, v58, v59
  s_waitcnt lgkmcnt(2)
  v_smfmac_f32_16x16x64_bf16 v[64:67], v[72:75], v[96:103], v2
  v_cvt_pk_bf16_f32 v84, v56, v58
  v_smfmac_f32_16x16x64_bf16 v[64:67], v[76:79], v[104:111], v2
  v_add_f32 v60, v60, v61
  v_add_f32 v62, v62, v63
  v_smfmac_f32_16x16x64_bf16 v[68:71], v[72:75], v[112:119], v2
  v_cvt_pk_bf16_f32 v85, v60, v62
  v_smfmac_f32_16x16x64_bf16 v[68:71], v[76:79], v[120:127], v2
  buffer_store_dwordx2 v[84:85], v3, s[4:7], s22 offen sc1
  v_add_f32 v64, v64, v65
  v_add_f32_e64 v66, v66, v67
  s_nop 0
  v_cvt_pk_bf16_f32 v86, v64, v66
  s_nop 2
  v_add_f32 v68, v68, v69
  v_add_f32_e64 v70, v70, v71
  v_cvt_pk_bf16_f32 v87, v68, v70
  buffer_store_dwordx2 v[86:87], v3, s[4:7], s23 offen sc1
  s_add_u32 s28, s28, 8192
  s_add_u32 s30, s30, 8192
  s_add_u32 s31, s31, 65536
  s_add_u32 s32, s32, 65536
  s_add_u32 s10, s10, 1
  s_add_u32 s44, s31, s42
  s_add_u32 s45, s32, s43
  s_cmp_lg_u32 s9, 0
  s_cbranch_scc1 L_d_b0
  v_add_u32 v0, 20480, v6
  ds_read_b128 v[72:75], v0
  v_mov_b64 v[88:89], -1
  s_mov_b32 s46, 0
  s_sleep 1
  s_sleep 1
  s_sleep 1
  s_nop 15
  s_nop 2
  buffer_load_dwordx4 v[40:43], v6, s[4:7], s24 offen offset:0 sc1
  buffer_load_dwordx4 v[44:47], v6, s[4:7], s24 offen offset:1024 sc1
  buffer_load_dwordx4 v[48:51], v6, s[4:7], s24 offen offset:2048 sc1
  buffer_load_dwordx4 v[52:55], v6, s[4:7], s24 offen offset:3072 sc1
  buffer_load_dwordx4 v[56:59], v6, s[4:7], s25 offen offset:0 sc1
  buffer_load_dwordx4 v[60:63], v6, s[4:7], s25 offen offset:1024 sc1
  buffer_load_dwordx4 v[64:67], v6, s[4:7], s25 offen offset:2048 sc1
  buffer_load_dwordx4 v[68:71], v6, s[4:7], s25 offen offset:3072 sc1
  s_sleep 1
  s_nop 15
  buffer_load_dwordx4 v[96:99], v6, s[4:7], s24 offen offset:0 sc1
  buffer_load_dwordx4 v[100:103], v6, s[4:7], s24 offen offset:1024 sc1
  buffer_load_dwordx4 v[104:107], v6, s[4:7], s24 offen offset:2048 sc1
  buffer_load_dwordx4 v[108:111], v6, s[4:7], s24 offen offset:3072 sc1
  buffer_load_dwordx4 v[112:115], v6, s[4:7], s25 offen offset:0 sc1
  buffer_load_dwordx4 v[116:119], v6, s[4:7], s25 offen offset:1024 sc1
  buffer_load_dwordx4 v[120:123], v6, s[4:7], s25 offen offset:2048 sc1
  buffer_load_dwordx4 v[124:127], v6, s[4:7], s25 offen offset:3072 sc1
  s_waitcnt lgkmcnt(0)
L_d_rA:
  s_waitcnt vmcnt(15)
  v_mfma_f32_16x16x32_bf16 v[76:79], v[40:43], v[72:75], 0
  v_max_u32 v90, v40, v42
  s_waitcnt vmcnt(14)
  v_mfma_f32_16x16x32_bf16 v[76:79], v[44:47], v[72:75], v[76:79]
  v_max3_u32 v90, v90, v44, v46
  s_waitcnt vmcnt(13)
  v_mfma_f32_16x16x32_bf16 v[76:79], v[48:51], v[72:75], v[76:79]
  v_max3_u32 v90, v90, v48, v50
  s_waitcnt vmcnt(12)
  v_mfma_f32_16x16x32_bf16 v[76:79], v[52:55], v[72:75], v[76:79]
  v_max3_u32 v90, v90, v52, v54
  s_waitcnt vmcnt(11)
  v_mfma_f32_16x16x32_bf16 v[76:79], v[56:59], v[72:75], v[76:79]
  v_max3_u32 v90, v90, v56, v58
  s_waitcnt vmcnt(10)
  v_mfma_f32_16x16x32_bf16 v[76:79], v[60:63], v[72:75], v[76:79]
  v_max3_u32 v90, v90, v60, v62
  s_waitcnt vmcnt(9)
  v_mfma_f32_16x16x32_bf16 v[76:79], v[64:67], v[72:75], v[76:79]
  v_max3_u32 v90, v90, v64, v66
  s_waitcnt vmcnt(8)
  v_mfma_f32_16x16x32_bf16 v[76:79], v[68:71], v[72:75], v[76:79]
  v_max3_u32 v90, v90, v68, v70
  v_cmp_eq_u32_e64 vcc, -1, v90
  s_nop 4
  s_cbranch_vccnz L_d_rAfail
  v_cvt_pk_bf16_f32 v76, v76, v77
  v_cvt_pk_bf16_f32 v77, v78, v79
  buffer_store_dwordx2 v[76:77], v11, s[4:7], s26 offen sc1
  buffer_store_dwordx2 v[88:89], v11, s[4:7], s34 offen sc1
L_d_rdone:
L_d_b0:
  s_barrier
  s_xor_b32 s26, s26, 0x2000
  s_xor_b32 s34, s34, 0x2000
  s_add_u32 s35, s35, 1
  s_cmp_eq_u32 s35, 3
  s_cselect_b32 s35, 0, s35
  s_lshl_b32 s62, s35, 18
  s_add_u32 s62, s62, 262144
  s_add_u32 s16, s62, s18
  s_add_u32 s17, s16, 16384
  s_add_u32 s22, s16, 32768
  s_add_u32 s23, s16, 49152
  s_add_u32 s24, s62, s20
  s_add_u32 s25, s24, 4096
  s_add_u32 s61, s35, 2
  s_cmp_ge_u32 s61, 3
  s_cselect_b32 s60, 3, 0
  s_sub_u32 s61, s61, s60
  s_lshl_b32 s61, s61, 18
  s_add_u32 s61, s61, 262144
  s_add_u32 s33, s61, s21
  s_mov_b32 s46, 0
  s_nop 4
  buffer_load_dwordx4 v[40:43], v6, s[4:7], s27 offen sc1
  buffer_load_dwordx4 v[44:47], v6, s[4:7], s27 offen offset:1024 sc1
  ds_read_b128 v[84:87], v6 offset:21504
  s_add_u32 s56, s10, 2
  s_min_u32 s56, s56, 64
  s_waitcnt lgkmcnt(0)
  v_readlane_b32 s57, v84, 0
  v_readlane_b32 s58, v85, 0
  v_readlane_b32 s59, v86, 0
  v_readlane_b32 s60, v87, 0
  s_min_u32 s57, s57, s58
  s_min_u32 s59, s59, s60
  s_min_u32 s57, s57, s59
  s_max_u32 s37, s37, s57
  s_cmp_lt_u32 s37, s56
  s_cbranch_scc1 L_d_needslow
L_d_needok:
  s_waitcnt vmcnt(2)
  v_mov_b64 v[72:73], 0
  v_mov_b64 v[74:75], 0
  v_mov_b64 v[76:77], 0
  v_mov_b64 v[78:79], 0
  v_mov_b64 v[80:81], 0
  v_mov_b64 v[82:83], 0
  v_mov_b64 v[84:85], 0
  v_mov_b64 v[86:87], 0
  v_mov_b64 v[88:89], 0
  v_mov_b64 v[90:91], 0
  v_mov_b64 v[92:93], 0
  v_mov_b64_e64 v[94:95], 0
  ds_read_b128 v[96:99], v8 offset:0
  ds_read_b128 v[100:103], v8 offset:1024
  ds_read_b128 v[104:107], v8 offset:2048
  ds_read_b128 v[108:111], v8 offset:3072
  ds_read_b128 v[112:115], v8 offset:4096
  ds_read_b128 v[116:119], v8 offset:5120
  ds_read_b128 v[120:123], v8 offset:6144
  ds_read_b128 v[124:127], v8 offset:7168
  s_nop 6
  buffer_load_dwordx4 v[32:35], v6, s[4:7], s27 offen sc1
  buffer_load_dwordx4 v[36:39], v6, s[4:7], s27 offen offset:1024 sc1
L_d_pA:
  s_waitcnt vmcnt(2)
  ds_write_b128 v7, v[40:43] offset:0
  ds_write_b128 v7, v[44:47] offset:1024
  v_max3_u32 v0, v40, v42, v44
  v_max_u32 v0, v0, v46
  v_cmp_eq_u32 vcc, -1, v0
  s_cbranch_vccnz L_d_pAfail
L_d_pdone:
  s_waitcnt lgkmcnt(2)
  s_cmp_lt_u32 s10, 63
  s_nop 0
  s_cbranch_scc1 L_d_step
L_d_last:
  s_add_u32 s42, s31, s42
  s_add_u32 s43, s32, s43
  v_xor_b32 v16, 2048, v7
  v_xor_b32 v17, 4096, v7
  v_xor_b32 v18, 6144, v7
  s_waitcnt vmcnt(0) lgkmcnt(0)
  s_barrier
  ds_read_b128 v[48:51], v16 offset:0
  ds_read_b128 v[52:55], v16 offset:1024
  ds_read_b128 v[56:59], v17 offset:0
  ds_read_b128 v[60:63], v17 offset:1024
  ds_read_b128 v[64:67], v18 offset:0
  ds_read_b128 v[68:71], v18 offset:1024
  ds_read_b128 v[96:99], v8 offset:8192
  ds_read_b128 v[100:103], v8 offset:9216
  ds_read_b128 v[104:107], v8 offset:10240
  ds_read_b128 v[108:111], v8 offset:11264
  ds_read_b128 v[112:115], v8 offset:12288
  ds_read_b128 v[116:119], v8 offset:13312
  ds_read_b128 v[120:123], v8 offset:14336
  ds_read_b128 v[124:127], v8 offset:15360
  v_smfmac_f32_16x16x64_bf16 v[80:83], v[40:43], a[96:103], v2
  v_smfmac_f32_16x16x64_bf16 v[84:87], v[40:43], a[104:111], v2
  v_smfmac_f32_16x16x64_bf16 v[80:83], v[44:47], a[112:119], v2
  v_smfmac_f32_16x16x64_bf16 v[84:87], v[44:47], a[120:127], v2
  s_waitcnt lgkmcnt(6)
  v_smfmac_f32_16x16x64_bf16 v[80:83], v[48:51], v[96:103], v2
  s_waitcnt lgkmcnt(4)
  v_smfmac_f32_16x16x64_bf16 v[84:87], v[48:51], v[104:111], v2
  s_waitcnt lgkmcnt(2)
  v_smfmac_f32_16x16x64_bf16 v[80:83], v[52:55], v[112:119], v2
  s_waitcnt lgkmcnt(0)
  v_smfmac_f32_16x16x64_bf16 v[84:87], v[52:55], v[120:127], v2
  v_smfmac_f32_16x16x64_bf16 v[80:83], v[56:59], a[128:135], v2
  v_smfmac_f32_16x16x64_bf16 v[84:87], v[56:59], a[136:143], v2
  v_smfmac_f32_16x16x64_bf16 v[80:83], v[60:63], a[144:151], v2
  v_smfmac_f32_16x16x64_bf16 v[84:87], v[60:63], a[152:159], v2
  v_smfmac_f32_16x16x64_bf16 v[80:83], v[64:67], a[160:167], v2
  v_smfmac_f32_16x16x64_bf16 v[84:87], v[64:67], a[168:175], v2
  v_smfmac_f32_16x16x64_bf16 v[80:83], v[68:71], a[176:183], v2
  v_smfmac_f32_16x16x64_bf16 v[84:87], v[68:71], a[184:191], v2
  ds_read_b128 v[96:99], v8 offset:16384
  ds_read_b128 v[100:103], v8 offset:17408
  ds_read_b128 v[104:107], v8 offset:18432
  ds_read_b128 v[108:111], v8 offset:19456
  ds_read_b128 v[112:115], v8 offset:20480
  ds_read_b128 v[116:119], v8 offset:21504
  ds_read_b128 v[120:123], v8 offset:22528
  ds_read_b128 v[124:127], v8 offset:23552
  v_cvt_pk_bf16_f32 v20, v80, v81
  v_cvt_pk_bf16_f32 v21, v82, v83
  v_cvt_pk_bf16_f32 v22, v84, v85
  v_cvt_pk_bf16_f32 v23, v86, v87
  v_mfma_f32_16x16x16_bf16 v[80:83], v[20:21], v[4:5], 0
  v_mfma_f32_16x16x16_bf16 v[84:87], v[22:23], v[4:5], 0
  v_smfmac_f32_16x16x64_bf16 v[88:91], v[40:43], a[192:199], v2
  v_smfmac_f32_16x16x64_bf16 v[92:95], v[40:43], a[200:207], v2
  v_smfmac_f32_16x16x64_bf16 v[88:91], v[44:47], a[208:215], v2
  v_smfmac_f32_16x16x64_bf16 v[92:95], v[44:47], a[216:223], v2
  v_smfmac_f32_16x16x64_bf16 v[88:91], v[48:51], a[224:231], v2
  v_smfmac_f32_16x16x64_bf16 v[92:95], v[48:51], a[232:239], v2
  v_smfmac_f32_16x16x64_bf16 v[88:91], v[52:55], a[240:247], v2
  v_smfmac_f32_16x16x64_bf16 v[92:95], v[52:55], a[248:255], v2
  v_smfmac_f32_16x16x64_bf16 v[88:91], v[64:67], v[128:135], v2
  v_smfmac_f32_16x16x64_bf16 v[92:95], v[64:67], v[136:143], v2
  v_smfmac_f32_16x16x64_bf16 v[88:91], v[68:71], v[144:151], v2
  v_smfmac_f32_16x16x64_bf16 v[92:95], v[68:71], v[152:159], v2
  s_waitcnt lgkmcnt(6)
  v_smfmac_f32_16x16x64_bf16 v[88:91], v[56:59], v[96:103], v2
  s_waitcnt lgkmcnt(4)
  v_smfmac_f32_16x16x64_bf16 v[92:95], v[56:59], v[104:111], v2
  s_waitcnt lgkmcnt(2)
  v_smfmac_f32_16x16x64_bf16 v[88:91], v[60:63], v[112:119], v2
  s_waitcnt lgkmcnt(0)
  v_smfmac_f32_16x16x64_bf16 v[92:95], v[60:63], v[120:127], v2
  v_cvt_pk_bf16_f32 v20, v80, v84
  v_cvt_pk_bf16_f32 v21, v81, v85
  v_cvt_pk_bf16_f32 v22, v82, v86
  v_cvt_pk_bf16_f32 v23, v83, v87
  buffer_store_dwordx4 v[20:23], v12, s[4:7], s42 offen sc1
  v_add_f32 v88, v88, v89
  v_add_f32 v90, v90, v91
  s_nop 0
  v_add_f32 v92, v92, v93
  v_add_f32 v94, v94, v95
  v_cvt_pk_bf16_f32 v88, v88, v90
  v_cvt_pk_bf16_f32 v89, v92, v94
  buffer_store_dwordx2 v[88:89], v13, s[4:7], s43 offen sc1
  s_waitcnt vmcnt(0) lgkmcnt(0)
  v_mov_b32 v0, 64
  buffer_store_dword v0, v10, s[4:7], s47 offen sc1
  s_waitcnt vmcnt(0)
  s_branch L_c_fin
L_d_rAfail:
  s_add_u32 s46, s46, 1
  s_cmp_ge_u32 s46, 20000
  s_cbranch_scc1 L_bail
  buffer_load_dwordx4 v[40:43], v6, s[4:7], s24 offen offset:0 sc1
  buffer_load_dwordx4 v[44:47], v6, s[4:7], s24 offen offset:1024 sc1
  buffer_load_dwordx4 v[48:51], v6, s[4:7], s24 offen offset:2048 sc1
  buffer_load_dwordx4 v[52:55], v6, s[4:7], s24 offen offset:3072 sc1
  buffer_load_dwordx4 v[56:59], v6, s[4:7], s25 offen offset:0 sc1
  buffer_load_dwordx4 v[60:63], v6, s[4:7], s25 offen offset:1024 sc1
  buffer_load_dwordx4 v[64:67], v6, s[4:7], s25 offen offset:2048 sc1
  buffer_load_dwordx4 v[68:71], v6, s[4:7], s25 offen offset:3072 sc1
  s_waitcnt vmcnt(15)
  v_mfma_f32_16x16x32_bf16 v[80:83], v[96:99], v[72:75], 0
  v_max_u32 v90, v96, v98
  s_waitcnt vmcnt(14)
  v_mfma_f32_16x16x32_bf16 v[80:83], v[100:103], v[72:75], v[80:83]
  v_max3_u32 v90, v90, v100, v102
  s_waitcnt vmcnt(13)
  v_mfma_f32_16x16x32_bf16 v[80:83], v[104:107], v[72:75], v[80:83]
  v_max3_u32 v90, v90, v104, v106
  s_waitcnt vmcnt(12)
  v_mfma_f32_16x16x32_bf16 v[80:83], v[108:111], v[72:75], v[80:83]
  v_max3_u32 v90, v90, v108, v110
  s_waitcnt vmcnt(11)
  v_mfma_f32_16x16x32_bf16 v[80:83], v[112:115], v[72:75], v[80:83]
  v_max3_u32 v90, v90, v112, v114
  s_waitcnt vmcnt(10)
  v_mfma_f32_16x16x32_bf16 v[80:83], v[116:119], v[72:75], v[80:83]
  v_max3_u32 v90, v90, v116, v118
  s_waitcnt vmcnt(9)
  v_mfma_f32_16x16x32_bf16 v[80:83], v[120:123], v[72:75], v[80:83]
  v_max3_u32 v90, v90, v120, v122
  s_waitcnt vmcnt(8)
  v_mfma_f32_16x16x32_bf16 v[80:83], v[124:127], v[72:75], v[80:83]
  v_max3_u32 v90, v90, v124, v126
  v_cmp_eq_u32 vcc, -1, v90
  s_nop 4
  s_cbranch_vccnz L_d_rBfail
  v_cvt_pk_bf16_f32 v80, v80, v81
  v_cvt_pk_bf16_f32 v81, v82, v83
  buffer_store_dwordx2 v[80:81], v11, s[4:7], s26 offen sc1
  buffer_store_dwordx2 v[88:89], v11, s[4:7], s34 offen sc1
  s_branch L_d_rdone
L_d_rBfail:
  buffer_load_dwordx4 v[96:99], v6, s[4:7], s24 offen offset:0 sc1
  buffer_load_dwordx4 v[100:103], v6, s[4:7], s24 offen offset:1024 sc1
  buffer_load_dwordx4 v[104:107], v6, s[4:7], s24 offen offset:2048 sc1
  buffer_load_dwordx4 v[108:111], v6, s[4:7], s24 offen offset:3072 sc1
  buffer_load_dwordx4 v[112:115], v6, s[4:7], s25 offen offset:0 sc1
  buffer_load_dwordx4 v[116:119], v6, s[4:7], s25 offen offset:1024 sc1
  buffer_load_dwordx4 v[120:123], v6, s[4:7], s25 offen offset:2048 sc1
  buffer_load_dwordx4 v[124:127], v6, s[4:7], s25 offen offset:3072 sc1
  s_branch L_d_rA
L_d_pAfail:
  s_add_u32 s46, s46, 1
  s_cmp_ge_u32 s46, 20000
  s_cbranch_scc1 L_bail
  buffer_load_dwordx4 v[40:43], v6, s[4:7], s27 offen sc1
  buffer_load_dwordx4 v[44:47], v6, s[4:7], s27 offen offset:1024 sc1
  s_waitcnt vmcnt(2)
  ds_write_b128 v7, v[32:35] offset:0
  ds_write_b128 v7, v[36:39] offset:1024
  v_max3_u32 v0, v32, v34, v36
  v_max_u32 v0, v0, v38
  v_cmp_eq_u32 vcc, -1, v0
  s_cbranch_vccnz L_d_pBfail
  s_waitcnt vmcnt(0)
  s_nop 1
  s_branch L_d_pdone
L_d_pBfail:
  buffer_load_dwordx4 v[32:35], v6, s[4:7], s27 offen sc1
  buffer_load_dwordx4 v[36:39], v6, s[4:7], s27 offen offset:1024 sc1
  s_branch L_d_pA
L_d_xretry:
  s_nop 15
  s_mov_b32 s46, 0
L_d_xr_loop:
  ds_read_b128 v[72:75], v6 offset:8192
  ds_read_b128 v[76:79], v6 offset:10240
  ds_read_b128 v[104:107], v6 offset:12288
  ds_read_b128 v[108:111], v6 offset:14336
  ds_read_b128 v[84:87], v6 offset:17408
  s_waitcnt lgkmcnt(0)
  v_max3_u32 v1, v84, v85, v86
  v_max_u32 v1, v1, v87
  v_max3_u32 v1, v1, v72, v73
  v_max3_u32 v1, v1, v74, v75
  v_max3_u32 v1, v1, v76, v77
  v_max3_u32 v1, v1, v78, v79
  v_max3_u32 v1, v1, v104, v105
  v_max3_u32 v1, v1, v106, v107
  v_max3_u32 v1, v1, v108, v109
  v_max3_u32 v1, v1, v110, v111
  v_cmp_eq_u32 vcc, -1, v1
  s_cbranch_vccz L_d_xr_ok
  s_add_u32 s46, s46, 1
  s_cmp_lt_u32 s46, 20000
  s_nop 0
  s_cbranch_scc1 L_d_xr_loop
  s_branch L_bail
L_d_xr_ok:
  v_add_f32 v72, v72, v76
  v_add_f32 v73, v73, v77
  v_add_f32 v74, v74, v78
  v_add_f32 v75, v75, v79
  v_add_f32 v104, v104, v108
  v_add_f32 v105, v105, v109
  v_add_f32 v106, v106, v110
  v_add_f32 v107, v107, v111
  v_add_f32 v72, v72, v104
  v_add_f32 v73, v73, v105
  v_add_f32 v74, v74, v106
  v_add_f32 v75, v75, v107
  v_max3_f32 v0, v72, v73, v74
  v_max_f32 v0, v0, v75
  v_add_f32 v84, v84, v85
  v_add_f32 v86, v86, v87
  v_add_f32 v84, v84, v86
  v_max_f32 v0, v0, v84
  s_mov_b64 vcc, s[12:13]
  s_branch L_d_xok
L_d_needslow:
  s_mov_b32 s95, s56
  s_mov_b32 s46, 0
L_cnds:
  v_mov_b32 v1, 0
  buffer_load_dword v0, v1, s[4:7], s39 offen sc1
  s_waitcnt vmcnt(0)
  v_readfirstlane_b32 s37, v0
  s_nop 0
  s_cmp_ge_u32 s37, s95
  s_nop 1
  s_cbranch_scc1 L_cndsd
  s_sleep 2
  s_add_u32 s46, s46, 1
  s_cmp_lt_u32 s46, 400000
  s_cbranch_scc1 L_cnds
  s_branch L_bail
L_cndsd:
  s_branch L_d_needok
L_c_fin:
  s_endpgm
L_bail:
  v_mov_b32 v0, 0xdead
  v_mov_b32 v1, 4
  s_mov_b64 exec, 1
  buffer_store_dword v0, v1, s[52:55], 0 offen
  s_waitcnt vmcnt(0)
  s_endpgm
L_exit:
  s_endpgm
L_code_end:
  s_endpgm
.section .rodata,"a"
.p2align 6
.amdhsa_kernel adaLN_cond__memory_aug_recurrent_mem_tr__dense_activation_relu__prompt_kernel
  .amdhsa_next_free_vgpr 512
  .amdhsa_next_free_sgpr 102
  .amdhsa_accum_offset 256
  .amdhsa_group_segment_fixed_size 0
  .amdhsa_kernarg_size 120
  .amdhsa_user_sgpr_count 2
  .amdhsa_user_sgpr_kernarg_segment_ptr 1
  .amdhsa_system_sgpr_workgroup_id_x 1
.end_amdhsa_kernel
.text
```
